```python
import torch

def _softmax(x, axis=-1):
    return torch.softmax(x, dim=axis)
def _gelu(x):
    return torch.nn.functional.gelu(x, approximate="tanh")
def _silu(x):
    return torch.nn.functional.silu(x)
def _sigmoid(x):
    return torch.sigmoid(x)
def _layernorm(x, axis=-1, eps=1e-5):
    m = x.mean(dim=axis, keepdim=True)
    v = x.var(dim=axis, keepdim=True, unbiased=False)
    return (x - m) / torch.sqrt(v + eps)
def _scatter_add(tgt, idx, src, axis=0):
    return tgt.clone().index_add_(axis, idx, src)
def _segment_sum(src, seg, n):
    out = torch.zeros((n,) + src.shape[1:], dtype=src.dtype)
    return out.index_add_(0, seg, src)
def _pad(x, pw):
    flat = tuple(v for pair in reversed(pw) for v in pair)
    return torch.nn.functional.pad(x, flat)

kernel_name = 'recurrent_scan__linear_kernel_hedgehog__dense_activation_mish__prompt'

def setup_inputs():

    _w = (lambda a: (lambda t: t.to(torch.bfloat16) if t.is_floating_point() else t)(torch.as_tensor(a)))
    def _A_setup():
        B, S, D, H = 1, 2048, 640, 32
        Dh = D // H
        return {
            "x": _w((lambda *s: torch.randn(*s, dtype=torch.bfloat16) * 0.05)(B, S, D)),
            "wqkv": _w((lambda *s: torch.randn(*s, dtype=torch.bfloat16) * 0.4)(D, 3 * D)),
            "w_phi": _w((lambda *s: torch.randn(*s, dtype=torch.bfloat16) * 0.4)(H, Dh, Dh) * (Dh ** -0.5)),
            "wo": _w((lambda *s: torch.randn(*s, dtype=torch.bfloat16) * 0.2)(D, D)),
        }
    _A_in = _A_setup()

    def _B_setup():
        B, S, D, F = 1, 2048, 640, 1728
        return {
            "x": _w((lambda *s: torch.randn(*s, dtype=torch.bfloat16) * 0.05)(B, S, D)),
            "w1": _w((lambda *s: torch.randn(*s, dtype=torch.bfloat16) * 0.4)(D, F) * (D ** -0.5)),
            "b1": _w((lambda *s: torch.randn(*s, dtype=torch.bfloat16) * 0.4)(F)),
            "w2": _w((lambda *s: torch.randn(*s, dtype=torch.bfloat16) * 0.1)(F, D) * (F ** -0.5)),
        }
    _B_in = _B_setup()

    return {
        "A_x": _A_in["x"],
        "A_wqkv": _A_in["wqkv"],
        "A_w_phi": _A_in["w_phi"],
        "A_wo": _A_in["wo"],
        "B_x": _B_in["x"],
        "B_w1": _B_in["w1"],
        "B_b1": _B_in["b1"],
        "B_w2": _B_in["w2"],
    }

def reference(A_x, A_wqkv, A_w_phi, A_wo, B_x, B_w1, B_b1, B_w2):
    def _A_ref(x, wqkv, w_phi, wo):
        B, S, D = x.shape
        H = 32; Dh = D // H
        qkv = (lambda x, *d: x.permute(*d))((x @ wqkv).reshape(B, S, 3, H, Dh), 2, 0, 3, 1, 4)
        q, k, v = qkv[0], qkv[1], qkv[2]
        pq = torch.einsum("bhsd,hdf->bhsf", q, w_phi)
        pk = torch.einsum("bhsd,hdf->bhsf", k, w_phi)
        phi_q = torch.concatenate([_softmax(pq, axis=-1), _softmax(-pq, axis=-1)], axis=-1)
        phi_k = torch.concatenate([_softmax(pk, axis=-1), _softmax(-pk, axis=-1)], axis=-1)
        kv = torch.einsum("bhsf,bhsd->bhfd", phi_k, v)
        z  = torch.einsum("bhsf->bhf", phi_k)
        num = torch.einsum("bhqf,bhfd->bhqd", phi_q, kv)
        den = torch.einsum("bhqf,bhf->bhq", phi_q, z)[..., None] + 1e-6
        o = num / den
        return (lambda x, *d: x.permute(*d))(o, 0, 2, 1, 3).reshape(B, S, D) @ wo

    def _B_ref(x, w1, b1, w2):
        h = torch.einsum("bsd,df->bsf", x, w1) + b1
        sp = torch.log1p(torch.exp(-torch.abs(h))) + torch.where(h > 0, h, torch.zeros_like(h))
        act = h * torch.tanh(sp)
        return torch.einsum("bsf,fd->bsd", act, w2)

    x = A_x
    xn = _layernorm(x, axis=-1)
    s = _A_ref(xn, A_wqkv, A_w_phi, A_wo)
    g = _silu(_B_ref(xn, B_w1, B_b1, B_w2))
    return x + s * g
```

```asm
; @launch grid=(256,1,1) block=(512,1,1) lds=159808
.amdgcn_target "amdgcn-amd-amdhsa--gfx950"
.text
.globl recurrent_scan__linear_kernel_hedgehog__dense_activation_mish__prompt_kernel
.p2align 8
.type recurrent_scan__linear_kernel_hedgehog__dense_activation_mish__prompt_kernel,@function
recurrent_scan__linear_kernel_hedgehog__dense_activation_mish__prompt_kernel:
    s_cmp_ge_u32 s2, 256
    s_cbranch_scc1 K1_exit
    s_load_dwordx2 s[38:39], s[0:1], 0
    s_load_dwordx4 s[40:43], s[0:1], 8
    s_load_dwordx4 s[44:47], s[0:1], 40
    s_load_dwordx2 s[48:49], s[0:1], 80
    s_load_dwordx2 s[58:59], s[0:1], 24
    s_load_dwordx2 s[60:61], s[0:1], 56
    s_load_dwordx2 s[62:63], s[0:1], 72
    s_and_b32 s30, s2, 7
    s_lshr_b32 s31, s2, 3
    s_and_b32 s20, s30, 1
    s_lshl_b32 s20, s20, 3
    s_and_b32 s33, s31, 7
    s_add_u32 s20, s20, s33
    s_lshr_b32 s33, s31, 3
    s_lshr_b32 s22, s33, 1
    s_and_b32 s33, s33, 1
    s_lshr_b32 s21, s30, 1
    s_lshl_b32 s21, s21, 1
    s_add_u32 s21, s21, s33
    v_and_b32 v171, 63, v0
    v_lshrrev_b32 v188, 6, v0
    v_and_b32 v172, 15, v0
    v_bfe_u32 v173, v0, 4, 2
    v_readfirstlane_b32 s23, v188
    v_mov_b32 v209, 1073741824
    s_and_b32 s24, s23, 3
    s_lshr_b32 s25, s23, 2
    s_lshl_b32 s28, s23, 10
    s_waitcnt lgkmcnt(0)
    s_mov_b32 s4, s38
    s_and_b32 s5, s39, 0xffff
    s_mov_b32 s6, 2621440
    s_mov_b32 s7, 0x20000
    s_mov_b32 s12, s48
    s_and_b32 s13, s49, 0xffff
    s_mov_b32 s14, 21250048
    s_mov_b32 s15, 0x20000
    s_or_b32 s30, s2, s23
    s_cmp_lg_u32 s30, 0
    s_cbranch_scc1 K1_noz
    s_mov_b32 s31, 17039360
    v_lshlrev_b32 v188, 8, v171
    v_mov_b32 v189, 0
    buffer_store_dword v189, v188, s[12:15], s31 offen sc1
    s_mov_b32 s96, s62
    s_and_b32 s97, s63, 0xffff
    s_mov_b32 s98, 256
    s_mov_b32 s99, 0x20000
    s_waitcnt vmcnt(0)
    v_mov_b32 v188, 1
    s_mov_b64 exec, 1
    buffer_store_dword v188, v189, s[96:99], 0 offen sc1
    s_mov_b64 exec, -1
K1_noz:
    s_cmp_eq_u32 s22, 1
    s_cbranch_scc1 K1_ffn
    s_mul_i32 s32, s21, 160
    v_mov_b32 v208, 80
    s_mov_b32 s8, s40
    s_and_b32 s9, s41, 0xffff
    s_mov_b32 s10, 2457600
    s_mov_b32 s11, 0x20000
    s_mov_b32 s16, s42
    s_and_b32 s17, s43, 0xffff
    s_mov_b32 s18, 25600
    s_mov_b32 s19, 0x20000
    v_lshl_add_u32 v188, s23, 6, v171
    v_lshrrev_b32 v189, 3, v188
    v_xor_b32 v190, v189, v188
    v_and_b32 v190, 7, v190
    s_lshl_b32 s30, s20, 7
    v_add_u32 v189, s30, v189
    v_mul_u32_u24 v189, 1280, v189
    v_lshl_add_u32 v158, v190, 4, v189
    v_add_u32 v159, 81920, v158
    s_lshl_b32 s30, s23, 6
    s_add_u32 s30, s30, 0
    v_add_u32 v188, s30, v171
    v_mul_u32_u24 v189, 2185, v188
    v_lshrrev_b32 v189, 16, v189
    v_mul_u32_u24 v190, 30, v189
    v_sub_u32 v190, v188, v190
    v_bfe_u32 v192, v189, 2, 2
    v_lshlrev_b32 v191, 3, v192
    v_bfe_u32 v192, v189, 4, 1
    v_lshl_add_u32 v191, v192, 2, v191
    v_and_b32 v192, 3, v189
    v_add_u32 v191, v191, v192
    v_mul_u32_u24 v191, 3840, v191
    v_cmp_le_u32 vcc, 15, v190
    s_nop 1
    v_cndmask_b32 v192, 0, 15, vcc
    v_sub_u32 v193, v190, v192
    v_cndmask_b32 v192, 0, v208, vcc
    v_mul_u32_u24 v194, 52, v193
    v_lshrrev_b32 v194, 8, v194
    v_mul_u32_u24 v195, 5, v194
    v_sub_u32 v195, v193, v195
    v_lshl_add_u32 v192, v195, 4, v192
    v_add_u32 v192, s32, v192
    v_add_u32 v195, 1, v194
    v_mul_u32_u24 v195, 1280, v195
    v_cmp_eq_u32 vcc, 2, v194
    s_nop 1
    v_cndmask_b32 v195, v195, 0, vcc
    v_add3_u32 v156, v191, v192, v195
    v_cmp_le_u32 vcc, 32, v189
    s_nop 1
    v_cndmask_b32 v156, v156, v209, vcc
    s_lshl_b32 s30, s23, 6
    s_add_u32 s30, s30, 512
    v_add_u32 v188, s30, v171
    v_mul_u32_u24 v189, 2185, v188
    v_lshrrev_b32 v189, 16, v189
    v_mul_u32_u24 v190, 30, v189
    v_sub_u32 v190, v188, v190
    v_bfe_u32 v192, v189, 2, 2
    v_lshlrev_b32 v191, 3, v192
    v_bfe_u32 v192, v189, 4, 1
    v_lshl_add_u32 v191, v192, 2, v191
    v_and_b32 v192, 3, v189
    v_add_u32 v191, v191, v192
    v_mul_u32_u24 v191, 3840, v191
    v_cmp_le_u32 vcc, 15, v190
    s_nop 1
    v_cndmask_b32 v192, 0, 15, vcc
    v_sub_u32 v193, v190, v192
    v_cndmask_b32 v192, 0, v208, vcc
    v_mul_u32_u24 v194, 52, v193
    v_lshrrev_b32 v194, 8, v194
    v_mul_u32_u24 v195, 5, v194
    v_sub_u32 v195, v193, v195
    v_lshl_add_u32 v192, v195, 4, v192
    v_add_u32 v192, s32, v192
    v_add_u32 v195, 1, v194
    v_mul_u32_u24 v195, 1280, v195
    v_cmp_eq_u32 vcc, 2, v194
    s_nop 1
    v_cndmask_b32 v195, v195, 0, vcc
    v_add3_u32 v157, v191, v192, v195
    v_cmp_le_u32 vcc, 32, v189
    s_nop 1
    v_cndmask_b32 v157, v157, v209, vcc
    s_lshl_b32 s33, s21, 2
    s_lshr_b32 s30, s23, 1
    s_add_u32 s31, s30, s33
    s_mul_i32 s31, s31, 800
    v_lshl_add_u32 v218, v171, 4, s31
    v_cmp_gt_u32 vcc, 50, v171
    s_nop 1
    v_cndmask_b32 v218, v209, v218, vcc
    s_lshl_b32 s31, s23, 10
    s_add_u32 m0, s31, 81920
    s_nop 0
    buffer_load_dwordx4 v218, s[16:19], 0 offen lds
    s_lshl_b32 s29, s22, 3
    s_add_u32 s29, s29, s21
    s_add_u32 s29, s29, s20
    s_and_b32 s29, s29, 15
    s_mul_i32 s29, s29, 10
    s_lshr_b32 s29, s29, 4
    s_lshl_b32 s56, s29, 1
    s_mov_b32 s52, s28
    s_add_u32 s26, s28, 98304
    s_mov_b32 s57, 0
    s_mov_b32 s27, 0
    s_mul_i32 s53, s56, 122880
    s_add_u32 s56, s56, 1
    s_cmp_eq_u32 s56, 20
    s_cselect_b32 s56, 0, s56
    s_lshl_b32 s54, s29, 7
    s_add_u32 s29, s29, 1
    s_cmp_eq_u32 s29, 10
    s_cselect_b32 s29, 0, s29
    s_add_u32 m0, s52, 0
    s_nop 0
    buffer_load_dwordx4 v156, s[8:11], s53 offen lds
    s_add_u32 m0, s52, 8192
    s_nop 0
    buffer_load_dwordx4 v157, s[8:11], s53 offen lds
    s_add_u32 s52, s52, 16384
    s_sub_u32 s55, s52, 98304
    s_cmp_ge_u32 s52, 98304
    s_cselect_b32 s52, s55, s52
    s_mul_i32 s53, s56, 122880
    s_add_u32 s56, s56, 1
    s_cmp_eq_u32 s56, 20
    s_cselect_b32 s56, 0, s56
    s_add_u32 s57, s57, 1
    s_cmp_ge_u32 s57, 20
    s_cselect_b32 s53, 1073741824, s53
    s_add_u32 m0, s26, 0
    s_nop 0
    buffer_load_dwordx4 v158, s[4:7], s54 offen lds
    s_add_u32 m0, s26, 8192
    s_nop 0
    buffer_load_dwordx4 v159, s[4:7], s54 offen lds
    s_add_u32 s26, s26, 16384
    s_sub_u32 s55, s26, 49152
    s_cmp_ge_u32 s26, 147456
    s_cselect_b32 s26, s55, s26
    s_lshl_b32 s54, s29, 7
    s_add_u32 s29, s29, 1
    s_cmp_eq_u32 s29, 10
    s_cselect_b32 s29, 0, s29
    s_add_u32 s27, s27, 1
    s_cmp_ge_u32 s27, 10
    s_cselect_b32 s54, 1073741824, s54
    s_add_u32 m0, s52, 0
    s_nop 0
    buffer_load_dwordx4 v156, s[8:11], s53 offen lds
    s_add_u32 m0, s52, 8192
    s_nop 0
    buffer_load_dwordx4 v157, s[8:11], s53 offen lds
    s_add_u32 s52, s52, 16384
    s_sub_u32 s55, s52, 98304
    s_cmp_ge_u32 s52, 98304
    s_cselect_b32 s52, s55, s52
    s_mul_i32 s53, s56, 122880
    s_add_u32 s56, s56, 1
    s_cmp_eq_u32 s56, 20
    s_cselect_b32 s56, 0, s56
    s_add_u32 s57, s57, 1
    s_cmp_ge_u32 s57, 20
    s_cselect_b32 s53, 1073741824, s53
    v_lshrrev_b32 v188, 2, v172
    v_lshl_add_u32 v188, v173, 2, v188
    v_mul_u32_u24 v188, 480, v188
    v_and_b32 v189, 3, v172
    v_lshl_add_u32 v188, v189, 3, v188
    s_mul_i32 s30, s25, 240
    v_add_u32 v152, s30, v188
    s_lshl_b32 s31, s24, 6
    v_add_u32 v154, s31, v152
    v_xor_b32 v188, v172, v173
    v_and_b32 v188, 7, v188
    v_lshlrev_b32 v188, 4, v188
    s_lshl_b32 s31, s24, 5
    v_add_u32 v174, s31, v172
    v_lshl_add_u32 v188, v174, 7, v188
    v_add_u32 v153, 98304, v188
    s_lshl_b32 s31, s25, 11
    v_add_u32 v155, s31, v153
    v_xor_b32 v164, 64, v153
    v_xor_b32 v165, 64, v155
    v_mov_b32 v0, 0
    v_mov_b32 v1, 0
    v_mov_b32 v2, 0
    v_mov_b32 v3, 0
    v_mov_b32 v4, 0
    v_mov_b32 v5, 0
    v_mov_b32 v6, 0
    v_mov_b32 v7, 0
    v_mov_b32 v8, 0
    v_mov_b32 v9, 0
    v_mov_b32 v10, 0
    v_mov_b32 v11, 0
    v_mov_b32 v12, 0
    v_mov_b32 v13, 0
    v_mov_b32 v14, 0
    v_mov_b32 v15, 0
    v_mov_b32 v16, 0
    v_mov_b32 v17, 0
    v_mov_b32 v18, 0
    v_mov_b32 v19, 0
    v_mov_b32 v20, 0
    v_mov_b32 v21, 0
    v_mov_b32 v22, 0
    v_mov_b32 v23, 0
    v_mov_b32 v24, 0
    v_mov_b32 v25, 0
    v_mov_b32 v26, 0
    v_mov_b32 v27, 0
    v_mov_b32 v28, 0
    v_mov_b32 v29, 0
    v_mov_b32 v30, 0
    v_mov_b32 v31, 0
    v_mov_b32 v32, 0
    v_mov_b32 v33, 0
    v_mov_b32 v34, 0
    v_mov_b32 v35, 0
    v_mov_b32 v36, 0
    v_mov_b32 v37, 0
    v_mov_b32 v38, 0
    v_mov_b32 v39, 0
    v_mov_b32 v40, 0
    v_mov_b32 v41, 0
    v_mov_b32 v42, 0
    v_mov_b32 v43, 0
    v_mov_b32 v44, 0
    v_mov_b32 v45, 0
    v_mov_b32 v46, 0
    v_mov_b32 v47, 0
    v_mov_b32 v48, 0
    v_mov_b32 v49, 0
    v_mov_b32 v50, 0
    v_mov_b32 v51, 0
    v_mov_b32 v52, 0
    v_mov_b32 v53, 0
    v_mov_b32 v54, 0
    v_mov_b32 v55, 0
    v_mov_b32 v56, 0
    v_mov_b32 v57, 0
    v_mov_b32 v58, 0
    v_mov_b32 v59, 0
    v_mov_b32 v60, 0
    v_mov_b32 v61, 0
    v_mov_b32 v62, 0
    v_mov_b32 v63, 0
    v_mov_b32 v128, 0
    v_mov_b32 v129, 0
    v_mov_b32 v130, 0
    v_mov_b32 v131, 0
    v_mov_b32 v132, 0
    v_mov_b32 v133, 0
    v_mov_b32 v134, 0
    v_mov_b32 v135, 0
    v_mov_b32 v136, 0
    v_mov_b32 v137, 0
    v_mov_b32 v138, 0
    v_mov_b32 v139, 0
    v_mov_b32 v140, 0
    v_mov_b32 v141, 0
    v_mov_b32 v142, 0
    v_mov_b32 v143, 0
    v_mov_b32 v160, 0x3f803f80
    v_mov_b32 v161, 0x3f803f80
    v_mov_b32 v162, 0x3f803f80
    v_mov_b32 v163, 0x3f803f80
    s_and_b32 s30, s23, 1
    s_lshl_b32 s30, s30, 4
    v_lshrrev_b32 v219, 2, v171
    v_add_u32 v219, s30, v219
    v_and_b32 v220, 3, v171
    s_lshr_b32 s30, s23, 1
    s_and_b32 s30, s30, 1
    s_lshl_b32 s30, s30, 2
    v_subrev_u32 v221, s30, v219
    v_mul_u32_u24 v222, 40, v221
    v_and_b32 v223, 1, v220
    v_mul_u32_u24 v223, 20, v223
    s_lshl_b32 s31, s23, 10
    s_add_u32 s31, s31, 81920
    v_add3_u32 v222, v222, v223, s31
    v_cmp_gt_u32 s[36:37], 20, v221
    v_mov_b32 v223, s31
    s_nop 0
    v_cndmask_b32 v222, v223, v222, s[36:37]
    v_cmp_gt_u32 vcc, 2, v220
    v_add_u32 v224, 8, v222
    s_nop 0
    v_cndmask_b32 v224, v224, v222, vcc
    v_add_u32 v225, 18, v222
    v_add_u32 v226, 10, v222
    v_cndmask_b32 v225, v225, v226, vcc
    s_and_b64 s[38:39], vcc, s[36:37]
    s_waitcnt vmcnt(6)
    ds_read_u16 v228, v224
    ds_read_u16 v229, v222 offset:2
    ds_read_u16 v230, v222 offset:4
    ds_read_u16 v231, v222 offset:6
    ds_read_u16 v232, v225
    ds_read_u16 v233, v222 offset:12
    ds_read_u16 v234, v222 offset:14
    ds_read_u16 v235, v222 offset:16
    s_waitcnt lgkmcnt(0)
    v_cndmask_b32 v228, 0, v228, s[36:37]
    v_cndmask_b32 v229, 0, v229, s[38:39]
    v_cndmask_b32 v230, 0, v230, s[38:39]
    v_cndmask_b32 v231, 0, v231, s[38:39]
    v_cndmask_b32 v232, 0, v232, s[36:37]
    v_cndmask_b32 v233, 0, v233, s[38:39]
    v_cndmask_b32 v234, 0, v234, s[38:39]
    v_cndmask_b32 v235, 0, v235, s[38:39]
    v_lshl_or_b32 v218, v229, 16, v228
    v_lshl_or_b32 v219, v231, 16, v230
    v_lshl_or_b32 v220, v233, 16, v232
    v_lshl_or_b32 v221, v235, 16, v234
    s_lshl_b32 s31, s23, 10
    s_add_u32 s31, s31, 147456
    v_lshl_add_u32 v222, v171, 4, s31
    ds_write_b128 v222, v[218:221]
    v_mov_b32 v144, v152
    v_mov_b32 v145, v153
    v_mov_b32 v146, v154
    v_mov_b32 v147, v155
    s_waitcnt vmcnt(2)
    s_waitcnt lgkmcnt(0)
    s_barrier
    s_mov_b32 s50, 4
    s_mov_b32 s51, 16384
    s_mov_b32 s47, 0
    ds_read_b64_tr_b16 v[64:65], v144 offset:0
    ds_read_b64_tr_b16 v[66:67], v144 offset:7680
    ds_read_b128 v[96:99], v145 offset:0
    ds_read_b128 v[100:103], v145 offset:2048
    ds_read_b128 v[112:115], v147
    ds_read_b64_tr_b16 v[68:69], v144 offset:32
    ds_read_b64_tr_b16 v[70:71], v144 offset:7712
    ds_read_b64_tr_b16 v[72:73], v144 offset:64
    ds_read_b64_tr_b16 v[74:75], v144 offset:7744
    ds_read_b64_tr_b16 v[76:77], v144 offset:96
    ds_read_b64_tr_b16 v[78:79], v144 offset:7776
    v_add_u32 v148, s51, v152
    v_add_u32 v150, s51, v154
    v_add_u32 v149, s47, v164
    v_add_u32 v151, s47, v165
    s_add_u32 s51, s51, 16384
    s_cmp_eq_u32 s51, 98304
    s_cselect_b32 s51, 0, s51
    s_waitcnt lgkmcnt(9)
    s_waitcnt lgkmcnt(7)
    v_mfma_f32_16x16x32_bf16 v[0:3], v[64:67], v[96:99], v[0:3]
    ds_read_b64_tr_b16 v[80:81], v144 offset:128
    ds_read_b64_tr_b16 v[82:83], v144 offset:7808
    v_mfma_f32_16x16x32_bf16 v[32:35], v[64:67], v[100:103], v[32:35]
    ds_read_b64_tr_b16 v[120:121], v146 offset:0
    ds_read_b64_tr_b16 v[122:123], v146 offset:7680
    s_waitcnt lgkmcnt(10)
    v_mfma_f32_16x16x32_bf16 v[128:131], v[160:163], v[112:115], v[128:131]
    s_waitcnt lgkmcnt(8)
    v_mfma_f32_16x16x32_bf16 v[4:7], v[68:71], v[96:99], v[4:7]
    ds_read_b64_tr_b16 v[84:85], v144 offset:160
    ds_read_b64_tr_b16 v[86:87], v144 offset:7840
    v_mfma_f32_16x16x32_bf16 v[36:39], v[68:71], v[100:103], v[36:39]
    ds_read_b64_tr_b16 v[124:125], v146 offset:32
    ds_read_b64_tr_b16 v[126:127], v146 offset:7712
    v_mfma_f32_16x16x32_bf16 v[132:135], v[112:115], v[112:115], v[132:135]
    s_waitcnt lgkmcnt(10)
    v_mfma_f32_16x16x32_bf16 v[8:11], v[72:75], v[96:99], v[8:11]
    ds_read_b64_tr_b16 v[88:89], v144 offset:192
    v_mfma_f32_16x16x32_bf16 v[40:43], v[72:75], v[100:103], v[40:43]
    ds_read_b64_tr_b16 v[90:91], v144 offset:7872
    s_waitcnt lgkmcnt(10)
    v_mfma_f32_16x16x32_bf16 v[12:15], v[76:79], v[96:99], v[12:15]
    ds_read_b64_tr_b16 v[92:93], v144 offset:224
    v_mfma_f32_16x16x32_bf16 v[44:47], v[76:79], v[100:103], v[44:47]
    ds_read_b64_tr_b16 v[94:95], v144 offset:7904
    s_waitcnt vmcnt(0)
    s_barrier
    s_waitcnt lgkmcnt(10)
    v_mfma_f32_16x16x32_bf16 v[16:19], v[80:83], v[96:99], v[16:19]
    s_add_u32 m0, s52, 0
    s_nop 0
    buffer_load_dwordx4 v156, s[8:11], s53 offen lds
    s_add_u32 m0, s52, 8192
    s_nop 0
    buffer_load_dwordx4 v157, s[8:11], s53 offen lds
    s_add_u32 s52, s52, 16384
    s_sub_u32 s55, s52, 98304
    s_cmp_ge_u32 s52, 98304
    s_cselect_b32 s52, s55, s52
    s_mul_i32 s53, s56, 122880
    s_add_u32 s56, s56, 1
    s_cmp_eq_u32 s56, 20
    s_cselect_b32 s56, 0, s56
    s_add_u32 s57, s57, 1
    s_cmp_ge_u32 s57, 20
    s_cselect_b32 s53, 1073741824, s53
    v_mfma_f32_16x16x32_bf16 v[48:51], v[80:83], v[100:103], v[48:51]
    ds_read_b64_tr_b16 v[64:65], v148 offset:0
    ds_read_b64_tr_b16 v[66:67], v148 offset:7680
    ds_read_b128 v[104:107], v149 offset:0
    ds_read_b128 v[108:111], v149 offset:2048
    ds_read_b128 v[116:119], v151
    s_waitcnt lgkmcnt(11)
    v_mfma_f32_16x16x32_bf16 v[20:23], v[84:87], v[96:99], v[20:23]
    s_add_u32 m0, s26, 0
    s_nop 0
    buffer_load_dwordx4 v158, s[4:7], s54 offen lds
    s_add_u32 m0, s26, 8192
    s_nop 0
    buffer_load_dwordx4 v159, s[4:7], s54 offen lds
    s_add_u32 s26, s26, 16384
    s_sub_u32 s55, s26, 49152
    s_cmp_ge_u32 s26, 147456
    s_cselect_b32 s26, s55, s26
    s_lshl_b32 s54, s29, 7
    s_add_u32 s29, s29, 1
    s_cmp_eq_u32 s29, 10
    s_cselect_b32 s29, 0, s29
    v_mfma_f32_16x16x32_bf16 v[52:55], v[84:87], v[100:103], v[52:55]
    s_add_u32 s27, s27, 1
    s_cmp_ge_u32 s27, 10
    s_cselect_b32 s54, 1073741824, s54
    ds_read_b64_tr_b16 v[68:69], v148 offset:32
    ds_read_b64_tr_b16 v[70:71], v148 offset:7712
    s_waitcnt lgkmcnt(9)
    v_mfma_f32_16x16x32_bf16 v[24:27], v[88:91], v[96:99], v[24:27]
    s_add_u32 m0, s52, 0
    s_nop 0
    buffer_load_dwordx4 v156, s[8:11], s53 offen lds
    s_add_u32 m0, s52, 8192
    s_nop 0
    buffer_load_dwordx4 v157, s[8:11], s53 offen lds
    s_add_u32 s52, s52, 16384
    s_sub_u32 s55, s52, 98304
    s_cmp_ge_u32 s52, 98304
    s_cselect_b32 s52, s55, s52
    v_mfma_f32_16x16x32_bf16 v[56:59], v[88:91], v[100:103], v[56:59]
    s_mul_i32 s53, s56, 122880
    s_add_u32 s56, s56, 1
    s_cmp_eq_u32 s56, 20
    s_cselect_b32 s56, 0, s56
    s_add_u32 s57, s57, 1
    s_cmp_ge_u32 s57, 20
    s_cselect_b32 s53, 1073741824, s53
    ds_read_b64_tr_b16 v[72:73], v148 offset:64
    v_mfma_f32_16x16x32_bf16 v[136:139], v[120:123], v[160:163], v[136:139]
    ds_read_b64_tr_b16 v[74:75], v148 offset:7744
    s_waitcnt lgkmcnt(9)
    v_mfma_f32_16x16x32_bf16 v[28:31], v[92:95], v[96:99], v[28:31]
    s_add_u32 m0, s52, 0
    s_nop 0
    buffer_load_dwordx4 v156, s[8:11], s53 offen lds
    s_add_u32 m0, s52, 8192
    s_nop 0
    buffer_load_dwordx4 v157, s[8:11], s53 offen lds
    s_add_u32 s52, s52, 16384
    s_sub_u32 s55, s52, 98304
    s_cmp_ge_u32 s52, 98304
    s_cselect_b32 s52, s55, s52
    v_mfma_f32_16x16x32_bf16 v[60:63], v[92:95], v[100:103], v[60:63]
    s_mul_i32 s53, s56, 122880
    s_add_u32 s56, s56, 1
    s_cmp_eq_u32 s56, 20
    s_cselect_b32 s56, 0, s56
    s_add_u32 s57, s57, 1
    s_cmp_ge_u32 s57, 20
    s_cselect_b32 s53, 1073741824, s53
    ds_read_b64_tr_b16 v[76:77], v148 offset:96
    v_mfma_f32_16x16x32_bf16 v[140:143], v[124:127], v[160:163], v[140:143]
    ds_read_b64_tr_b16 v[78:79], v148 offset:7776
    s_add_u32 s47, s47, 16384
    s_cmp_eq_u32 s47, 49152
    s_cselect_b32 s47, 0, s47
    v_add_u32 v144, s51, v152
    v_add_u32 v146, s51, v154
    v_add_u32 v145, s47, v153
    v_add_u32 v147, s47, v155
    s_add_u32 s51, s51, 16384
    s_cmp_eq_u32 s51, 98304
    s_cselect_b32 s51, 0, s51
    s_waitcnt lgkmcnt(9)
    s_waitcnt lgkmcnt(7)
    v_mfma_f32_16x16x32_bf16 v[0:3], v[64:67], v[104:107], v[0:3]
    ds_read_b64_tr_b16 v[80:81], v148 offset:128
    ds_read_b64_tr_b16 v[82:83], v148 offset:7808
    v_mfma_f32_16x16x32_bf16 v[32:35], v[64:67], v[108:111], v[32:35]
    ds_read_b64_tr_b16 v[120:121], v150 offset:0
    ds_read_b64_tr_b16 v[122:123], v150 offset:7680
    s_waitcnt lgkmcnt(10)
    v_mfma_f32_16x16x32_bf16 v[128:131], v[160:163], v[116:119], v[128:131]
    s_waitcnt lgkmcnt(8)
    v_mfma_f32_16x16x32_bf16 v[4:7], v[68:71], v[104:107], v[4:7]
    ds_read_b64_tr_b16 v[84:85], v148 offset:160
    ds_read_b64_tr_b16 v[86:87], v148 offset:7840
    v_mfma_f32_16x16x32_bf16 v[36:39], v[68:71], v[108:111], v[36:39]
    ds_read_b64_tr_b16 v[124:125], v150 offset:32
    ds_read_b64_tr_b16 v[126:127], v150 offset:7712
    v_mfma_f32_16x16x32_bf16 v[132:135], v[116:119], v[116:119], v[132:135]
    s_waitcnt lgkmcnt(10)
    v_mfma_f32_16x16x32_bf16 v[8:11], v[72:75], v[104:107], v[8:11]
    ds_read_b64_tr_b16 v[88:89], v148 offset:192
    v_mfma_f32_16x16x32_bf16 v[40:43], v[72:75], v[108:111], v[40:43]
    ds_read_b64_tr_b16 v[90:91], v148 offset:7872
    s_waitcnt lgkmcnt(10)
    v_mfma_f32_16x16x32_bf16 v[12:15], v[76:79], v[104:107], v[12:15]
    ds_read_b64_tr_b16 v[92:93], v148 offset:224
    v_mfma_f32_16x16x32_bf16 v[44:47], v[76:79], v[108:111], v[44:47]
    ds_read_b64_tr_b16 v[94:95], v148 offset:7904
    s_waitcnt vmcnt(4)
    s_barrier
    s_waitcnt lgkmcnt(10)
    v_mfma_f32_16x16x32_bf16 v[16:19], v[80:83], v[104:107], v[16:19]
    s_add_u32 m0, s52, 0
    s_nop 0
    buffer_load_dwordx4 v156, s[8:11], s53 offen lds
    s_add_u32 m0, s52, 8192
    s_nop 0
    buffer_load_dwordx4 v157, s[8:11], s53 offen lds
    s_add_u32 s52, s52, 16384
    s_sub_u32 s55, s52, 98304
    s_cmp_ge_u32 s52, 98304
    s_cselect_b32 s52, s55, s52
    s_mul_i32 s53, s56, 122880
    s_add_u32 s56, s56, 1
    s_cmp_eq_u32 s56, 20
    s_cselect_b32 s56, 0, s56
    ds_read_b64_tr_b16 v[64:65], v144 offset:0
    v_mfma_f32_16x16x32_bf16 v[48:51], v[80:83], v[108:111], v[48:51]
    ds_read_b64_tr_b16 v[66:67], v144 offset:7680
    ds_read_b128 v[96:99], v145 offset:0
    ds_read_b128 v[100:103], v145 offset:2048
    ds_read_b128 v[112:115], v147
    s_waitcnt lgkmcnt(11)
    v_mfma_f32_16x16x32_bf16 v[20:23], v[84:87], v[104:107], v[20:23]
    s_add_u32 s57, s57, 1
    s_cmp_ge_u32 s57, 20
    s_cselect_b32 s53, 1073741824, s53
    s_add_u32 m0, s26, 0
    s_nop 0
    buffer_load_dwordx4 v158, s[4:7], s54 offen lds
    s_add_u32 m0, s26, 8192
    s_nop 0
    buffer_load_dwordx4 v159, s[4:7], s54 offen lds
    v_mfma_f32_16x16x32_bf16 v[52:55], v[84:87], v[108:111], v[52:55]
    s_add_u32 s26, s26, 16384
    s_sub_u32 s55, s26, 49152
    s_cmp_ge_u32 s26, 147456
    s_cselect_b32 s26, s55, s26
    ds_read_b64_tr_b16 v[68:69], v144 offset:32
    ds_read_b64_tr_b16 v[70:71], v144 offset:7712
    s_waitcnt lgkmcnt(9)
    v_mfma_f32_16x16x32_bf16 v[24:27], v[88:91], v[104:107], v[24:27]
    s_lshl_b32 s54, s29, 7
    s_add_u32 s29, s29, 1
    s_cmp_eq_u32 s29, 10
    s_cselect_b32 s29, 0, s29
    s_add_u32 s27, s27, 1
    s_cmp_ge_u32 s27, 10
    s_cselect_b32 s54, 1073741824, s54
    v_mfma_f32_16x16x32_bf16 v[56:59], v[88:91], v[108:111], v[56:59]
    s_add_u32 m0, s52, 0
    s_nop 0
    buffer_load_dwordx4 v156, s[8:11], s53 offen lds
    s_add_u32 m0, s52, 8192
    s_nop 0
    buffer_load_dwordx4 v157, s[8:11], s53 offen lds
    v_mfma_f32_16x16x32_bf16 v[136:139], v[120:123], v[160:163], v[136:139]
    ds_read_b64_tr_b16 v[72:73], v144 offset:64
    ds_read_b64_tr_b16 v[74:75], v144 offset:7744
    s_waitcnt lgkmcnt(9)
    v_mfma_f32_16x16x32_bf16 v[28:31], v[92:95], v[104:107], v[28:31]
    s_add_u32 s52, s52, 16384
    s_sub_u32 s55, s52, 98304
    s_cmp_ge_u32 s52, 98304
    s_cselect_b32 s52, s55, s52
    s_mul_i32 s53, s56, 122880
    s_add_u32 s56, s56, 1
    s_cmp_eq_u32 s56, 20
    s_cselect_b32 s56, 0, s56
    v_mfma_f32_16x16x32_bf16 v[60:63], v[92:95], v[108:111], v[60:63]
    s_add_u32 s57, s57, 1
    s_cmp_ge_u32 s57, 20
    s_cselect_b32 s53, 1073741824, s53
    ds_read_b64_tr_b16 v[76:77], v144 offset:96
    v_mfma_f32_16x16x32_bf16 v[140:143], v[124:127], v[160:163], v[140:143]
    ds_read_b64_tr_b16 v[78:79], v144 offset:7776
    v_add_u32 v148, s51, v152
    v_add_u32 v150, s51, v154
    v_add_u32 v149, s47, v164
    v_add_u32 v151, s47, v165
    s_add_u32 s51, s51, 16384
    s_cmp_eq_u32 s51, 98304
    s_cselect_b32 s51, 0, s51
    s_waitcnt lgkmcnt(9)
    s_waitcnt lgkmcnt(7)
    v_mfma_f32_16x16x32_bf16 v[0:3], v[64:67], v[96:99], v[0:3]
    ds_read_b64_tr_b16 v[80:81], v144 offset:128
    ds_read_b64_tr_b16 v[82:83], v144 offset:7808
    v_mfma_f32_16x16x32_bf16 v[32:35], v[64:67], v[100:103], v[32:35]
    ds_read_b64_tr_b16 v[120:121], v146 offset:0
    ds_read_b64_tr_b16 v[122:123], v146 offset:7680
    s_waitcnt lgkmcnt(10)
    v_mfma_f32_16x16x32_bf16 v[128:131], v[160:163], v[112:115], v[128:131]
    s_waitcnt lgkmcnt(8)
    v_mfma_f32_16x16x32_bf16 v[4:7], v[68:71], v[96:99], v[4:7]
    ds_read_b64_tr_b16 v[84:85], v144 offset:160
    ds_read_b64_tr_b16 v[86:87], v144 offset:7840
    v_mfma_f32_16x16x32_bf16 v[36:39], v[68:71], v[100:103], v[36:39]
    ds_read_b64_tr_b16 v[124:125], v146 offset:32
    ds_read_b64_tr_b16 v[126:127], v146 offset:7712
    v_mfma_f32_16x16x32_bf16 v[132:135], v[112:115], v[112:115], v[132:135]
    s_waitcnt lgkmcnt(10)
    v_mfma_f32_16x16x32_bf16 v[8:11], v[72:75], v[96:99], v[8:11]
    ds_read_b64_tr_b16 v[88:89], v144 offset:192
    v_mfma_f32_16x16x32_bf16 v[40:43], v[72:75], v[100:103], v[40:43]
    ds_read_b64_tr_b16 v[90:91], v144 offset:7872
    s_waitcnt lgkmcnt(10)
    v_mfma_f32_16x16x32_bf16 v[12:15], v[76:79], v[96:99], v[12:15]
    ds_read_b64_tr_b16 v[92:93], v144 offset:224
    v_mfma_f32_16x16x32_bf16 v[44:47], v[76:79], v[100:103], v[44:47]
    ds_read_b64_tr_b16 v[94:95], v144 offset:7904
    s_waitcnt vmcnt(8)
    s_barrier
    s_waitcnt lgkmcnt(10)
    v_mfma_f32_16x16x32_bf16 v[16:19], v[80:83], v[96:99], v[16:19]
    s_add_u32 m0, s52, 0
    s_nop 0
    buffer_load_dwordx4 v156, s[8:11], s53 offen lds
    s_add_u32 m0, s52, 8192
    s_nop 0
    buffer_load_dwordx4 v157, s[8:11], s53 offen lds
    s_add_u32 s52, s52, 16384
    s_sub_u32 s55, s52, 98304
    s_cmp_ge_u32 s52, 98304
    s_cselect_b32 s52, s55, s52
    ds_read_b64_tr_b16 v[64:65], v148 offset:0
    v_mfma_f32_16x16x32_bf16 v[48:51], v[80:83], v[100:103], v[48:51]
    ds_read_b64_tr_b16 v[66:67], v148 offset:7680
    ds_read_b128 v[104:107], v149 offset:0
    ds_read_b128 v[108:111], v149 offset:2048
    ds_read_b128 v[116:119], v151
    s_waitcnt lgkmcnt(11)
    v_mfma_f32_16x16x32_bf16 v[20:23], v[84:87], v[96:99], v[20:23]
    s_mul_i32 s53, s56, 122880
    s_add_u32 s56, s56, 1
    s_cmp_eq_u32 s56, 20
    s_cselect_b32 s56, 0, s56
    s_add_u32 s57, s57, 1
    s_cmp_ge_u32 s57, 20
    s_cselect_b32 s53, 1073741824, s53
    s_add_u32 m0, s26, 0
    s_nop 0
    buffer_load_dwordx4 v158, s[4:7], s54 offen lds
    v_mfma_f32_16x16x32_bf16 v[52:55], v[84:87], v[100:103], v[52:55]
    ds_read_b64_tr_b16 v[68:69], v148 offset:32
    ds_read_b64_tr_b16 v[70:71], v148 offset:7712
    s_waitcnt lgkmcnt(9)
    v_mfma_f32_16x16x32_bf16 v[24:27], v[88:91], v[96:99], v[24:27]
    s_add_u32 m0, s26, 8192
    s_nop 0
    buffer_load_dwordx4 v159, s[4:7], s54 offen lds
    s_add_u32 s26, s26, 16384
    s_sub_u32 s55, s26, 49152
    s_cmp_ge_u32 s26, 147456
    s_cselect_b32 s26, s55, s26
    v_mfma_f32_16x16x32_bf16 v[56:59], v[88:91], v[100:103], v[56:59]
    ds_read_b64_tr_b16 v[72:73], v148 offset:64
    ds_read_b64_tr_b16 v[74:75], v148 offset:7744
    v_mfma_f32_16x16x32_bf16 v[136:139], v[120:123], v[160:163], v[136:139]
    s_waitcnt lgkmcnt(9)
    v_mfma_f32_16x16x32_bf16 v[28:31], v[92:95], v[96:99], v[28:31]
    s_lshl_b32 s54, s29, 7
    s_add_u32 s29, s29, 1
    s_cmp_eq_u32 s29, 10
    s_cselect_b32 s29, 0, s29
    s_add_u32 s27, s27, 1
    s_cmp_ge_u32 s27, 10
    s_cselect_b32 s54, 1073741824, s54
    v_mfma_f32_16x16x32_bf16 v[60:63], v[92:95], v[100:103], v[60:63]
    ds_read_b64_tr_b16 v[76:77], v148 offset:96
    ds_read_b64_tr_b16 v[78:79], v148 offset:7776
    v_mfma_f32_16x16x32_bf16 v[140:143], v[124:127], v[160:163], v[140:143]
    s_add_u32 s47, s47, 16384
    s_cmp_eq_u32 s47, 49152
    s_cselect_b32 s47, 0, s47
    v_add_u32 v144, s51, v152
    v_add_u32 v146, s51, v154
    v_add_u32 v145, s47, v153
    v_add_u32 v147, s47, v155
    s_add_u32 s51, s51, 16384
    s_cmp_eq_u32 s51, 98304
    s_cselect_b32 s51, 0, s51
    s_waitcnt lgkmcnt(9)
    s_waitcnt lgkmcnt(7)
    v_mfma_f32_16x16x32_bf16 v[0:3], v[64:67], v[104:107], v[0:3]
    ds_read_b64_tr_b16 v[80:81], v148 offset:128
    ds_read_b64_tr_b16 v[82:83], v148 offset:7808
    v_mfma_f32_16x16x32_bf16 v[32:35], v[64:67], v[108:111], v[32:35]
    ds_read_b64_tr_b16 v[120:121], v150 offset:0
    ds_read_b64_tr_b16 v[122:123], v150 offset:7680
    s_waitcnt lgkmcnt(10)
    v_mfma_f32_16x16x32_bf16 v[128:131], v[160:163], v[116:119], v[128:131]
    s_waitcnt lgkmcnt(8)
    v_mfma_f32_16x16x32_bf16 v[4:7], v[68:71], v[104:107], v[4:7]
    ds_read_b64_tr_b16 v[84:85], v148 offset:160
    ds_read_b64_tr_b16 v[86:87], v148 offset:7840
    v_mfma_f32_16x16x32_bf16 v[36:39], v[68:71], v[108:111], v[36:39]
    ds_read_b64_tr_b16 v[124:125], v150 offset:32
    ds_read_b64_tr_b16 v[126:127], v150 offset:7712
    v_mfma_f32_16x16x32_bf16 v[132:135], v[116:119], v[116:119], v[132:135]
    s_waitcnt lgkmcnt(10)
    v_mfma_f32_16x16x32_bf16 v[8:11], v[72:75], v[104:107], v[8:11]
    ds_read_b64_tr_b16 v[88:89], v148 offset:192
    v_mfma_f32_16x16x32_bf16 v[40:43], v[72:75], v[108:111], v[40:43]
    ds_read_b64_tr_b16 v[90:91], v148 offset:7872
    s_waitcnt lgkmcnt(10)
    v_mfma_f32_16x16x32_bf16 v[12:15], v[76:79], v[104:107], v[12:15]
    ds_read_b64_tr_b16 v[92:93], v148 offset:224
    v_mfma_f32_16x16x32_bf16 v[44:47], v[76:79], v[108:111], v[44:47]
    ds_read_b64_tr_b16 v[94:95], v148 offset:7904
    s_waitcnt vmcnt(6)
    s_barrier
    s_waitcnt lgkmcnt(10)
    v_mfma_f32_16x16x32_bf16 v[16:19], v[80:83], v[104:107], v[16:19]
    s_add_u32 m0, s52, 0
    s_nop 0
    buffer_load_dwordx4 v156, s[8:11], s53 offen lds
    s_add_u32 m0, s52, 8192
    s_nop 0
    buffer_load_dwordx4 v157, s[8:11], s53 offen lds
    ds_read_b64_tr_b16 v[64:65], v144 offset:0
    ds_read_b64_tr_b16 v[66:67], v144 offset:7680
    v_mfma_f32_16x16x32_bf16 v[48:51], v[80:83], v[108:111], v[48:51]
    ds_read_b128 v[96:99], v145 offset:0
    ds_read_b128 v[100:103], v145 offset:2048
    ds_read_b128 v[112:115], v147
    s_waitcnt lgkmcnt(11)
    v_mfma_f32_16x16x32_bf16 v[20:23], v[84:87], v[104:107], v[20:23]
    s_add_u32 s52, s52, 16384
    s_sub_u32 s55, s52, 98304
    s_cmp_ge_u32 s52, 98304
    s_cselect_b32 s52, s55, s52
    ds_read_b64_tr_b16 v[68:69], v144 offset:32
    v_mfma_f32_16x16x32_bf16 v[52:55], v[84:87], v[108:111], v[52:55]
    ds_read_b64_tr_b16 v[70:71], v144 offset:7712
    s_waitcnt lgkmcnt(9)
    v_mfma_f32_16x16x32_bf16 v[24:27], v[88:91], v[104:107], v[24:27]
    s_mul_i32 s53, s56, 122880
    s_add_u32 s56, s56, 1
    s_cmp_eq_u32 s56, 20
    s_cselect_b32 s56, 0, s56
    v_mfma_f32_16x16x32_bf16 v[56:59], v[88:91], v[108:111], v[56:59]
    ds_read_b64_tr_b16 v[72:73], v144 offset:64
    v_mfma_f32_16x16x32_bf16 v[136:139], v[120:123], v[160:163], v[136:139]
    ds_read_b64_tr_b16 v[74:75], v144 offset:7744
    s_waitcnt lgkmcnt(9)
    v_mfma_f32_16x16x32_bf16 v[28:31], v[92:95], v[104:107], v[28:31]
    s_add_u32 s57, s57, 1
    s_cmp_ge_u32 s57, 20
    s_cselect_b32 s53, 1073741824, s53
    v_mfma_f32_16x16x32_bf16 v[60:63], v[92:95], v[108:111], v[60:63]
    ds_read_b64_tr_b16 v[76:77], v144 offset:96
    v_mfma_f32_16x16x32_bf16 v[140:143], v[124:127], v[160:163], v[140:143]
    ds_read_b64_tr_b16 v[78:79], v144 offset:7776
K1_loop_q:
    v_add_u32 v148, s51, v152
    v_add_u32 v150, s51, v154
    v_add_u32 v149, s47, v164
    v_add_u32 v151, s47, v165
    s_add_u32 s51, s51, 16384
    s_cmp_eq_u32 s51, 98304
    s_cselect_b32 s51, 0, s51
    s_waitcnt lgkmcnt(9)
    s_waitcnt lgkmcnt(7)
    v_mfma_f32_16x16x32_bf16 v[0:3], v[64:67], v[96:99], v[0:3]
    ds_read_b64_tr_b16 v[80:81], v144 offset:128
    ds_read_b64_tr_b16 v[82:83], v144 offset:7808
    v_mfma_f32_16x16x32_bf16 v[32:35], v[64:67], v[100:103], v[32:35]
    ds_read_b64_tr_b16 v[120:121], v146 offset:0
    ds_read_b64_tr_b16 v[122:123], v146 offset:7680
    s_waitcnt lgkmcnt(10)
    v_mfma_f32_16x16x32_bf16 v[128:131], v[160:163], v[112:115], v[128:131]
    s_waitcnt lgkmcnt(8)
    v_mfma_f32_16x16x32_bf16 v[4:7], v[68:71], v[96:99], v[4:7]
    ds_read_b64_tr_b16 v[84:85], v144 offset:160
    ds_read_b64_tr_b16 v[86:87], v144 offset:7840
    v_mfma_f32_16x16x32_bf16 v[36:39], v[68:71], v[100:103], v[36:39]
    ds_read_b64_tr_b16 v[124:125], v146 offset:32
    ds_read_b64_tr_b16 v[126:127], v146 offset:7712
    v_mfma_f32_16x16x32_bf16 v[132:135], v[112:115], v[112:115], v[132:135]
    s_waitcnt lgkmcnt(10)
    v_mfma_f32_16x16x32_bf16 v[8:11], v[72:75], v[96:99], v[8:11]
    ds_read_b64_tr_b16 v[88:89], v144 offset:192
    v_mfma_f32_16x16x32_bf16 v[40:43], v[72:75], v[100:103], v[40:43]
    ds_read_b64_tr_b16 v[90:91], v144 offset:7872
    s_waitcnt lgkmcnt(10)
    v_mfma_f32_16x16x32_bf16 v[12:15], v[76:79], v[96:99], v[12:15]
    ds_read_b64_tr_b16 v[92:93], v144 offset:224
    v_mfma_f32_16x16x32_bf16 v[44:47], v[76:79], v[100:103], v[44:47]
    ds_read_b64_tr_b16 v[94:95], v144 offset:7904
    s_waitcnt vmcnt(10)
    s_barrier
    s_waitcnt lgkmcnt(10)
    v_mfma_f32_16x16x32_bf16 v[16:19], v[80:83], v[96:99], v[16:19]
    s_add_u32 m0, s52, 0
    s_nop 0
    buffer_load_dwordx4 v156, s[8:11], s53 offen lds
    s_add_u32 m0, s52, 8192
    s_nop 0
    buffer_load_dwordx4 v157, s[8:11], s53 offen lds
    s_add_u32 s52, s52, 16384
    s_sub_u32 s55, s52, 98304
    s_cmp_ge_u32 s52, 98304
    s_cselect_b32 s52, s55, s52
    ds_read_b64_tr_b16 v[64:65], v148 offset:0
    v_mfma_f32_16x16x32_bf16 v[48:51], v[80:83], v[100:103], v[48:51]
    ds_read_b64_tr_b16 v[66:67], v148 offset:7680
    ds_read_b128 v[104:107], v149 offset:0
    ds_read_b128 v[108:111], v149 offset:2048
    ds_read_b128 v[116:119], v151
    s_waitcnt lgkmcnt(11)
    v_mfma_f32_16x16x32_bf16 v[20:23], v[84:87], v[96:99], v[20:23]
    s_mul_i32 s53, s56, 122880
    s_add_u32 s56, s56, 1
    s_cmp_eq_u32 s56, 20
    s_cselect_b32 s56, 0, s56
    s_add_u32 s57, s57, 1
    s_cmp_ge_u32 s57, 20
    s_cselect_b32 s53, 1073741824, s53
    s_add_u32 m0, s26, 0
    s_nop 0
    buffer_load_dwordx4 v158, s[4:7], s54 offen lds
    v_mfma_f32_16x16x32_bf16 v[52:55], v[84:87], v[100:103], v[52:55]
    ds_read_b64_tr_b16 v[68:69], v148 offset:32
    ds_read_b64_tr_b16 v[70:71], v148 offset:7712
    s_waitcnt lgkmcnt(9)
    v_mfma_f32_16x16x32_bf16 v[24:27], v[88:91], v[96:99], v[24:27]
    s_add_u32 m0, s26, 8192
    s_nop 0
    buffer_load_dwordx4 v159, s[4:7], s54 offen lds
    s_add_u32 s26, s26, 16384
    s_sub_u32 s55, s26, 49152
    s_cmp_ge_u32 s26, 147456
    s_cselect_b32 s26, s55, s26
    v_mfma_f32_16x16x32_bf16 v[56:59], v[88:91], v[100:103], v[56:59]
    ds_read_b64_tr_b16 v[72:73], v148 offset:64
    ds_read_b64_tr_b16 v[74:75], v148 offset:7744
    v_mfma_f32_16x16x32_bf16 v[136:139], v[120:123], v[160:163], v[136:139]
    s_waitcnt lgkmcnt(9)
    v_mfma_f32_16x16x32_bf16 v[28:31], v[92:95], v[96:99], v[28:31]
    s_lshl_b32 s54, s29, 7
    s_add_u32 s29, s29, 1
    s_cmp_eq_u32 s29, 10
    s_cselect_b32 s29, 0, s29
    s_add_u32 s27, s27, 1
    s_cmp_ge_u32 s27, 10
    s_cselect_b32 s54, 1073741824, s54
    v_mfma_f32_16x16x32_bf16 v[60:63], v[92:95], v[100:103], v[60:63]
    ds_read_b64_tr_b16 v[76:77], v148 offset:96
    ds_read_b64_tr_b16 v[78:79], v148 offset:7776
    v_mfma_f32_16x16x32_bf16 v[140:143], v[124:127], v[160:163], v[140:143]
    s_add_u32 s47, s47, 16384
    s_cmp_eq_u32 s47, 49152
    s_cselect_b32 s47, 0, s47
    v_add_u32 v144, s51, v152
    v_add_u32 v146, s51, v154
    v_add_u32 v145, s47, v153
    v_add_u32 v147, s47, v155
    s_add_u32 s51, s51, 16384
    s_cmp_eq_u32 s51, 98304
    s_cselect_b32 s51, 0, s51
    s_waitcnt lgkmcnt(9)
    s_waitcnt lgkmcnt(7)
    v_mfma_f32_16x16x32_bf16 v[0:3], v[64:67], v[104:107], v[0:3]
    ds_read_b64_tr_b16 v[80:81], v148 offset:128
    ds_read_b64_tr_b16 v[82:83], v148 offset:7808
    v_mfma_f32_16x16x32_bf16 v[32:35], v[64:67], v[108:111], v[32:35]
    ds_read_b64_tr_b16 v[120:121], v150 offset:0
    ds_read_b64_tr_b16 v[122:123], v150 offset:7680
    s_waitcnt lgkmcnt(10)
    v_mfma_f32_16x16x32_bf16 v[128:131], v[160:163], v[116:119], v[128:131]
    s_waitcnt lgkmcnt(8)
    v_mfma_f32_16x16x32_bf16 v[4:7], v[68:71], v[104:107], v[4:7]
    ds_read_b64_tr_b16 v[84:85], v148 offset:160
    ds_read_b64_tr_b16 v[86:87], v148 offset:7840
    v_mfma_f32_16x16x32_bf16 v[36:39], v[68:71], v[108:111], v[36:39]
    ds_read_b64_tr_b16 v[124:125], v150 offset:32
    ds_read_b64_tr_b16 v[126:127], v150 offset:7712
    v_mfma_f32_16x16x32_bf16 v[132:135], v[116:119], v[116:119], v[132:135]
    s_waitcnt lgkmcnt(10)
    v_mfma_f32_16x16x32_bf16 v[8:11], v[72:75], v[104:107], v[8:11]
    ds_read_b64_tr_b16 v[88:89], v148 offset:192
    v_mfma_f32_16x16x32_bf16 v[40:43], v[72:75], v[108:111], v[40:43]
    ds_read_b64_tr_b16 v[90:91], v148 offset:7872
    s_waitcnt lgkmcnt(10)
    v_mfma_f32_16x16x32_bf16 v[12:15], v[76:79], v[104:107], v[12:15]
    ds_read_b64_tr_b16 v[92:93], v148 offset:224
    v_mfma_f32_16x16x32_bf16 v[44:47], v[76:79], v[108:111], v[44:47]
    ds_read_b64_tr_b16 v[94:95], v148 offset:7904
    s_waitcnt vmcnt(6)
    s_barrier
    s_waitcnt lgkmcnt(10)
    v_mfma_f32_16x16x32_bf16 v[16:19], v[80:83], v[104:107], v[16:19]
    s_add_u32 m0, s52, 0
    s_nop 0
    buffer_load_dwordx4 v156, s[8:11], s53 offen lds
    s_add_u32 m0, s52, 8192
    s_nop 0
    buffer_load_dwordx4 v157, s[8:11], s53 offen lds
    ds_read_b64_tr_b16 v[64:65], v144 offset:0
    ds_read_b64_tr_b16 v[66:67], v144 offset:7680
    v_mfma_f32_16x16x32_bf16 v[48:51], v[80:83], v[108:111], v[48:51]
    ds_read_b128 v[96:99], v145 offset:0
    ds_read_b128 v[100:103], v145 offset:2048
    ds_read_b128 v[112:115], v147
    s_waitcnt lgkmcnt(11)
    v_mfma_f32_16x16x32_bf16 v[20:23], v[84:87], v[104:107], v[20:23]
    s_add_u32 s52, s52, 16384
    s_sub_u32 s55, s52, 98304
    s_cmp_ge_u32 s52, 98304
    s_cselect_b32 s52, s55, s52
    ds_read_b64_tr_b16 v[68:69], v144 offset:32
    v_mfma_f32_16x16x32_bf16 v[52:55], v[84:87], v[108:111], v[52:55]
    ds_read_b64_tr_b16 v[70:71], v144 offset:7712
    s_waitcnt lgkmcnt(9)
    v_mfma_f32_16x16x32_bf16 v[24:27], v[88:91], v[104:107], v[24:27]
    s_mul_i32 s53, s56, 122880
    s_add_u32 s56, s56, 1
    s_cmp_eq_u32 s56, 20
    s_cselect_b32 s56, 0, s56
    v_mfma_f32_16x16x32_bf16 v[56:59], v[88:91], v[108:111], v[56:59]
    ds_read_b64_tr_b16 v[72:73], v144 offset:64
    v_mfma_f32_16x16x32_bf16 v[136:139], v[120:123], v[160:163], v[136:139]
    ds_read_b64_tr_b16 v[74:75], v144 offset:7744
    s_waitcnt lgkmcnt(9)
    v_mfma_f32_16x16x32_bf16 v[28:31], v[92:95], v[104:107], v[28:31]
    s_add_u32 s57, s57, 1
    s_cmp_ge_u32 s57, 20
    s_cselect_b32 s53, 1073741824, s53
    v_mfma_f32_16x16x32_bf16 v[60:63], v[92:95], v[108:111], v[60:63]
    ds_read_b64_tr_b16 v[76:77], v144 offset:96
    v_mfma_f32_16x16x32_bf16 v[140:143], v[124:127], v[160:163], v[140:143]
    ds_read_b64_tr_b16 v[78:79], v144 offset:7776
    s_add_u32 s50, s50, 2
    s_cmp_lt_u32 s50, 20
    s_cbranch_scc1 K1_loop_q
    s_waitcnt lgkmcnt(0)
    s_nop 7
    s_nop 7
    s_lshl_b32 s30, s25, 9
    s_lshl_b32 s31, s24, 7
    s_add_u32 s30, s30, s31
    s_add_u32 s30, s30, 155648
    v_lshl_add_u32 v188, v173, 4, s30
    v_and_b32 v189, 3, v172
    v_cmp_eq_u32 vcc, 1, v189
    s_nop 1
    v_cndmask_b32 v129, v132, v133, vcc
    v_cmp_eq_u32 vcc, 2, v189
    s_nop 1
    v_cndmask_b32 v129, v129, v134, vcc
    v_cmp_eq_u32 vcc, 3, v189
    s_nop 1
    v_cndmask_b32 v129, v129, v135, vcc
    ds_write_b128 v188, v[136:139]
    ds_write_b128 v188, v[140:143] offset:64
    s_lshl_b32 s30, s25, 7
    s_add_u32 s30, s30, 156672
    v_lshl_add_u32 v188, v174, 3, s30
    v_lshrrev_b32 v189, 2, v172
    v_lshlrev_b32 v190, 3, v171
    v_add_u32 v190, 157696, v190
    v_cmp_eq_u32 vcc, v189, v173
    s_nop 1
    v_cndmask_b32 v188, v190, v188, vcc
    ds_write_b64 v188, v[128:129]
    s_waitcnt vmcnt(0) lgkmcnt(0)
    s_barrier
    v_lshlrev_b32 v188, 3, v174
    v_add_u32 v188, 156672, v188
    ds_read_b64 v[128:129], v188
    ds_read_b64 v[130:131], v188 offset:128
    s_lshl_b32 s30, s25, 9
    s_add_u32 s30, s30, 155648
    v_lshl_add_u32 v188, v173, 4, s30
    ds_read_b128 v[64:67], v188 offset:0
    ds_read_b128 v[68:71], v188 offset:64
    ds_read_b128 v[72:75], v188 offset:128
    ds_read_b128 v[76:79], v188 offset:192
    ds_read_b128 v[80:83], v188 offset:256
    ds_read_b128 v[84:87], v188 offset:320
    ds_read_b128 v[88:91], v188 offset:384
    ds_read_b128 v[92:95], v188 offset:448
    s_mov_b32 s8, s60
    s_and_b32 s9, s61, 0xffff
    s_mov_b32 s10, 2211840
    s_mov_b32 s11, 0x20000
    s_mov_b32 s4, s58
    s_and_b32 s5, s59, 0xffff
    s_mov_b32 s6, 819200
    s_mov_b32 s7, 0x20000
    s_lshl_b32 s30, s2, 3
    s_add_u32 s30, s30, s23
    s_mul_i32 s31, s30, 9
    v_add_u32 v228, s31, v171
    v_lshlrev_b32 v228, 7, v228
    v_cmp_gt_u32 vcc, 9, v171
    s_nop 1
    v_cndmask_b32 v228, v209, v228, vcc
    v_lshl_add_u32 v229, s30, 2, v171
    v_lshlrev_b32 v229, 7, v229
    v_cmp_gt_u32 vcc, 4, v171
    s_nop 1
    v_cndmask_b32 v229, v209, v229, vcc
    buffer_load_dword v255, v228, s[8:11], 0 offen
    buffer_load_dword v255, v229, s[4:7], 0 offen
    s_mov_b32 s96, s62
    s_and_b32 s97, s63, 0xffff
    s_mov_b32 s98, 256
    s_mov_b32 s99, 0x20000
    v_mov_b32 v228, 0
    buffer_load_dword v254, v228, s[96:99], 0 offen sc1
    s_mov_b32 s30, 0x3acccccd
    s_mov_b32 s31, 0x3727c5ac
    s_mov_b32 s34, 0x3fb8aa3b
    s_mov_b32 s35, 0xbfb8aa3b
    s_waitcnt lgkmcnt(8)
    v_mul_f32 v128, s30, v128
    v_mul_f32 v129, s30, v129
    v_fma_f32 v129, -v128, v128, v129
    v_max_f32 v129, 0, v129
    v_cvt_pk_bf16_f32 v192, v128, v128
    v_lshlrev_b32 v192, 16, v192
    v_cvt_pk_bf16_f32 v193, v129, v129
    v_lshlrev_b32 v193, 16, v193
    v_add_f32 v193, s31, v193
    v_cvt_pk_bf16_f32 v193, v193, v193
    v_lshlrev_b32 v193, 16, v193
    v_sqrt_f32 v193, v193
    s_nop 0
    v_cvt_pk_bf16_f32 v193, v193, v193
    v_lshlrev_b32 v193, 16, v193
    v_rcp_f32 v96, v193
    s_nop 0
    v_mul_f32 v100, v192, v96
    v_mov_b32 v97, v96
    v_sub_f32 v100, 0, v100
    v_mov_b32 v101, v100
    v_mul_f32 v130, s30, v130
    v_mul_f32 v131, s30, v131
    v_fma_f32 v131, -v130, v130, v131
    v_max_f32 v131, 0, v131
    v_cvt_pk_bf16_f32 v196, v130, v130
    v_lshlrev_b32 v196, 16, v196
    v_cvt_pk_bf16_f32 v197, v131, v131
    v_lshlrev_b32 v197, 16, v197
    v_add_f32 v197, s31, v197
    v_cvt_pk_bf16_f32 v197, v197, v197
    v_lshlrev_b32 v197, 16, v197
    v_sqrt_f32 v197, v197
    s_nop 0
    v_cvt_pk_bf16_f32 v197, v197, v197
    v_lshlrev_b32 v197, 16, v197
    v_rcp_f32 v98, v197
    s_nop 0
    v_mul_f32 v102, v196, v98
    v_mov_b32 v99, v98
    v_sub_f32 v102, 0, v102
    v_mov_b32 v103, v102
    s_lshl_b32 s30, s20, 7
    v_add_u32 v189, s30, v174
    s_waitcnt lgkmcnt(0)
    v_pk_mul_f32 v[202:203], v[64:65], v[100:101]
    v_pk_fma_f32 v[202:203], v[0:1], v[96:97], v[202:203]
    v_cvt_pk_bf16_f32 v112, v202, v203
    v_pk_mul_f32 v[204:205], v[66:67], v[100:101]
    v_pk_fma_f32 v[204:205], v[2:3], v[96:97], v[204:205]
    v_cvt_pk_bf16_f32 v113, v204, v205
    v_pk_mul_f32 v[206:207], v[68:69], v[100:101]
    v_pk_fma_f32 v[206:207], v[4:5], v[96:97], v[206:207]
    v_cvt_pk_bf16_f32 v114, v206, v207
    v_pk_mul_f32 v[208:209], v[70:71], v[100:101]
    v_pk_fma_f32 v[208:209], v[6:7], v[96:97], v[208:209]
    v_cvt_pk_bf16_f32 v115, v208, v209
    v_pk_mul_f32 v[202:203], v[72:73], v[100:101]
    v_pk_fma_f32 v[202:203], v[8:9], v[96:97], v[202:203]
    v_cvt_pk_bf16_f32 v116, v202, v203
    v_pk_mul_f32 v[204:205], v[74:75], v[100:101]
    v_pk_fma_f32 v[204:205], v[10:11], v[96:97], v[204:205]
    v_cvt_pk_bf16_f32 v117, v204, v205
    v_pk_mul_f32 v[206:207], v[76:77], v[100:101]
    v_pk_fma_f32 v[206:207], v[12:13], v[96:97], v[206:207]
    v_cvt_pk_bf16_f32 v118, v206, v207
    v_pk_mul_f32 v[208:209], v[78:79], v[100:101]
    v_pk_fma_f32 v[208:209], v[14:15], v[96:97], v[208:209]
    v_cvt_pk_bf16_f32 v119, v208, v209
    v_pk_mul_f32 v[202:203], v[80:81], v[100:101]
    v_pk_fma_f32 v[202:203], v[16:17], v[96:97], v[202:203]
    v_cvt_pk_bf16_f32 v120, v202, v203
    v_pk_mul_f32 v[204:205], v[82:83], v[100:101]
    v_pk_fma_f32 v[204:205], v[18:19], v[96:97], v[204:205]
    v_cvt_pk_bf16_f32 v121, v204, v205
    v_pk_mul_f32 v[206:207], v[84:85], v[100:101]
    v_pk_fma_f32 v[206:207], v[20:21], v[96:97], v[206:207]
    v_cvt_pk_bf16_f32 v122, v206, v207
    v_pk_mul_f32 v[208:209], v[86:87], v[100:101]
    v_pk_fma_f32 v[208:209], v[22:23], v[96:97], v[208:209]
    v_cvt_pk_bf16_f32 v123, v208, v209
    v_pk_mul_f32 v[202:203], v[88:89], v[100:101]
    v_pk_fma_f32 v[202:203], v[24:25], v[96:97], v[202:203]
    v_cvt_pk_bf16_f32 v124, v202, v203
    v_pk_mul_f32 v[204:205], v[90:91], v[100:101]
    v_pk_fma_f32 v[204:205], v[26:27], v[96:97], v[204:205]
    v_cvt_pk_bf16_f32 v125, v204, v205
    v_pk_mul_f32 v[206:207], v[92:93], v[100:101]
    v_pk_fma_f32 v[206:207], v[28:29], v[96:97], v[206:207]
    v_cvt_pk_bf16_f32 v126, v206, v207
    v_pk_mul_f32 v[208:209], v[94:95], v[100:101]
    v_pk_fma_f32 v[208:209], v[30:31], v[96:97], v[208:209]
    v_cvt_pk_bf16_f32 v127, v208, v209
    v_pk_mul_f32 v[202:203], v[64:65], v[102:103]
    v_pk_fma_f32 v[202:203], v[32:33], v[98:99], v[202:203]
    v_cvt_pk_bf16_f32 v128, v202, v203
    v_pk_mul_f32 v[204:205], v[66:67], v[102:103]
    v_pk_fma_f32 v[204:205], v[34:35], v[98:99], v[204:205]
    v_cvt_pk_bf16_f32 v129, v204, v205
    v_pk_mul_f32 v[206:207], v[68:69], v[102:103]
    v_pk_fma_f32 v[206:207], v[36:37], v[98:99], v[206:207]
    v_cvt_pk_bf16_f32 v130, v206, v207
    v_pk_mul_f32 v[208:209], v[70:71], v[102:103]
    v_pk_fma_f32 v[208:209], v[38:39], v[98:99], v[208:209]
    v_cvt_pk_bf16_f32 v131, v208, v209
    v_pk_mul_f32 v[202:203], v[72:73], v[102:103]
    v_pk_fma_f32 v[202:203], v[40:41], v[98:99], v[202:203]
    v_cvt_pk_bf16_f32 v132, v202, v203
    v_pk_mul_f32 v[204:205], v[74:75], v[102:103]
    v_pk_fma_f32 v[204:205], v[42:43], v[98:99], v[204:205]
    v_cvt_pk_bf16_f32 v133, v204, v205
    v_pk_mul_f32 v[206:207], v[76:77], v[102:103]
    v_pk_fma_f32 v[206:207], v[44:45], v[98:99], v[206:207]
    v_cvt_pk_bf16_f32 v134, v206, v207
    v_pk_mul_f32 v[208:209], v[78:79], v[102:103]
    v_pk_fma_f32 v[208:209], v[46:47], v[98:99], v[208:209]
    v_cvt_pk_bf16_f32 v135, v208, v209
    v_pk_mul_f32 v[202:203], v[80:81], v[102:103]
    v_pk_fma_f32 v[202:203], v[48:49], v[98:99], v[202:203]
    v_cvt_pk_bf16_f32 v136, v202, v203
    v_pk_mul_f32 v[204:205], v[82:83], v[102:103]
    v_pk_fma_f32 v[204:205], v[50:51], v[98:99], v[204:205]
    v_cvt_pk_bf16_f32 v137, v204, v205
    v_pk_mul_f32 v[206:207], v[84:85], v[102:103]
    v_pk_fma_f32 v[206:207], v[52:53], v[98:99], v[206:207]
    v_cvt_pk_bf16_f32 v138, v206, v207
    v_pk_mul_f32 v[208:209], v[86:87], v[102:103]
    v_pk_fma_f32 v[208:209], v[54:55], v[98:99], v[208:209]
    v_cvt_pk_bf16_f32 v139, v208, v209
    v_pk_mul_f32 v[202:203], v[88:89], v[102:103]
    v_pk_fma_f32 v[202:203], v[56:57], v[98:99], v[202:203]
    v_cvt_pk_bf16_f32 v140, v202, v203
    v_pk_mul_f32 v[204:205], v[90:91], v[102:103]
    v_pk_fma_f32 v[204:205], v[58:59], v[98:99], v[204:205]
    v_cvt_pk_bf16_f32 v141, v204, v205
    v_pk_mul_f32 v[206:207], v[92:93], v[102:103]
    v_pk_fma_f32 v[206:207], v[60:61], v[98:99], v[206:207]
    v_cvt_pk_bf16_f32 v142, v206, v207
    v_pk_mul_f32 v[208:209], v[94:95], v[102:103]
    v_pk_fma_f32 v[208:209], v[62:63], v[98:99], v[208:209]
    v_cvt_pk_bf16_f32 v143, v208, v209
    s_lshl_b32 s30, s21, 2
    s_lshl_b32 s31, s25, 1
    s_add_u32 s30, s30, s31
    s_lshl_b32 s30, s30, 7
    s_lshl_b32 s31, s20, 3
    s_add_u32 s30, s30, s31
    s_lshl_b32 s31, s24, 1
    s_add_u32 s30, s30, s31
    s_lshl_b32 s30, s30, 10
    s_add_u32 s31, s30, 131072
    v_lshlrev_b32 v190, 4, v171
    buffer_store_dwordx4 v[122:125], v190, s[12:15], s30 offen offset:0 sc1
    buffer_store_dwordx4 v[124:127], v190, s[12:15], s31 offen offset:0 sc1
    buffer_store_dwordx4 v[138:141], v190, s[12:15], s30 offen offset:1024 sc1
    buffer_store_dwordx4 v[140:143], v190, s[12:15], s31 offen offset:1024 sc1
    v_mul_u32_u24 v194, 160, v174
    s_mul_i32 s30, s25, 80
    s_add_u32 s30, s30, 53248
    v_add_u32 v194, s30, v194
    v_lshl_add_u32 v194, v173, 3, v194
    v_lshlrev_b32 v196, 3, v171
    v_add_u32 v196, 73728, v196
    v_subrev_u32 v195, 16, v194
    v_cmp_le_u32 vcc, 2, v173
    s_nop 1
    v_cndmask_b32 v195, v196, v195, vcc
    v_add_u32 v197, 2560, v195
    v_cndmask_b32 v197, v196, v197, vcc
    ds_write_b64 v195, v[116:117]
    ds_write_b64 v194, v[118:119] offset:16
    ds_write_b64 v194, v[120:121] offset:48
    ds_write_b64 v197, v[132:133]
    ds_write_b64 v194, v[134:135] offset:2576
    ds_write_b64 v194, v[136:137] offset:2608
    v_lshrrev_b32 v198, 2, v172
    v_lshl_add_u32 v198, v173, 2, v198
    v_lshlrev_b32 v198, 6, v198
    v_and_b32 v199, 3, v172
    v_lshl_add_u32 v198, v199, 3, v198
    s_lshl_b32 s30, s25, 12
    s_add_u32 s30, s30, 147456
    v_add_u32 v198, s30, v198
    ds_read_b64_tr_b16 v[64:65], v198 offset:0
    ds_read_b64_tr_b16 v[66:67], v198 offset:1024
    ds_read_b64_tr_b16 v[68:69], v198 offset:32
    ds_read_b64_tr_b16 v[70:71], v198 offset:1056
    ds_read_b64_tr_b16 v[72:73], v198 offset:2048
    ds_read_b64_tr_b16 v[74:75], v198 offset:3072
    ds_read_b64_tr_b16 v[76:77], v198 offset:2080
    ds_read_b64_tr_b16 v[78:79], v198 offset:3104
    s_waitcnt lgkmcnt(0)
    v_mfma_f32_16x16x32_bf16 v[0:3], v[64:67], v[112:115], 0
    v_mfma_f32_16x16x32_bf16 v[4:7], v[68:71], v[112:115], 0
    v_mfma_f32_16x16x32_bf16 v[8:11], v[72:75], v[114:117], 0
    v_mfma_f32_16x16x32_bf16 v[12:15], v[76:79], v[114:117], 0
    v_mfma_f32_16x16x32_bf16 v[16:19], v[64:67], v[128:131], 0
    v_mfma_f32_16x16x32_bf16 v[20:23], v[68:71], v[128:131], 0
    v_mfma_f32_16x16x32_bf16 v[24:27], v[72:75], v[130:133], 0
    v_mfma_f32_16x16x32_bf16 v[28:31], v[76:79], v[130:133], 0
    s_nop 0
    v_cvt_pk_bf16_f32 v195, v0, v1
    v_cvt_pk_bf16_f32 v196, v2, v3
    v_cvt_pk_bf16_f32 v197, v4, v4
    v_cvt_pk_bf16_f32 v211, v8, v9
    v_cvt_pk_bf16_f32 v212, v10, v11
    v_cvt_pk_bf16_f32 v213, v12, v12
    v_cvt_pk_bf16_f32 v227, v16, v17
    v_cvt_pk_bf16_f32 v228, v18, v19
    v_cvt_pk_bf16_f32 v229, v20, v20
    v_cvt_pk_bf16_f32 v243, v24, v25
    v_cvt_pk_bf16_f32 v244, v26, v27
    v_cvt_pk_bf16_f32 v245, v28, v28
    v_lshlrev_b32 v190, 16, v195
    v_and_b32 v191, 0xffff0000, v195
    v_lshlrev_b32 v192, 16, v196
    v_and_b32 v193, 0xffff0000, v196
    v_lshlrev_b32 v194, 16, v197
    v_lshlrev_b32 v206, 16, v211
    v_and_b32 v207, 0xffff0000, v211
    v_lshlrev_b32 v208, 16, v212
    v_and_b32 v209, 0xffff0000, v212
    v_lshlrev_b32 v210, 16, v213
    v_lshlrev_b32 v222, 16, v227
    v_and_b32 v223, 0xffff0000, v227
    v_lshlrev_b32 v224, 16, v228
    v_and_b32 v225, 0xffff0000, v228
    v_lshlrev_b32 v226, 16, v229
    v_lshlrev_b32 v238, 16, v243
    v_and_b32 v239, 0xffff0000, v243
    v_lshlrev_b32 v240, 16, v244
    v_and_b32 v241, 0xffff0000, v244
    v_lshlrev_b32 v242, 16, v245
    v_max3_f32 v32, v190, v191, v192
    v_min3_f32 v33, v190, v191, v192
    v_max3_f32 v32, v32, v193, v194
    v_min3_f32 v33, v33, v193, v194
    v_max3_f32 v38, v206, v207, v208
    v_min3_f32 v39, v206, v207, v208
    v_max3_f32 v38, v38, v209, v210
    v_min3_f32 v39, v39, v209, v210
    v_max3_f32 v44, v222, v223, v224
    v_min3_f32 v45, v222, v223, v224
    v_max3_f32 v44, v44, v225, v226
    v_min3_f32 v45, v45, v225, v226
    v_max3_f32 v50, v238, v239, v240
    v_min3_f32 v51, v238, v239, v240
    v_max3_f32 v50, v50, v241, v242
    v_min3_f32 v51, v51, v241, v242
    v_sub_f32 v33, 0, v33
    v_sub_f32 v39, 0, v39
    v_sub_f32 v45, 0, v45
    v_sub_f32 v51, 0, v51
    v_mov_b32 v34, v32
    v_mov_b32 v40, v38
    v_mov_b32 v46, v44
    v_mov_b32 v52, v50
    v_mov_b32 v35, v33
    v_mov_b32 v41, v39
    v_mov_b32 v47, v45
    v_mov_b32 v53, v51
    v_permlane32_swap_b32 v32, v34
    v_permlane32_swap_b32 v38, v40
    v_permlane32_swap_b32 v44, v46
    v_permlane32_swap_b32 v50, v52
    v_permlane32_swap_b32 v33, v35
    v_permlane32_swap_b32 v39, v41
    v_permlane32_swap_b32 v45, v47
    v_permlane32_swap_b32 v51, v53
    v_max_f32 v32, v32, v34
    v_max_f32 v38, v38, v40
    v_max_f32 v44, v44, v46
    v_max_f32 v50, v50, v52
    v_max_f32 v33, v33, v35
    v_max_f32 v39, v39, v41
    v_max_f32 v45, v45, v47
    v_max_f32 v51, v51, v53
    v_mov_b32 v34, v32
    v_mov_b32 v40, v38
    v_mov_b32 v46, v44
    v_mov_b32 v52, v50
    v_mov_b32 v35, v33
    v_mov_b32 v41, v39
    v_mov_b32 v47, v45
    v_mov_b32 v53, v51
    v_permlane16_swap_b32 v32, v34
    v_permlane16_swap_b32 v38, v40
    v_permlane16_swap_b32 v44, v46
    v_permlane16_swap_b32 v50, v52
    v_permlane16_swap_b32 v33, v35
    v_permlane16_swap_b32 v39, v41
    v_permlane16_swap_b32 v45, v47
    v_permlane16_swap_b32 v51, v53
    v_max_f32 v32, v32, v34
    v_max_f32 v38, v38, v40
    v_max_f32 v44, v44, v46
    v_max_f32 v50, v50, v52
    v_max_f32 v33, v33, v35
    v_max_f32 v39, v39, v41
    v_max_f32 v45, v45, v47
    v_max_f32 v51, v51, v53
    v_mul_f32 v32, s35, v32
    v_mul_f32 v33, s35, v33
    v_mul_f32 v38, s35, v38
    v_mul_f32 v39, s35, v39
    v_mul_f32 v44, s35, v44
    v_mul_f32 v45, s35, v45
    v_mul_f32 v50, s35, v50
    v_mul_f32 v51, s35, v51
    v_fma_f32 v195, v190, s34, v32
    v_fma_f32 v200, v190, s35, v33
    v_fma_f32 v196, v191, s34, v32
    v_fma_f32 v201, v191, s35, v33
    v_fma_f32 v197, v192, s34, v32
    v_fma_f32 v202, v192, s35, v33
    v_fma_f32 v198, v193, s34, v32
    v_fma_f32 v203, v193, s35, v33
    v_fma_f32 v199, v194, s34, v32
    v_fma_f32 v204, v194, s35, v33
    v_fma_f32 v211, v206, s34, v38
    v_fma_f32 v216, v206, s35, v39
    v_fma_f32 v212, v207, s34, v38
    v_fma_f32 v217, v207, s35, v39
    v_fma_f32 v213, v208, s34, v38
    v_fma_f32 v218, v208, s35, v39
    v_fma_f32 v214, v209, s34, v38
    v_fma_f32 v219, v209, s35, v39
    v_fma_f32 v215, v210, s34, v38
    v_fma_f32 v220, v210, s35, v39
    v_fma_f32 v227, v222, s34, v44
    v_fma_f32 v232, v222, s35, v45
    v_fma_f32 v228, v223, s34, v44
    v_fma_f32 v233, v223, s35, v45
    v_fma_f32 v229, v224, s34, v44
    v_fma_f32 v234, v224, s35, v45
    v_fma_f32 v230, v225, s34, v44
    v_fma_f32 v235, v225, s35, v45
    v_fma_f32 v231, v226, s34, v44
    v_fma_f32 v236, v226, s35, v45
    v_fma_f32 v243, v238, s34, v50
    v_fma_f32 v248, v238, s35, v51
    v_fma_f32 v244, v239, s34, v50
    v_fma_f32 v249, v239, s35, v51
    v_fma_f32 v245, v240, s34, v50
    v_fma_f32 v250, v240, s35, v51
    v_fma_f32 v246, v241, s34, v50
    v_fma_f32 v251, v241, s35, v51
    v_fma_f32 v247, v242, s34, v50
    v_fma_f32 v252, v242, s35, v51
    v_exp_f32 v195, v195
    v_exp_f32 v196, v196
    v_exp_f32 v197, v197
    v_exp_f32 v198, v198
    v_exp_f32 v199, v199
    v_exp_f32 v200, v200
    v_exp_f32 v201, v201
    v_exp_f32 v202, v202
    v_exp_f32 v203, v203
    v_exp_f32 v204, v204
    v_exp_f32 v211, v211
    v_exp_f32 v212, v212
    v_exp_f32 v213, v213
    v_exp_f32 v214, v214
    v_exp_f32 v215, v215
    v_exp_f32 v216, v216
    v_exp_f32 v217, v217
    v_exp_f32 v218, v218
    v_exp_f32 v219, v219
    v_exp_f32 v220, v220
    v_exp_f32 v227, v227
    v_exp_f32 v228, v228
    v_exp_f32 v229, v229
    v_exp_f32 v230, v230
    v_exp_f32 v231, v231
    v_exp_f32 v232, v232
    v_exp_f32 v233, v233
    v_exp_f32 v234, v234
    v_exp_f32 v235, v235
    v_exp_f32 v236, v236
    v_exp_f32 v243, v243
    v_exp_f32 v244, v244
    v_exp_f32 v245, v245
    v_exp_f32 v246, v246
    v_exp_f32 v247, v247
    v_exp_f32 v248, v248
    v_exp_f32 v249, v249
    v_exp_f32 v250, v250
    v_exp_f32 v251, v251
    v_exp_f32 v252, v252
    v_add_f32 v32, v195, v196
    v_add_f32 v33, v200, v201
    v_add_f32 v34, v197, v198
    v_add_f32 v35, v202, v203
    v_add_f32 v32, v32, v199
    v_add_f32 v33, v33, v204
    v_add_f32 v32, v32, v34
    v_add_f32 v33, v33, v35
    v_add_f32 v38, v211, v212
    v_add_f32 v39, v216, v217
    v_add_f32 v40, v213, v214
    v_add_f32 v41, v218, v219
    v_add_f32 v38, v38, v215
    v_add_f32 v39, v39, v220
    v_add_f32 v38, v38, v40
    v_add_f32 v39, v39, v41
    v_add_f32 v44, v227, v228
    v_add_f32 v45, v232, v233
    v_add_f32 v46, v229, v230
    v_add_f32 v47, v234, v235
    v_add_f32 v44, v44, v231
    v_add_f32 v45, v45, v236
    v_add_f32 v44, v44, v46
    v_add_f32 v45, v45, v47
    v_add_f32 v50, v243, v244
    v_add_f32 v51, v248, v249
    v_add_f32 v52, v245, v246
    v_add_f32 v53, v250, v251
    v_add_f32 v50, v50, v247
    v_add_f32 v51, v51, v252
    v_add_f32 v50, v50, v52
    v_add_f32 v51, v51, v53
    v_mov_b32 v34, v32
    v_mov_b32 v40, v38
    v_mov_b32 v46, v44
    v_mov_b32 v52, v50
    v_mov_b32 v35, v33
    v_mov_b32 v41, v39
    v_mov_b32 v47, v45
    v_mov_b32 v53, v51
    v_permlane32_swap_b32 v32, v34
    v_permlane32_swap_b32 v38, v40
    v_permlane32_swap_b32 v44, v46
    v_permlane32_swap_b32 v50, v52
    v_permlane32_swap_b32 v33, v35
    v_permlane32_swap_b32 v39, v41
    v_permlane32_swap_b32 v45, v47
    v_permlane32_swap_b32 v51, v53
    v_add_f32 v32, v32, v34
    v_add_f32 v38, v38, v40
    v_add_f32 v44, v44, v46
    v_add_f32 v50, v50, v52
    v_add_f32 v33, v33, v35
    v_add_f32 v39, v39, v41
    v_add_f32 v45, v45, v47
    v_add_f32 v51, v51, v53
    v_mov_b32 v34, v32
    v_mov_b32 v40, v38
    v_mov_b32 v46, v44
    v_mov_b32 v52, v50
    v_mov_b32 v35, v33
    v_mov_b32 v41, v39
    v_mov_b32 v47, v45
    v_mov_b32 v53, v51
    v_permlane16_swap_b32 v32, v34
    v_permlane16_swap_b32 v38, v40
    v_permlane16_swap_b32 v44, v46
    v_permlane16_swap_b32 v50, v52
    v_permlane16_swap_b32 v33, v35
    v_permlane16_swap_b32 v39, v41
    v_permlane16_swap_b32 v45, v47
    v_permlane16_swap_b32 v51, v53
    v_add_f32 v32, v32, v34
    v_add_f32 v38, v38, v40
    v_add_f32 v44, v44, v46
    v_add_f32 v50, v50, v52
    v_add_f32 v33, v33, v35
    v_add_f32 v39, v39, v41
    v_add_f32 v45, v45, v47
    v_add_f32 v51, v51, v53
    v_rcp_f32 v32, v32
    v_rcp_f32 v33, v33
    v_rcp_f32 v38, v38
    v_rcp_f32 v39, v39
    v_rcp_f32 v44, v44
    v_rcp_f32 v45, v45
    v_rcp_f32 v50, v50
    v_rcp_f32 v51, v51
    v_mul_f32 v195, v195, v32
    v_mul_f32 v200, v200, v33
    v_mul_f32 v196, v196, v32
    v_mul_f32 v201, v201, v33
    v_mul_f32 v197, v197, v32
    v_mul_f32 v202, v202, v33
    v_mul_f32 v198, v198, v32
    v_mul_f32 v203, v203, v33
    v_mul_f32 v199, v199, v32
    v_mul_f32 v204, v204, v33
    v_mul_f32 v211, v211, v38
    v_mul_f32 v216, v216, v39
    v_mul_f32 v212, v212, v38
    v_mul_f32 v217, v217, v39
    v_mul_f32 v213, v213, v38
    v_mul_f32 v218, v218, v39
    v_mul_f32 v214, v214, v38
    v_mul_f32 v219, v219, v39
    v_mul_f32 v215, v215, v38
    v_mul_f32 v220, v220, v39
    v_mul_f32 v227, v227, v44
    v_mul_f32 v232, v232, v45
    v_mul_f32 v228, v228, v44
    v_mul_f32 v233, v233, v45
    v_mul_f32 v229, v229, v44
    v_mul_f32 v234, v234, v45
    v_mul_f32 v230, v230, v44
    v_mul_f32 v235, v235, v45
    v_mul_f32 v231, v231, v44
    v_mul_f32 v236, v236, v45
    v_mul_f32 v243, v243, v50
    v_mul_f32 v248, v248, v51
    v_mul_f32 v244, v244, v50
    v_mul_f32 v249, v249, v51
    v_mul_f32 v245, v245, v50
    v_mul_f32 v250, v250, v51
    v_mul_f32 v246, v246, v50
    v_mul_f32 v251, v251, v51
    v_mul_f32 v247, v247, v50
    v_mul_f32 v252, v252, v51
    v_cvt_pk_bf16_f32 v32, v195, v196
    v_cvt_pk_bf16_f32 v33, v197, v198
    v_cvt_pk_bf16_f32 v34, v199, v200
    v_cvt_pk_bf16_f32 v35, v201, v202
    v_cvt_pk_bf16_f32 v36, v203, v204
    v_mov_b32 v37, 0
    v_cvt_pk_bf16_f32 v38, v211, v212
    v_cvt_pk_bf16_f32 v39, v213, v214
    v_cvt_pk_bf16_f32 v40, v215, v216
    v_cvt_pk_bf16_f32 v41, v217, v218
    v_cvt_pk_bf16_f32 v42, v219, v220
    v_mov_b32 v43, 0
    v_cvt_pk_bf16_f32 v44, v227, v228
    v_cvt_pk_bf16_f32 v45, v229, v230
    v_cvt_pk_bf16_f32 v46, v231, v232
    v_cvt_pk_bf16_f32 v47, v233, v234
    v_cvt_pk_bf16_f32 v48, v235, v236
    v_mov_b32 v49, 0
    v_cvt_pk_bf16_f32 v50, v243, v244
    v_cvt_pk_bf16_f32 v51, v245, v246
    v_cvt_pk_bf16_f32 v52, v247, v248
    v_cvt_pk_bf16_f32 v53, v249, v250
    v_cvt_pk_bf16_f32 v54, v251, v252
    v_mov_b32 v55, 0
    v_mul_u32_u24 v188, 416, v174
    s_mul_i32 s30, s25, 192
    v_add_u32 v188, s30, v188
    v_lshl_add_u32 v188, v173, 3, v188
    ds_write_b64 v188, v[32:33] offset:0
    ds_write_b64 v188, v[34:35] offset:32
    ds_write_b64 v188, v[36:37] offset:64
    ds_write_b64 v188, v[38:39] offset:96
    ds_write_b64 v188, v[40:41] offset:128
    ds_write_b64 v188, v[42:43] offset:160
    ds_write_b64 v188, v[44:45] offset:6656
    ds_write_b64 v188, v[46:47] offset:6688
    ds_write_b64 v188, v[48:49] offset:6720
    ds_write_b64 v188, v[50:51] offset:6752
    ds_write_b64 v188, v[52:53] offset:6784
    ds_write_b64 v188, v[54:55] offset:6816
    v_lshrrev_b32 v190, 2, v172
    v_lshl_add_u32 v190, v173, 2, v190
    v_and_b32 v191, 3, v172
    v_lshlrev_b32 v191, 3, v191
    v_mul_u32_u24 v193, 416, v190
    s_mul_i32 s30, s24, 96
    v_add3_u32 v193, v193, v191, s30
    v_mul_u32_u24 v189, 160, v190
    s_mul_i32 s30, s24, 40
    s_lshl_b32 s31, s25, 5
    s_add_u32 s30, s30, s31
    s_add_u32 s30, s30, 53248
    v_add3_u32 v189, v189, v191, s30
    s_cmp_eq_u32 s25, 1
    s_cselect_b32 s30, 4, 99
    v_cmp_eq_u32 vcc, s30, v172
    v_mov_b32 v192, 0x3f803f80
    s_waitcnt lgkmcnt(0)
    s_barrier
    ds_read_b64_tr_b16 v[64:65], v193 offset:0
    ds_read_b64_tr_b16 v[66:67], v193 offset:6656
    ds_read_b64_tr_b16 v[68:69], v193 offset:32
    ds_read_b64_tr_b16 v[70:71], v193 offset:6688
    ds_read_b64_tr_b16 v[72:73], v193 offset:64
    ds_read_b64_tr_b16 v[74:75], v193 offset:6720
    ds_read_b64_tr_b16 v[112:113], v189 offset:0
    ds_read_b64_tr_b16 v[114:115], v189 offset:2560
    ds_read_b64_tr_b16 v[76:77], v193 offset:13312
    ds_read_b64_tr_b16 v[78:79], v193 offset:19968
    ds_read_b64_tr_b16 v[80:81], v193 offset:13344
    ds_read_b64_tr_b16 v[82:83], v193 offset:20000
    ds_read_b64_tr_b16 v[84:85], v193 offset:13376
    ds_read_b64_tr_b16 v[86:87], v193 offset:20032
    ds_read_b64_tr_b16 v[116:117], v189 offset:5120
    ds_read_b64_tr_b16 v[118:119], v189 offset:7680
    ds_read_b64_tr_b16 v[88:89], v193 offset:26624
    ds_read_b64_tr_b16 v[90:91], v193 offset:33280
    ds_read_b64_tr_b16 v[92:93], v193 offset:26656
    ds_read_b64_tr_b16 v[94:95], v193 offset:33312
    ds_read_b64_tr_b16 v[96:97], v193 offset:26688
    ds_read_b64_tr_b16 v[98:99], v193 offset:33344
    ds_read_b64_tr_b16 v[120:121], v189 offset:10240
    ds_read_b64_tr_b16 v[122:123], v189 offset:12800
    ds_read_b64_tr_b16 v[100:101], v193 offset:39936
    ds_read_b64_tr_b16 v[102:103], v193 offset:46592
    ds_read_b64_tr_b16 v[104:105], v193 offset:39968
    ds_read_b64_tr_b16 v[106:107], v193 offset:46624
    ds_read_b64_tr_b16 v[108:109], v193 offset:40000
    ds_read_b64_tr_b16 v[110:111], v193 offset:46656
    ds_read_b64_tr_b16 v[124:125], v189 offset:15360
    ds_read_b64_tr_b16 v[126:127], v189 offset:17920
    s_lshl_b32 s30, s20, 5
    s_lshl_b32 s31, s21, 2
    s_add_u32 s30, s30, s31
    s_add_u32 s30, s30, s24
    s_mul_i32 s30, s30, 6
    s_mul_i32 s31, s25, 3
    s_add_u32 s30, s30, s31
    s_lshl_b32 s30, s30, 10
    s_add_u32 s30, s30, 11272192
    v_lshlrev_b32 v188, 4, v171
    s_waitcnt lgkmcnt(0)
    v_cndmask_b32 v112, v112, v192, vcc
    v_cndmask_b32 v113, v113, v192, vcc
    v_cndmask_b32 v114, v114, v192, vcc
    v_cndmask_b32 v115, v115, v192, vcc
    v_cndmask_b32 v116, v116, v192, vcc
    v_cndmask_b32 v117, v117, v192, vcc
    v_cndmask_b32 v118, v118, v192, vcc
    v_cndmask_b32 v119, v119, v192, vcc
    v_cndmask_b32 v120, v120, v192, vcc
    v_cndmask_b32 v121, v121, v192, vcc
    v_cndmask_b32 v122, v122, v192, vcc
    v_cndmask_b32 v123, v123, v192, vcc
    v_cndmask_b32 v124, v124, v192, vcc
    v_cndmask_b32 v125, v125, v192, vcc
    v_cndmask_b32 v126, v126, v192, vcc
    v_cndmask_b32 v127, v127, v192, vcc
    v_mfma_f32_16x16x32_bf16 v[0:3], v[64:67], v[112:115], 0
    v_mfma_f32_16x16x32_bf16 v[4:7], v[68:71], v[112:115], 0
    v_mfma_f32_16x16x32_bf16 v[8:11], v[72:75], v[112:115], 0
    v_mfma_f32_16x16x32_bf16 v[0:3], v[76:79], v[116:119], v[0:3]
    v_mfma_f32_16x16x32_bf16 v[4:7], v[80:83], v[116:119], v[4:7]
    v_mfma_f32_16x16x32_bf16 v[8:11], v[84:87], v[116:119], v[8:11]
    v_mfma_f32_16x16x32_bf16 v[0:3], v[88:91], v[120:123], v[0:3]
    v_mfma_f32_16x16x32_bf16 v[4:7], v[92:95], v[120:123], v[4:7]
    v_mfma_f32_16x16x32_bf16 v[8:11], v[96:99], v[120:123], v[8:11]
    v_mfma_f32_16x16x32_bf16 v[0:3], v[100:103], v[124:127], v[0:3]
    v_mfma_f32_16x16x32_bf16 v[4:7], v[104:107], v[124:127], v[4:7]
    v_mfma_f32_16x16x32_bf16 v[8:11], v[108:111], v[124:127], v[8:11]
    s_nop 5
    buffer_store_dwordx4 v[0:3], v188, s[12:15], s30 offen offset:0 sc1
    buffer_store_dwordx4 v[4:7], v188, s[12:15], s30 offen offset:1024 sc1
    buffer_store_dwordx4 v[8:11], v188, s[12:15], s30 offen offset:2048 sc1
    s_lshl_b32 s30, s21, 8
    s_add_u32 s30, s30, 17047552
    s_branch KM_join
K1_ffn:
    s_nop 7
    s_nop 3
    s_mul_i32 s32, s21, 448
    s_mov_b32 s8, s44
    s_and_b32 s9, s45, 0xffff
    s_mov_b32 s10, 2211840
    s_mov_b32 s11, 0x20000
    s_mov_b32 s16, s46
    s_and_b32 s17, s47, 0xffff
    s_mov_b32 s18, 3456
    s_mov_b32 s19, 0x20000
    v_lshl_add_u32 v188, s23, 6, v171
    v_lshrrev_b32 v189, 3, v188
    v_xor_b32 v190, v189, v188
    v_and_b32 v190, 7, v190
    s_lshl_b32 s30, s20, 7
    v_add_u32 v189, s30, v189
    v_mul_u32_u24 v189, 1280, v189
    v_lshl_add_u32 v158, v190, 4, v189
    v_add_u32 v159, 81920, v158
    s_lshl_b32 s30, s23, 6
    s_add_u32 s30, s30, 0
    v_add_u32 v188, s30, v171
    v_mul_u32_u24 v189, 2185, v188
    v_lshrrev_b32 v189, 16, v189
    v_mul_u32_u24 v190, 30, v189
    v_sub_u32 v190, v188, v190
    v_bfe_u32 v192, v189, 2, 2
    v_lshlrev_b32 v191, 3, v192
    v_bfe_u32 v192, v189, 4, 1
    v_lshl_add_u32 v191, v192, 2, v191
    v_and_b32 v192, 3, v189
    v_add_u32 v191, v191, v192
    v_mul_u32_u24 v191, 3456, v191
    v_lshl_add_u32 v192, v190, 4, s32
    v_add_u32 v156, v191, v192
    v_cmp_le_u32 vcc, 28, v190
    s_nop 1
    v_cndmask_b32 v156, v156, v209, vcc
    v_cmp_le_u32 vcc, 3456, v192
    s_nop 1
    v_cndmask_b32 v156, v156, v209, vcc
    v_cmp_le_u32 vcc, 32, v189
    s_nop 1
    v_cndmask_b32 v156, v156, v209, vcc
    s_lshl_b32 s30, s23, 6
    s_add_u32 s30, s30, 512
    v_add_u32 v188, s30, v171
    v_mul_u32_u24 v189, 2185, v188
    v_lshrrev_b32 v189, 16, v189
    v_mul_u32_u24 v190, 30, v189
    v_sub_u32 v190, v188, v190
    v_bfe_u32 v192, v189, 2, 2
    v_lshlrev_b32 v191, 3, v192
    v_bfe_u32 v192, v189, 4, 1
    v_lshl_add_u32 v191, v192, 2, v191
    v_and_b32 v192, 3, v189
    v_add_u32 v191, v191, v192
    v_mul_u32_u24 v191, 3456, v191
    v_lshl_add_u32 v192, v190, 4, s32
    v_add_u32 v157, v191, v192
    v_cmp_le_u32 vcc, 28, v190
    s_nop 1
    v_cndmask_b32 v157, v157, v209, vcc
    v_cmp_le_u32 vcc, 3456, v192
    s_nop 1
    v_cndmask_b32 v157, v157, v209, vcc
    v_cmp_le_u32 vcc, 32, v189
    s_nop 1
    v_cndmask_b32 v157, v157, v209, vcc
    v_lshl_add_u32 v188, v171, 4, s32
    v_cmp_gt_u32 vcc, 28, v171
    s_nop 1
    v_cndmask_b32 v188, v209, v188, vcc
    s_mov_b32 m0, 147456
    s_nop 0
    buffer_load_dwordx4 v188, s[16:19], 0 offen lds
    s_lshl_b32 s29, s22, 3
    s_add_u32 s29, s29, s21
    s_add_u32 s29, s29, s20
    s_and_b32 s29, s29, 15
    s_mul_i32 s29, s29, 10
    s_lshr_b32 s29, s29, 4
    s_lshl_b32 s56, s29, 1
    s_mov_b32 s52, s28
    s_add_u32 s26, s28, 98304
    s_mov_b32 s57, 0
    s_mov_b32 s27, 0
    s_mul_i32 s53, s56, 110592
    s_add_u32 s56, s56, 1
    s_cmp_eq_u32 s56, 20
    s_cselect_b32 s56, 0, s56
    s_lshl_b32 s54, s29, 7
    s_add_u32 s29, s29, 1
    s_cmp_eq_u32 s29, 10
    s_cselect_b32 s29, 0, s29
    s_add_u32 m0, s52, 0
    s_nop 0
    buffer_load_dwordx4 v156, s[8:11], s53 offen lds
    s_add_u32 m0, s52, 8192
    s_nop 0
    buffer_load_dwordx4 v157, s[8:11], s53 offen lds
    s_add_u32 s52, s52, 16384
    s_sub_u32 s55, s52, 98304
    s_cmp_ge_u32 s52, 98304
    s_cselect_b32 s52, s55, s52
    s_mul_i32 s53, s56, 110592
    s_add_u32 s56, s56, 1
    s_cmp_eq_u32 s56, 20
    s_cselect_b32 s56, 0, s56
    s_add_u32 s57, s57, 1
    s_cmp_ge_u32 s57, 20
    s_cselect_b32 s53, 1073741824, s53
    s_add_u32 m0, s26, 0
    s_nop 0
    buffer_load_dwordx4 v158, s[4:7], s54 offen lds
    s_add_u32 m0, s26, 8192
    s_nop 0
    buffer_load_dwordx4 v159, s[4:7], s54 offen lds
    s_add_u32 s26, s26, 16384
    s_sub_u32 s55, s26, 49152
    s_cmp_ge_u32 s26, 147456
    s_cselect_b32 s26, s55, s26
    s_lshl_b32 s54, s29, 7
    s_add_u32 s29, s29, 1
    s_cmp_eq_u32 s29, 10
    s_cselect_b32 s29, 0, s29
    s_add_u32 s27, s27, 1
    s_cmp_ge_u32 s27, 10
    s_cselect_b32 s54, 1073741824, s54
    s_add_u32 m0, s52, 0
    s_nop 0
    buffer_load_dwordx4 v156, s[8:11], s53 offen lds
    s_add_u32 m0, s52, 8192
    s_nop 0
    buffer_load_dwordx4 v157, s[8:11], s53 offen lds
    s_add_u32 s52, s52, 16384
    s_sub_u32 s55, s52, 98304
    s_cmp_ge_u32 s52, 98304
    s_cselect_b32 s52, s55, s52
    s_mul_i32 s53, s56, 110592
    s_add_u32 s56, s56, 1
    s_cmp_eq_u32 s56, 20
    s_cselect_b32 s56, 0, s56
    s_add_u32 s57, s57, 1
    s_cmp_ge_u32 s57, 20
    s_cselect_b32 s53, 1073741824, s53
    v_lshrrev_b32 v188, 2, v172
    v_lshl_add_u32 v188, v173, 2, v188
    v_mul_u32_u24 v188, 480, v188
    v_and_b32 v189, 3, v172
    v_lshl_add_u32 v188, v189, 3, v188
    s_mul_i32 s30, s25, 256
    v_add_u32 v152, s30, v188
    s_lshl_b32 s31, s24, 6
    v_add_u32 v154, s31, v152
    v_xor_b32 v188, v172, v173
    v_and_b32 v188, 7, v188
    v_lshlrev_b32 v188, 4, v188
    s_lshl_b32 s31, s24, 5
    v_add_u32 v174, s31, v172
    v_lshl_add_u32 v188, v174, 7, v188
    v_add_u32 v153, 98304, v188
    s_lshl_b32 s31, s25, 11
    v_add_u32 v155, s31, v153
    v_xor_b32 v164, 64, v153
    v_xor_b32 v165, 64, v155
    v_mov_b32 v0, 0
    v_mov_b32 v1, 0
    v_mov_b32 v2, 0
    v_mov_b32 v3, 0
    v_mov_b32 v4, 0
    v_mov_b32 v5, 0
    v_mov_b32 v6, 0
    v_mov_b32 v7, 0
    v_mov_b32 v8, 0
    v_mov_b32 v9, 0
    v_mov_b32 v10, 0
    v_mov_b32 v11, 0
    v_mov_b32 v12, 0
    v_mov_b32 v13, 0
    v_mov_b32 v14, 0
    v_mov_b32 v15, 0
    v_mov_b32 v16, 0
    v_mov_b32 v17, 0
    v_mov_b32 v18, 0
    v_mov_b32 v19, 0
    v_mov_b32 v20, 0
    v_mov_b32 v21, 0
    v_mov_b32 v22, 0
    v_mov_b32 v23, 0
    v_mov_b32 v24, 0
    v_mov_b32 v25, 0
    v_mov_b32 v26, 0
    v_mov_b32 v27, 0
    v_mov_b32 v28, 0
    v_mov_b32 v29, 0
    v_mov_b32 v30, 0
    v_mov_b32 v31, 0
    v_mov_b32 v32, 0
    v_mov_b32 v33, 0
    v_mov_b32 v34, 0
    v_mov_b32 v35, 0
    v_mov_b32 v36, 0
    v_mov_b32 v37, 0
    v_mov_b32 v38, 0
    v_mov_b32 v39, 0
    v_mov_b32 v40, 0
    v_mov_b32 v41, 0
    v_mov_b32 v42, 0
    v_mov_b32 v43, 0
    v_mov_b32 v44, 0
    v_mov_b32 v45, 0
    v_mov_b32 v46, 0
    v_mov_b32 v47, 0
    v_mov_b32 v48, 0
    v_mov_b32 v49, 0
    v_mov_b32 v50, 0
    v_mov_b32 v51, 0
    v_mov_b32 v52, 0
    v_mov_b32 v53, 0
    v_mov_b32 v54, 0
    v_mov_b32 v55, 0
    v_mov_b32 v56, 0
    v_mov_b32 v57, 0
    v_mov_b32 v58, 0
    v_mov_b32 v59, 0
    v_mov_b32 v60, 0
    v_mov_b32 v61, 0
    v_mov_b32 v62, 0
    v_mov_b32 v63, 0
    v_mov_b32 v128, 0
    v_mov_b32 v129, 0
    v_mov_b32 v130, 0
    v_mov_b32 v131, 0
    v_mov_b32 v132, 0
    v_mov_b32 v133, 0
    v_mov_b32 v134, 0
    v_mov_b32 v135, 0
    v_mov_b32 v136, 0
    v_mov_b32 v137, 0
    v_mov_b32 v138, 0
    v_mov_b32 v139, 0
    v_mov_b32 v140, 0
    v_mov_b32 v141, 0
    v_mov_b32 v142, 0
    v_mov_b32 v143, 0
    v_mov_b32 v160, 0x3f803f80
    v_mov_b32 v161, 0x3f803f80
    v_mov_b32 v162, 0x3f803f80
    v_mov_b32 v163, 0x3f803f80
    v_mov_b32 v144, v152
    v_mov_b32 v145, v153
    v_mov_b32 v146, v154
    v_mov_b32 v147, v155
    s_waitcnt vmcnt(2)
    s_waitcnt lgkmcnt(0)
    s_barrier
    s_mov_b32 s50, 4
    s_mov_b32 s51, 16384
    s_mov_b32 s47, 0
    s_cmp_eq_u32 s25, 1
    s_cbranch_scc1 K1_ffn6
    ds_read_b64_tr_b16 v[64:65], v144 offset:0
    ds_read_b64_tr_b16 v[66:67], v144 offset:7680
    ds_read_b128 v[96:99], v145 offset:0
    ds_read_b128 v[100:103], v145 offset:2048
    ds_read_b128 v[112:115], v147
    ds_read_b64_tr_b16 v[68:69], v144 offset:32
    ds_read_b64_tr_b16 v[70:71], v144 offset:7712
    ds_read_b64_tr_b16 v[72:73], v144 offset:64
    ds_read_b64_tr_b16 v[74:75], v144 offset:7744
    ds_read_b64_tr_b16 v[76:77], v144 offset:96
    ds_read_b64_tr_b16 v[78:79], v144 offset:7776
    v_add_u32 v148, s51, v152
    v_add_u32 v150, s51, v154
    v_add_u32 v149, s47, v164
    v_add_u32 v151, s47, v165
    s_add_u32 s51, s51, 16384
    s_cmp_eq_u32 s51, 98304
    s_cselect_b32 s51, 0, s51
    s_waitcnt lgkmcnt(9)
    s_waitcnt lgkmcnt(7)
    v_mfma_f32_16x16x32_bf16 v[0:3], v[64:67], v[96:99], v[0:3]
    ds_read_b64_tr_b16 v[80:81], v144 offset:128
    ds_read_b64_tr_b16 v[82:83], v144 offset:7808
    v_mfma_f32_16x16x32_bf16 v[32:35], v[64:67], v[100:103], v[32:35]
    ds_read_b64_tr_b16 v[120:121], v146 offset:0
    ds_read_b64_tr_b16 v[122:123], v146 offset:7680
    s_waitcnt lgkmcnt(10)
    v_mfma_f32_16x16x32_bf16 v[128:131], v[160:163], v[112:115], v[128:131]
    s_waitcnt lgkmcnt(8)
    v_mfma_f32_16x16x32_bf16 v[4:7], v[68:71], v[96:99], v[4:7]
    ds_read_b64_tr_b16 v[84:85], v144 offset:160
    ds_read_b64_tr_b16 v[86:87], v144 offset:7840
    v_mfma_f32_16x16x32_bf16 v[36:39], v[68:71], v[100:103], v[36:39]
    ds_read_b64_tr_b16 v[124:125], v146 offset:32
    ds_read_b64_tr_b16 v[126:127], v146 offset:7712
    v_mfma_f32_16x16x32_bf16 v[132:135], v[112:115], v[112:115], v[132:135]
    s_waitcnt lgkmcnt(10)
    v_mfma_f32_16x16x32_bf16 v[8:11], v[72:75], v[96:99], v[8:11]
    ds_read_b64_tr_b16 v[88:89], v144 offset:192
    v_mfma_f32_16x16x32_bf16 v[40:43], v[72:75], v[100:103], v[40:43]
    ds_read_b64_tr_b16 v[90:91], v144 offset:7872
    s_waitcnt lgkmcnt(10)
    v_mfma_f32_16x16x32_bf16 v[12:15], v[76:79], v[96:99], v[12:15]
    ds_read_b64_tr_b16 v[92:93], v144 offset:224
    v_mfma_f32_16x16x32_bf16 v[44:47], v[76:79], v[100:103], v[44:47]
    ds_read_b64_tr_b16 v[94:95], v144 offset:7904
    s_waitcnt vmcnt(0)
    s_barrier
    s_waitcnt lgkmcnt(10)
    v_mfma_f32_16x16x32_bf16 v[16:19], v[80:83], v[96:99], v[16:19]
    s_add_u32 m0, s52, 0
    s_nop 0
    buffer_load_dwordx4 v156, s[8:11], s53 offen lds
    s_add_u32 m0, s52, 8192
    s_nop 0
    buffer_load_dwordx4 v157, s[8:11], s53 offen lds
    s_add_u32 s52, s52, 16384
    s_sub_u32 s55, s52, 98304
    s_cmp_ge_u32 s52, 98304
    s_cselect_b32 s52, s55, s52
    s_mul_i32 s53, s56, 110592
    s_add_u32 s56, s56, 1
    s_cmp_eq_u32 s56, 20
    s_cselect_b32 s56, 0, s56
    s_add_u32 s57, s57, 1
    s_cmp_ge_u32 s57, 20
    s_cselect_b32 s53, 1073741824, s53
    v_mfma_f32_16x16x32_bf16 v[48:51], v[80:83], v[100:103], v[48:51]
    ds_read_b64_tr_b16 v[64:65], v148 offset:0
    ds_read_b64_tr_b16 v[66:67], v148 offset:7680
    ds_read_b128 v[104:107], v149 offset:0
    ds_read_b128 v[108:111], v149 offset:2048
    ds_read_b128 v[116:119], v151
    s_waitcnt lgkmcnt(11)
    v_mfma_f32_16x16x32_bf16 v[20:23], v[84:87], v[96:99], v[20:23]
    s_add_u32 m0, s26, 0
    s_nop 0
    buffer_load_dwordx4 v158, s[4:7], s54 offen lds
    s_add_u32 m0, s26, 8192
    s_nop 0
    buffer_load_dwordx4 v159, s[4:7], s54 offen lds
    s_add_u32 s26, s26, 16384
    s_sub_u32 s55, s26, 49152
    s_cmp_ge_u32 s26, 147456
    s_cselect_b32 s26, s55, s26
    s_lshl_b32 s54, s29, 7
    s_add_u32 s29, s29, 1
    s_cmp_eq_u32 s29, 10
    s_cselect_b32 s29, 0, s29
    v_mfma_f32_16x16x32_bf16 v[52:55], v[84:87], v[100:103], v[52:55]
    s_add_u32 s27, s27, 1
    s_cmp_ge_u32 s27, 10
    s_cselect_b32 s54, 1073741824, s54
    ds_read_b64_tr_b16 v[68:69], v148 offset:32
    ds_read_b64_tr_b16 v[70:71], v148 offset:7712
    s_waitcnt lgkmcnt(9)
    v_mfma_f32_16x16x32_bf16 v[24:27], v[88:91], v[96:99], v[24:27]
    s_add_u32 m0, s52, 0
    s_nop 0
    buffer_load_dwordx4 v156, s[8:11], s53 offen lds
    s_add_u32 m0, s52, 8192
    s_nop 0
    buffer_load_dwordx4 v157, s[8:11], s53 offen lds
    s_add_u32 s52, s52, 16384
    s_sub_u32 s55, s52, 98304
    s_cmp_ge_u32 s52, 98304
    s_cselect_b32 s52, s55, s52
    v_mfma_f32_16x16x32_bf16 v[56:59], v[88:91], v[100:103], v[56:59]
    s_mul_i32 s53, s56, 110592
    s_add_u32 s56, s56, 1
    s_cmp_eq_u32 s56, 20
    s_cselect_b32 s56, 0, s56
    s_add_u32 s57, s57, 1
    s_cmp_ge_u32 s57, 20
    s_cselect_b32 s53, 1073741824, s53
    ds_read_b64_tr_b16 v[72:73], v148 offset:64
    v_mfma_f32_16x16x32_bf16 v[136:139], v[120:123], v[160:163], v[136:139]
    ds_read_b64_tr_b16 v[74:75], v148 offset:7744
    s_waitcnt lgkmcnt(9)
    v_mfma_f32_16x16x32_bf16 v[28:31], v[92:95], v[96:99], v[28:31]
    s_add_u32 m0, s52, 0
    s_nop 0
    buffer_load_dwordx4 v156, s[8:11], s53 offen lds
    s_add_u32 m0, s52, 8192
    s_nop 0
    buffer_load_dwordx4 v157, s[8:11], s53 offen lds
    s_add_u32 s52, s52, 16384
    s_sub_u32 s55, s52, 98304
    s_cmp_ge_u32 s52, 98304
    s_cselect_b32 s52, s55, s52
    v_mfma_f32_16x16x32_bf16 v[60:63], v[92:95], v[100:103], v[60:63]
    s_mul_i32 s53, s56, 110592
    s_add_u32 s56, s56, 1
    s_cmp_eq_u32 s56, 20
    s_cselect_b32 s56, 0, s56
    s_add_u32 s57, s57, 1
    s_cmp_ge_u32 s57, 20
    s_cselect_b32 s53, 1073741824, s53
    ds_read_b64_tr_b16 v[76:77], v148 offset:96
    v_mfma_f32_16x16x32_bf16 v[140:143], v[124:127], v[160:163], v[140:143]
    ds_read_b64_tr_b16 v[78:79], v148 offset:7776
    s_add_u32 s47, s47, 16384
    s_cmp_eq_u32 s47, 49152
    s_cselect_b32 s47, 0, s47
    v_add_u32 v144, s51, v152
    v_add_u32 v146, s51, v154
    v_add_u32 v145, s47, v153
    v_add_u32 v147, s47, v155
    s_add_u32 s51, s51, 16384
    s_cmp_eq_u32 s51, 98304
    s_cselect_b32 s51, 0, s51
    s_waitcnt lgkmcnt(9)
    s_waitcnt lgkmcnt(7)
    v_mfma_f32_16x16x32_bf16 v[0:3], v[64:67], v[104:107], v[0:3]
    ds_read_b64_tr_b16 v[80:81], v148 offset:128
    ds_read_b64_tr_b16 v[82:83], v148 offset:7808
    v_mfma_f32_16x16x32_bf16 v[32:35], v[64:67], v[108:111], v[32:35]
    ds_read_b64_tr_b16 v[120:121], v150 offset:0
    ds_read_b64_tr_b16 v[122:123], v150 offset:7680
    s_waitcnt lgkmcnt(10)
    v_mfma_f32_16x16x32_bf16 v[128:131], v[160:163], v[116:119], v[128:131]
    s_waitcnt lgkmcnt(8)
    v_mfma_f32_16x16x32_bf16 v[4:7], v[68:71], v[104:107], v[4:7]
    ds_read_b64_tr_b16 v[84:85], v148 offset:160
    ds_read_b64_tr_b16 v[86:87], v148 offset:7840
    v_mfma_f32_16x16x32_bf16 v[36:39], v[68:71], v[108:111], v[36:39]
    ds_read_b64_tr_b16 v[124:125], v150 offset:32
    ds_read_b64_tr_b16 v[126:127], v150 offset:7712
    v_mfma_f32_16x16x32_bf16 v[132:135], v[116:119], v[116:119], v[132:135]
    s_waitcnt lgkmcnt(10)
    v_mfma_f32_16x16x32_bf16 v[8:11], v[72:75], v[104:107], v[8:11]
    ds_read_b64_tr_b16 v[88:89], v148 offset:192
    v_mfma_f32_16x16x32_bf16 v[40:43], v[72:75], v[108:111], v[40:43]
    ds_read_b64_tr_b16 v[90:91], v148 offset:7872
    s_waitcnt lgkmcnt(10)
    v_mfma_f32_16x16x32_bf16 v[12:15], v[76:79], v[104:107], v[12:15]
    ds_read_b64_tr_b16 v[92:93], v148 offset:224
    v_mfma_f32_16x16x32_bf16 v[44:47], v[76:79], v[108:111], v[44:47]
    ds_read_b64_tr_b16 v[94:95], v148 offset:7904
    s_waitcnt vmcnt(4)
    s_barrier
    s_waitcnt lgkmcnt(10)
    v_mfma_f32_16x16x32_bf16 v[16:19], v[80:83], v[104:107], v[16:19]
    s_add_u32 m0, s52, 0
    s_nop 0
    buffer_load_dwordx4 v156, s[8:11], s53 offen lds
    s_add_u32 m0, s52, 8192
    s_nop 0
    buffer_load_dwordx4 v157, s[8:11], s53 offen lds
    s_add_u32 s52, s52, 16384
    s_sub_u32 s55, s52, 98304
    s_cmp_ge_u32 s52, 98304
    s_cselect_b32 s52, s55, s52
    s_mul_i32 s53, s56, 110592
    s_add_u32 s56, s56, 1
    s_cmp_eq_u32 s56, 20
    s_cselect_b32 s56, 0, s56
    ds_read_b64_tr_b16 v[64:65], v144 offset:0
    v_mfma_f32_16x16x32_bf16 v[48:51], v[80:83], v[108:111], v[48:51]
    ds_read_b64_tr_b16 v[66:67], v144 offset:7680
    ds_read_b128 v[96:99], v145 offset:0
    ds_read_b128 v[100:103], v145 offset:2048
    ds_read_b128 v[112:115], v147
    s_waitcnt lgkmcnt(11)
    v_mfma_f32_16x16x32_bf16 v[20:23], v[84:87], v[104:107], v[20:23]
    s_add_u32 s57, s57, 1
    s_cmp_ge_u32 s57, 20
    s_cselect_b32 s53, 1073741824, s53
    s_add_u32 m0, s26, 0
    s_nop 0
    buffer_load_dwordx4 v158, s[4:7], s54 offen lds
    s_add_u32 m0, s26, 8192
    s_nop 0
    buffer_load_dwordx4 v159, s[4:7], s54 offen lds
    v_mfma_f32_16x16x32_bf16 v[52:55], v[84:87], v[108:111], v[52:55]
    s_add_u32 s26, s26, 16384
    s_sub_u32 s55, s26, 49152
    s_cmp_ge_u32 s26, 147456
    s_cselect_b32 s26, s55, s26
    ds_read_b64_tr_b16 v[68:69], v144 offset:32
    ds_read_b64_tr_b16 v[70:71], v144 offset:7712
    s_waitcnt lgkmcnt(9)
    v_mfma_f32_16x16x32_bf16 v[24:27], v[88:91], v[104:107], v[24:27]
    s_lshl_b32 s54, s29, 7
    s_add_u32 s29, s29, 1
    s_cmp_eq_u32 s29, 10
    s_cselect_b32 s29, 0, s29
    s_add_u32 s27, s27, 1
    s_cmp_ge_u32 s27, 10
    s_cselect_b32 s54, 1073741824, s54
    v_mfma_f32_16x16x32_bf16 v[56:59], v[88:91], v[108:111], v[56:59]
    s_add_u32 m0, s52, 0
    s_nop 0
    buffer_load_dwordx4 v156, s[8:11], s53 offen lds
    s_add_u32 m0, s52, 8192
    s_nop 0
    buffer_load_dwordx4 v157, s[8:11], s53 offen lds
    v_mfma_f32_16x16x32_bf16 v[136:139], v[120:123], v[160:163], v[136:139]
    ds_read_b64_tr_b16 v[72:73], v144 offset:64
    ds_read_b64_tr_b16 v[74:75], v144 offset:7744
    s_waitcnt lgkmcnt(9)
    v_mfma_f32_16x16x32_bf16 v[28:31], v[92:95], v[104:107], v[28:31]
    s_add_u32 s52, s52, 16384
    s_sub_u32 s55, s52, 98304
    s_cmp_ge_u32 s52, 98304
    s_cselect_b32 s52, s55, s52
    s_mul_i32 s53, s56, 110592
    s_add_u32 s56, s56, 1
    s_cmp_eq_u32 s56, 20
    s_cselect_b32 s56, 0, s56
    v_mfma_f32_16x16x32_bf16 v[60:63], v[92:95], v[108:111], v[60:63]
    s_add_u32 s57, s57, 1
    s_cmp_ge_u32 s57, 20
    s_cselect_b32 s53, 1073741824, s53
    ds_read_b64_tr_b16 v[76:77], v144 offset:96
    v_mfma_f32_16x16x32_bf16 v[140:143], v[124:127], v[160:163], v[140:143]
    ds_read_b64_tr_b16 v[78:79], v144 offset:7776
    v_add_u32 v148, s51, v152
    v_add_u32 v150, s51, v154
    v_add_u32 v149, s47, v164
    v_add_u32 v151, s47, v165
    s_add_u32 s51, s51, 16384
    s_cmp_eq_u32 s51, 98304
    s_cselect_b32 s51, 0, s51
    s_waitcnt lgkmcnt(9)
    s_waitcnt lgkmcnt(7)
    v_mfma_f32_16x16x32_bf16 v[0:3], v[64:67], v[96:99], v[0:3]
    ds_read_b64_tr_b16 v[80:81], v144 offset:128
    ds_read_b64_tr_b16 v[82:83], v144 offset:7808
    v_mfma_f32_16x16x32_bf16 v[32:35], v[64:67], v[100:103], v[32:35]
    ds_read_b64_tr_b16 v[120:121], v146 offset:0
    ds_read_b64_tr_b16 v[122:123], v146 offset:7680
    s_waitcnt lgkmcnt(10)
    v_mfma_f32_16x16x32_bf16 v[128:131], v[160:163], v[112:115], v[128:131]
    s_waitcnt lgkmcnt(8)
    v_mfma_f32_16x16x32_bf16 v[4:7], v[68:71], v[96:99], v[4:7]
    ds_read_b64_tr_b16 v[84:85], v144 offset:160
    ds_read_b64_tr_b16 v[86:87], v144 offset:7840
    v_mfma_f32_16x16x32_bf16 v[36:39], v[68:71], v[100:103], v[36:39]
    ds_read_b64_tr_b16 v[124:125], v146 offset:32
    ds_read_b64_tr_b16 v[126:127], v146 offset:7712
    v_mfma_f32_16x16x32_bf16 v[132:135], v[112:115], v[112:115], v[132:135]
    s_waitcnt lgkmcnt(10)
    v_mfma_f32_16x16x32_bf16 v[8:11], v[72:75], v[96:99], v[8:11]
    ds_read_b64_tr_b16 v[88:89], v144 offset:192
    v_mfma_f32_16x16x32_bf16 v[40:43], v[72:75], v[100:103], v[40:43]
    ds_read_b64_tr_b16 v[90:91], v144 offset:7872
    s_waitcnt lgkmcnt(10)
    v_mfma_f32_16x16x32_bf16 v[12:15], v[76:79], v[96:99], v[12:15]
    ds_read_b64_tr_b16 v[92:93], v144 offset:224
    v_mfma_f32_16x16x32_bf16 v[44:47], v[76:79], v[100:103], v[44:47]
    ds_read_b64_tr_b16 v[94:95], v144 offset:7904
    s_waitcnt vmcnt(8)
    s_barrier
    s_waitcnt lgkmcnt(10)
    v_mfma_f32_16x16x32_bf16 v[16:19], v[80:83], v[96:99], v[16:19]
    s_add_u32 m0, s52, 0
    s_nop 0
    buffer_load_dwordx4 v156, s[8:11], s53 offen lds
    s_add_u32 m0, s52, 8192
    s_nop 0
    buffer_load_dwordx4 v157, s[8:11], s53 offen lds
    s_add_u32 s52, s52, 16384
    s_sub_u32 s55, s52, 98304
    s_cmp_ge_u32 s52, 98304
    s_cselect_b32 s52, s55, s52
    ds_read_b64_tr_b16 v[64:65], v148 offset:0
    v_mfma_f32_16x16x32_bf16 v[48:51], v[80:83], v[100:103], v[48:51]
    ds_read_b64_tr_b16 v[66:67], v148 offset:7680
    ds_read_b128 v[104:107], v149 offset:0
    ds_read_b128 v[108:111], v149 offset:2048
    ds_read_b128 v[116:119], v151
    s_waitcnt lgkmcnt(11)
    v_mfma_f32_16x16x32_bf16 v[20:23], v[84:87], v[96:99], v[20:23]
    s_mul_i32 s53, s56, 110592
    s_add_u32 s56, s56, 1
    s_cmp_eq_u32 s56, 20
    s_cselect_b32 s56, 0, s56
    s_add_u32 s57, s57, 1
    s_cmp_ge_u32 s57, 20
    s_cselect_b32 s53, 1073741824, s53
    s_add_u32 m0, s26, 0
    s_nop 0
    buffer_load_dwordx4 v158, s[4:7], s54 offen lds
    v_mfma_f32_16x16x32_bf16 v[52:55], v[84:87], v[100:103], v[52:55]
    ds_read_b64_tr_b16 v[68:69], v148 offset:32
    ds_read_b64_tr_b16 v[70:71], v148 offset:7712
    s_waitcnt lgkmcnt(9)
    v_mfma_f32_16x16x32_bf16 v[24:27], v[88:91], v[96:99], v[24:27]
    s_add_u32 m0, s26, 8192
    s_nop 0
    buffer_load_dwordx4 v159, s[4:7], s54 offen lds
    s_add_u32 s26, s26, 16384
    s_sub_u32 s55, s26, 49152
    s_cmp_ge_u32 s26, 147456
    s_cselect_b32 s26, s55, s26
    v_mfma_f32_16x16x32_bf16 v[56:59], v[88:91], v[100:103], v[56:59]
    ds_read_b64_tr_b16 v[72:73], v148 offset:64
    ds_read_b64_tr_b16 v[74:75], v148 offset:7744
    v_mfma_f32_16x16x32_bf16 v[136:139], v[120:123], v[160:163], v[136:139]
    s_waitcnt lgkmcnt(9)
    v_mfma_f32_16x16x32_bf16 v[28:31], v[92:95], v[96:99], v[28:31]
    s_lshl_b32 s54, s29, 7
    s_add_u32 s29, s29, 1
    s_cmp_eq_u32 s29, 10
    s_cselect_b32 s29, 0, s29
    s_add_u32 s27, s27, 1
    s_cmp_ge_u32 s27, 10
    s_cselect_b32 s54, 1073741824, s54
    v_mfma_f32_16x16x32_bf16 v[60:63], v[92:95], v[100:103], v[60:63]
    ds_read_b64_tr_b16 v[76:77], v148 offset:96
    ds_read_b64_tr_b16 v[78:79], v148 offset:7776
    v_mfma_f32_16x16x32_bf16 v[140:143], v[124:127], v[160:163], v[140:143]
    s_add_u32 s47, s47, 16384
    s_cmp_eq_u32 s47, 49152
    s_cselect_b32 s47, 0, s47
    v_add_u32 v144, s51, v152
    v_add_u32 v146, s51, v154
    v_add_u32 v145, s47, v153
    v_add_u32 v147, s47, v155
    s_add_u32 s51, s51, 16384
    s_cmp_eq_u32 s51, 98304
    s_cselect_b32 s51, 0, s51
    s_waitcnt lgkmcnt(9)
    s_waitcnt lgkmcnt(7)
    v_mfma_f32_16x16x32_bf16 v[0:3], v[64:67], v[104:107], v[0:3]
    ds_read_b64_tr_b16 v[80:81], v148 offset:128
    ds_read_b64_tr_b16 v[82:83], v148 offset:7808
    v_mfma_f32_16x16x32_bf16 v[32:35], v[64:67], v[108:111], v[32:35]
    ds_read_b64_tr_b16 v[120:121], v150 offset:0
    ds_read_b64_tr_b16 v[122:123], v150 offset:7680
    s_waitcnt lgkmcnt(10)
    v_mfma_f32_16x16x32_bf16 v[128:131], v[160:163], v[116:119], v[128:131]
    s_waitcnt lgkmcnt(8)
    v_mfma_f32_16x16x32_bf16 v[4:7], v[68:71], v[104:107], v[4:7]
    ds_read_b64_tr_b16 v[84:85], v148 offset:160
    ds_read_b64_tr_b16 v[86:87], v148 offset:7840
    v_mfma_f32_16x16x32_bf16 v[36:39], v[68:71], v[108:111], v[36:39]
    ds_read_b64_tr_b16 v[124:125], v150 offset:32
    ds_read_b64_tr_b16 v[126:127], v150 offset:7712
    v_mfma_f32_16x16x32_bf16 v[132:135], v[116:119], v[116:119], v[132:135]
    s_waitcnt lgkmcnt(10)
    v_mfma_f32_16x16x32_bf16 v[8:11], v[72:75], v[104:107], v[8:11]
    ds_read_b64_tr_b16 v[88:89], v148 offset:192
    v_mfma_f32_16x16x32_bf16 v[40:43], v[72:75], v[108:111], v[40:43]
    ds_read_b64_tr_b16 v[90:91], v148 offset:7872
    s_waitcnt lgkmcnt(10)
    v_mfma_f32_16x16x32_bf16 v[12:15], v[76:79], v[104:107], v[12:15]
    ds_read_b64_tr_b16 v[92:93], v148 offset:224
    v_mfma_f32_16x16x32_bf16 v[44:47], v[76:79], v[108:111], v[44:47]
    ds_read_b64_tr_b16 v[94:95], v148 offset:7904
    s_waitcnt vmcnt(6)
    s_barrier
    s_waitcnt lgkmcnt(10)
    v_mfma_f32_16x16x32_bf16 v[16:19], v[80:83], v[104:107], v[16:19]
    s_add_u32 m0, s52, 0
    s_nop 0
    buffer_load_dwordx4 v156, s[8:11], s53 offen lds
    s_add_u32 m0, s52, 8192
    s_nop 0
    buffer_load_dwordx4 v157, s[8:11], s53 offen lds
    ds_read_b64_tr_b16 v[64:65], v144 offset:0
    ds_read_b64_tr_b16 v[66:67], v144 offset:7680
    v_mfma_f32_16x16x32_bf16 v[48:51], v[80:83], v[108:111], v[48:51]
    ds_read_b128 v[96:99], v145 offset:0
    ds_read_b128 v[100:103], v145 offset:2048
    ds_read_b128 v[112:115], v147
    s_waitcnt lgkmcnt(11)
    v_mfma_f32_16x16x32_bf16 v[20:23], v[84:87], v[104:107], v[20:23]
    s_add_u32 s52, s52, 16384
    s_sub_u32 s55, s52, 98304
    s_cmp_ge_u32 s52, 98304
    s_cselect_b32 s52, s55, s52
    ds_read_b64_tr_b16 v[68:69], v144 offset:32
    v_mfma_f32_16x16x32_bf16 v[52:55], v[84:87], v[108:111], v[52:55]
    ds_read_b64_tr_b16 v[70:71], v144 offset:7712
    s_waitcnt lgkmcnt(9)
    v_mfma_f32_16x16x32_bf16 v[24:27], v[88:91], v[104:107], v[24:27]
    s_mul_i32 s53, s56, 110592
    s_add_u32 s56, s56, 1
    s_cmp_eq_u32 s56, 20
    s_cselect_b32 s56, 0, s56
    v_mfma_f32_16x16x32_bf16 v[56:59], v[88:91], v[108:111], v[56:59]
    ds_read_b64_tr_b16 v[72:73], v144 offset:64
    v_mfma_f32_16x16x32_bf16 v[136:139], v[120:123], v[160:163], v[136:139]
    ds_read_b64_tr_b16 v[74:75], v144 offset:7744
    s_waitcnt lgkmcnt(9)
    v_mfma_f32_16x16x32_bf16 v[28:31], v[92:95], v[104:107], v[28:31]
    s_add_u32 s57, s57, 1
    s_cmp_ge_u32 s57, 20
    s_cselect_b32 s53, 1073741824, s53
    v_mfma_f32_16x16x32_bf16 v[60:63], v[92:95], v[108:111], v[60:63]
    ds_read_b64_tr_b16 v[76:77], v144 offset:96
    v_mfma_f32_16x16x32_bf16 v[140:143], v[124:127], v[160:163], v[140:143]
    ds_read_b64_tr_b16 v[78:79], v144 offset:7776
K1_loop_f8:
    v_add_u32 v148, s51, v152
    v_add_u32 v150, s51, v154
    v_add_u32 v149, s47, v164
    v_add_u32 v151, s47, v165
    s_add_u32 s51, s51, 16384
    s_cmp_eq_u32 s51, 98304
    s_cselect_b32 s51, 0, s51
    s_waitcnt lgkmcnt(9)
    s_waitcnt lgkmcnt(7)
    v_mfma_f32_16x16x32_bf16 v[0:3], v[64:67], v[96:99], v[0:3]
    ds_read_b64_tr_b16 v[80:81], v144 offset:128
    ds_read_b64_tr_b16 v[82:83], v144 offset:7808
    v_mfma_f32_16x16x32_bf16 v[32:35], v[64:67], v[100:103], v[32:35]
    ds_read_b64_tr_b16 v[120:121], v146 offset:0
    ds_read_b64_tr_b16 v[122:123], v146 offset:7680
    s_waitcnt lgkmcnt(10)
    v_mfma_f32_16x16x32_bf16 v[128:131], v[160:163], v[112:115], v[128:131]
    s_waitcnt lgkmcnt(8)
    v_mfma_f32_16x16x32_bf16 v[4:7], v[68:71], v[96:99], v[4:7]
    ds_read_b64_tr_b16 v[84:85], v144 offset:160
    ds_read_b64_tr_b16 v[86:87], v144 offset:7840
    v_mfma_f32_16x16x32_bf16 v[36:39], v[68:71], v[100:103], v[36:39]
    ds_read_b64_tr_b16 v[124:125], v146 offset:32
    ds_read_b64_tr_b16 v[126:127], v146 offset:7712
    v_mfma_f32_16x16x32_bf16 v[132:135], v[112:115], v[112:115], v[132:135]
    s_waitcnt lgkmcnt(10)
    v_mfma_f32_16x16x32_bf16 v[8:11], v[72:75], v[96:99], v[8:11]
    ds_read_b64_tr_b16 v[88:89], v144 offset:192
    v_mfma_f32_16x16x32_bf16 v[40:43], v[72:75], v[100:103], v[40:43]
    ds_read_b64_tr_b16 v[90:91], v144 offset:7872
    s_waitcnt lgkmcnt(10)
    v_mfma_f32_16x16x32_bf16 v[12:15], v[76:79], v[96:99], v[12:15]
    ds_read_b64_tr_b16 v[92:93], v144 offset:224
    v_mfma_f32_16x16x32_bf16 v[44:47], v[76:79], v[100:103], v[44:47]
    ds_read_b64_tr_b16 v[94:95], v144 offset:7904
    s_waitcnt vmcnt(10)
    s_barrier
    s_waitcnt lgkmcnt(10)
    v_mfma_f32_16x16x32_bf16 v[16:19], v[80:83], v[96:99], v[16:19]
    s_add_u32 m0, s52, 0
    s_nop 0
    buffer_load_dwordx4 v156, s[8:11], s53 offen lds
    s_add_u32 m0, s52, 8192
    s_nop 0
    buffer_load_dwordx4 v157, s[8:11], s53 offen lds
    s_add_u32 s52, s52, 16384
    s_sub_u32 s55, s52, 98304
    s_cmp_ge_u32 s52, 98304
    s_cselect_b32 s52, s55, s52
    ds_read_b64_tr_b16 v[64:65], v148 offset:0
    v_mfma_f32_16x16x32_bf16 v[48:51], v[80:83], v[100:103], v[48:51]
    ds_read_b64_tr_b16 v[66:67], v148 offset:7680
    ds_read_b128 v[104:107], v149 offset:0
    ds_read_b128 v[108:111], v149 offset:2048
    ds_read_b128 v[116:119], v151
    s_waitcnt lgkmcnt(11)
    v_mfma_f32_16x16x32_bf16 v[20:23], v[84:87], v[96:99], v[20:23]
    s_mul_i32 s53, s56, 110592
    s_add_u32 s56, s56, 1
    s_cmp_eq_u32 s56, 20
    s_cselect_b32 s56, 0, s56
    s_add_u32 s57, s57, 1
    s_cmp_ge_u32 s57, 20
    s_cselect_b32 s53, 1073741824, s53
    s_add_u32 m0, s26, 0
    s_nop 0
    buffer_load_dwordx4 v158, s[4:7], s54 offen lds
    v_mfma_f32_16x16x32_bf16 v[52:55], v[84:87], v[100:103], v[52:55]
    ds_read_b64_tr_b16 v[68:69], v148 offset:32
    ds_read_b64_tr_b16 v[70:71], v148 offset:7712
    s_waitcnt lgkmcnt(9)
    v_mfma_f32_16x16x32_bf16 v[24:27], v[88:91], v[96:99], v[24:27]
    s_add_u32 m0, s26, 8192
    s_nop 0
    buffer_load_dwordx4 v159, s[4:7], s54 offen lds
    s_add_u32 s26, s26, 16384
    s_sub_u32 s55, s26, 49152
    s_cmp_ge_u32 s26, 147456
    s_cselect_b32 s26, s55, s26
    v_mfma_f32_16x16x32_bf16 v[56:59], v[88:91], v[100:103], v[56:59]
    ds_read_b64_tr_b16 v[72:73], v148 offset:64
    ds_read_b64_tr_b16 v[74:75], v148 offset:7744
    v_mfma_f32_16x16x32_bf16 v[136:139], v[120:123], v[160:163], v[136:139]
    s_waitcnt lgkmcnt(9)
    v_mfma_f32_16x16x32_bf16 v[28:31], v[92:95], v[96:99], v[28:31]
    s_lshl_b32 s54, s29, 7
    s_add_u32 s29, s29, 1
    s_cmp_eq_u32 s29, 10
    s_cselect_b32 s29, 0, s29
    s_add_u32 s27, s27, 1
    s_cmp_ge_u32 s27, 10
    s_cselect_b32 s54, 1073741824, s54
    v_mfma_f32_16x16x32_bf16 v[60:63], v[92:95], v[100:103], v[60:63]
    ds_read_b64_tr_b16 v[76:77], v148 offset:96
    ds_read_b64_tr_b16 v[78:79], v148 offset:7776
    v_mfma_f32_16x16x32_bf16 v[140:143], v[124:127], v[160:163], v[140:143]
    s_add_u32 s47, s47, 16384
    s_cmp_eq_u32 s47, 49152
    s_cselect_b32 s47, 0, s47
    v_add_u32 v144, s51, v152
    v_add_u32 v146, s51, v154
    v_add_u32 v145, s47, v153
    v_add_u32 v147, s47, v155
    s_add_u32 s51, s51, 16384
    s_cmp_eq_u32 s51, 98304
    s_cselect_b32 s51, 0, s51
    s_waitcnt lgkmcnt(9)
    s_waitcnt lgkmcnt(7)
    v_mfma_f32_16x16x32_bf16 v[0:3], v[64:67], v[104:107], v[0:3]
    ds_read_b64_tr_b16 v[80:81], v148 offset:128
    ds_read_b64_tr_b16 v[82:83], v148 offset:7808
    v_mfma_f32_16x16x32_bf16 v[32:35], v[64:67], v[108:111], v[32:35]
    ds_read_b64_tr_b16 v[120:121], v150 offset:0
    ds_read_b64_tr_b16 v[122:123], v150 offset:7680
    s_waitcnt lgkmcnt(10)
    v_mfma_f32_16x16x32_bf16 v[128:131], v[160:163], v[116:119], v[128:131]
    s_waitcnt lgkmcnt(8)
    v_mfma_f32_16x16x32_bf16 v[4:7], v[68:71], v[104:107], v[4:7]
    ds_read_b64_tr_b16 v[84:85], v148 offset:160
    ds_read_b64_tr_b16 v[86:87], v148 offset:7840
    v_mfma_f32_16x16x32_bf16 v[36:39], v[68:71], v[108:111], v[36:39]
    ds_read_b64_tr_b16 v[124:125], v150 offset:32
    ds_read_b64_tr_b16 v[126:127], v150 offset:7712
    v_mfma_f32_16x16x32_bf16 v[132:135], v[116:119], v[116:119], v[132:135]
    s_waitcnt lgkmcnt(10)
    v_mfma_f32_16x16x32_bf16 v[8:11], v[72:75], v[104:107], v[8:11]
    ds_read_b64_tr_b16 v[88:89], v148 offset:192
    v_mfma_f32_16x16x32_bf16 v[40:43], v[72:75], v[108:111], v[40:43]
    ds_read_b64_tr_b16 v[90:91], v148 offset:7872
    s_waitcnt lgkmcnt(10)
    v_mfma_f32_16x16x32_bf16 v[12:15], v[76:79], v[104:107], v[12:15]
    ds_read_b64_tr_b16 v[92:93], v148 offset:224
    v_mfma_f32_16x16x32_bf16 v[44:47], v[76:79], v[108:111], v[44:47]
    ds_read_b64_tr_b16 v[94:95], v148 offset:7904
    s_waitcnt vmcnt(6)
    s_barrier
    s_waitcnt lgkmcnt(10)
    v_mfma_f32_16x16x32_bf16 v[16:19], v[80:83], v[104:107], v[16:19]
    s_add_u32 m0, s52, 0
    s_nop 0
    buffer_load_dwordx4 v156, s[8:11], s53 offen lds
    s_add_u32 m0, s52, 8192
    s_nop 0
    buffer_load_dwordx4 v157, s[8:11], s53 offen lds
    ds_read_b64_tr_b16 v[64:65], v144 offset:0
    ds_read_b64_tr_b16 v[66:67], v144 offset:7680
    v_mfma_f32_16x16x32_bf16 v[48:51], v[80:83], v[108:111], v[48:51]
    ds_read_b128 v[96:99], v145 offset:0
    ds_read_b128 v[100:103], v145 offset:2048
    ds_read_b128 v[112:115], v147
    s_waitcnt lgkmcnt(11)
    v_mfma_f32_16x16x32_bf16 v[20:23], v[84:87], v[104:107], v[20:23]
    s_add_u32 s52, s52, 16384
    s_sub_u32 s55, s52, 98304
    s_cmp_ge_u32 s52, 98304
    s_cselect_b32 s52, s55, s52
    ds_read_b64_tr_b16 v[68:69], v144 offset:32
    v_mfma_f32_16x16x32_bf16 v[52:55], v[84:87], v[108:111], v[52:55]
    ds_read_b64_tr_b16 v[70:71], v144 offset:7712
    s_waitcnt lgkmcnt(9)
    v_mfma_f32_16x16x32_bf16 v[24:27], v[88:91], v[104:107], v[24:27]
    s_mul_i32 s53, s56, 110592
    s_add_u32 s56, s56, 1
    s_cmp_eq_u32 s56, 20
    s_cselect_b32 s56, 0, s56
    v_mfma_f32_16x16x32_bf16 v[56:59], v[88:91], v[108:111], v[56:59]
    ds_read_b64_tr_b16 v[72:73], v144 offset:64
    v_mfma_f32_16x16x32_bf16 v[136:139], v[120:123], v[160:163], v[136:139]
    ds_read_b64_tr_b16 v[74:75], v144 offset:7744
    s_waitcnt lgkmcnt(9)
    v_mfma_f32_16x16x32_bf16 v[28:31], v[92:95], v[104:107], v[28:31]
    s_add_u32 s57, s57, 1
    s_cmp_ge_u32 s57, 20
    s_cselect_b32 s53, 1073741824, s53
    v_mfma_f32_16x16x32_bf16 v[60:63], v[92:95], v[108:111], v[60:63]
    ds_read_b64_tr_b16 v[76:77], v144 offset:96
    v_mfma_f32_16x16x32_bf16 v[140:143], v[124:127], v[160:163], v[140:143]
    ds_read_b64_tr_b16 v[78:79], v144 offset:7776
    s_add_u32 s50, s50, 2
    s_cmp_lt_u32 s50, 20
    s_cbranch_scc1 K1_loop_f8
    s_waitcnt lgkmcnt(0)
    s_branch K1_ffn_join
K1_ffn6:
    s_nop 7
    s_nop 3
    ds_read_b64_tr_b16 v[64:65], v144 offset:0
    ds_read_b64_tr_b16 v[66:67], v144 offset:7680
    ds_read_b128 v[96:99], v145 offset:0
    ds_read_b128 v[100:103], v145 offset:2048
    ds_read_b128 v[112:115], v147
    ds_read_b64_tr_b16 v[68:69], v144 offset:32
    ds_read_b64_tr_b16 v[70:71], v144 offset:7712
    ds_read_b64_tr_b16 v[72:73], v144 offset:64
    ds_read_b64_tr_b16 v[74:75], v144 offset:7744
    ds_read_b64_tr_b16 v[76:77], v144 offset:96
    ds_read_b64_tr_b16 v[78:79], v144 offset:7776
    v_add_u32 v148, s51, v152
    v_add_u32 v150, s51, v154
    v_add_u32 v149, s47, v164
    v_add_u32 v151, s47, v165
    s_add_u32 s51, s51, 16384
    s_cmp_eq_u32 s51, 98304
    s_cselect_b32 s51, 0, s51
    s_waitcnt lgkmcnt(9)
    s_waitcnt lgkmcnt(7)
    v_mfma_f32_16x16x32_bf16 v[0:3], v[64:67], v[96:99], v[0:3]
    ds_read_b64_tr_b16 v[80:81], v144 offset:128
    ds_read_b64_tr_b16 v[82:83], v144 offset:7808
    v_mfma_f32_16x16x32_bf16 v[32:35], v[64:67], v[100:103], v[32:35]
    ds_read_b64_tr_b16 v[120:121], v146 offset:0
    ds_read_b64_tr_b16 v[122:123], v146 offset:7680
    s_waitcnt lgkmcnt(10)
    v_mfma_f32_16x16x32_bf16 v[128:131], v[160:163], v[112:115], v[128:131]
    s_waitcnt lgkmcnt(8)
    v_mfma_f32_16x16x32_bf16 v[4:7], v[68:71], v[96:99], v[4:7]
    ds_read_b64_tr_b16 v[84:85], v144 offset:160
    ds_read_b64_tr_b16 v[86:87], v144 offset:7840
    v_mfma_f32_16x16x32_bf16 v[36:39], v[68:71], v[100:103], v[36:39]
    ds_read_b64_tr_b16 v[124:125], v146 offset:32
    ds_read_b64_tr_b16 v[126:127], v146 offset:7712
    v_mfma_f32_16x16x32_bf16 v[132:135], v[112:115], v[112:115], v[132:135]
    s_waitcnt vmcnt(0)
    s_barrier
    s_waitcnt lgkmcnt(10)
    v_mfma_f32_16x16x32_bf16 v[8:11], v[72:75], v[96:99], v[8:11]
    s_add_u32 m0, s52, 0
    s_nop 0
    buffer_load_dwordx4 v156, s[8:11], s53 offen lds
    s_add_u32 m0, s52, 8192
    s_nop 0
    buffer_load_dwordx4 v157, s[8:11], s53 offen lds
    s_add_u32 s52, s52, 16384
    s_sub_u32 s55, s52, 98304
    s_cmp_ge_u32 s52, 98304
    s_cselect_b32 s52, s55, s52
    s_mul_i32 s53, s56, 110592
    s_add_u32 s56, s56, 1
    s_cmp_eq_u32 s56, 20
    s_cselect_b32 s56, 0, s56
    s_add_u32 s57, s57, 1
    s_cmp_ge_u32 s57, 20
    s_cselect_b32 s53, 1073741824, s53
    v_mfma_f32_16x16x32_bf16 v[40:43], v[72:75], v[100:103], v[40:43]
    ds_read_b64_tr_b16 v[64:65], v148 offset:0
    ds_read_b64_tr_b16 v[66:67], v148 offset:7680
    ds_read_b128 v[104:107], v149 offset:0
    ds_read_b128 v[108:111], v149 offset:2048
    ds_read_b128 v[116:119], v151
    s_waitcnt lgkmcnt(13)
    v_mfma_f32_16x16x32_bf16 v[12:15], v[76:79], v[96:99], v[12:15]
    s_add_u32 m0, s26, 0
    s_nop 0
    buffer_load_dwordx4 v158, s[4:7], s54 offen lds
    s_add_u32 m0, s26, 8192
    s_nop 0
    buffer_load_dwordx4 v159, s[4:7], s54 offen lds
    s_add_u32 s26, s26, 16384
    s_sub_u32 s55, s26, 49152
    s_cmp_ge_u32 s26, 147456
    s_cselect_b32 s26, s55, s26
    s_lshl_b32 s54, s29, 7
    s_add_u32 s29, s29, 1
    s_cmp_eq_u32 s29, 10
    s_cselect_b32 s29, 0, s29
    v_mfma_f32_16x16x32_bf16 v[44:47], v[76:79], v[100:103], v[44:47]
    s_add_u32 s27, s27, 1
    s_cmp_ge_u32 s27, 10
    s_cselect_b32 s54, 1073741824, s54
    ds_read_b64_tr_b16 v[68:69], v148 offset:32
    ds_read_b64_tr_b16 v[70:71], v148 offset:7712
    s_waitcnt lgkmcnt(13)
    v_mfma_f32_16x16x32_bf16 v[16:19], v[80:83], v[96:99], v[16:19]
    s_add_u32 m0, s52, 0
    s_nop 0
    buffer_load_dwordx4 v156, s[8:11], s53 offen lds
    s_add_u32 m0, s52, 8192
    s_nop 0
    buffer_load_dwordx4 v157, s[8:11], s53 offen lds
    s_add_u32 s52, s52, 16384
    s_sub_u32 s55, s52, 98304
    s_cmp_ge_u32 s52, 98304
    s_cselect_b32 s52, s55, s52
    v_mfma_f32_16x16x32_bf16 v[48:51], v[80:83], v[100:103], v[48:51]
    s_mul_i32 s53, s56, 110592
    s_add_u32 s56, s56, 1
    s_cmp_eq_u32 s56, 20
    s_cselect_b32 s56, 0, s56
    s_add_u32 s57, s57, 1
    s_cmp_ge_u32 s57, 20
    s_cselect_b32 s53, 1073741824, s53
    ds_read_b64_tr_b16 v[72:73], v148 offset:64
    s_waitcnt lgkmcnt(8)
    v_mfma_f32_16x16x32_bf16 v[136:139], v[120:123], v[160:163], v[136:139]
    ds_read_b64_tr_b16 v[74:75], v148 offset:7744
    v_mfma_f32_16x16x32_bf16 v[20:23], v[84:87], v[96:99], v[20:23]
    s_add_u32 m0, s52, 0
    s_nop 0
    buffer_load_dwordx4 v156, s[8:11], s53 offen lds
    s_add_u32 m0, s52, 8192
    s_nop 0
    buffer_load_dwordx4 v157, s[8:11], s53 offen lds
    s_add_u32 s52, s52, 16384
    s_sub_u32 s55, s52, 98304
    s_cmp_ge_u32 s52, 98304
    s_cselect_b32 s52, s55, s52
    v_mfma_f32_16x16x32_bf16 v[52:55], v[84:87], v[100:103], v[52:55]
    s_mul_i32 s53, s56, 110592
    s_add_u32 s56, s56, 1
    s_cmp_eq_u32 s56, 20
    s_cselect_b32 s56, 0, s56
    s_add_u32 s57, s57, 1
    s_cmp_ge_u32 s57, 20
    s_cselect_b32 s53, 1073741824, s53
    ds_read_b64_tr_b16 v[76:77], v148 offset:96
    v_mfma_f32_16x16x32_bf16 v[140:143], v[124:127], v[160:163], v[140:143]
    ds_read_b64_tr_b16 v[78:79], v148 offset:7776
    s_add_u32 s47, s47, 16384
    s_cmp_eq_u32 s47, 49152
    s_cselect_b32 s47, 0, s47
    v_add_u32 v144, s51, v152
    v_add_u32 v146, s51, v154
    v_add_u32 v145, s47, v153
    v_add_u32 v147, s47, v155
    s_add_u32 s51, s51, 16384
    s_cmp_eq_u32 s51, 98304
    s_cselect_b32 s51, 0, s51
    s_waitcnt lgkmcnt(9)
    s_waitcnt lgkmcnt(7)
    v_mfma_f32_16x16x32_bf16 v[0:3], v[64:67], v[104:107], v[0:3]
    ds_read_b64_tr_b16 v[80:81], v148 offset:128
    ds_read_b64_tr_b16 v[82:83], v148 offset:7808
    v_mfma_f32_16x16x32_bf16 v[32:35], v[64:67], v[108:111], v[32:35]
    ds_read_b64_tr_b16 v[120:121], v150 offset:0
    ds_read_b64_tr_b16 v[122:123], v150 offset:7680
    s_waitcnt lgkmcnt(10)
    v_mfma_f32_16x16x32_bf16 v[128:131], v[160:163], v[116:119], v[128:131]
    s_waitcnt lgkmcnt(8)
    v_mfma_f32_16x16x32_bf16 v[4:7], v[68:71], v[104:107], v[4:7]
    ds_read_b64_tr_b16 v[84:85], v148 offset:160
    ds_read_b64_tr_b16 v[86:87], v148 offset:7840
    v_mfma_f32_16x16x32_bf16 v[36:39], v[68:71], v[108:111], v[36:39]
    ds_read_b64_tr_b16 v[124:125], v150 offset:32
    ds_read_b64_tr_b16 v[126:127], v150 offset:7712
    v_mfma_f32_16x16x32_bf16 v[132:135], v[116:119], v[116:119], v[132:135]
    s_waitcnt vmcnt(4)
    s_barrier
    s_waitcnt lgkmcnt(10)
    v_mfma_f32_16x16x32_bf16 v[8:11], v[72:75], v[104:107], v[8:11]
    s_add_u32 m0, s52, 0
    s_nop 0
    buffer_load_dwordx4 v156, s[8:11], s53 offen lds
    s_add_u32 m0, s52, 8192
    s_nop 0
    buffer_load_dwordx4 v157, s[8:11], s53 offen lds
    s_add_u32 s52, s52, 16384
    s_sub_u32 s55, s52, 98304
    s_cmp_ge_u32 s52, 98304
    s_cselect_b32 s52, s55, s52
    s_mul_i32 s53, s56, 110592
    s_add_u32 s56, s56, 1
    s_cmp_eq_u32 s56, 20
    s_cselect_b32 s56, 0, s56
    ds_read_b64_tr_b16 v[64:65], v144 offset:0
    v_mfma_f32_16x16x32_bf16 v[40:43], v[72:75], v[108:111], v[40:43]
    ds_read_b64_tr_b16 v[66:67], v144 offset:7680
    ds_read_b128 v[96:99], v145 offset:0
    ds_read_b128 v[100:103], v145 offset:2048
    ds_read_b128 v[112:115], v147
    s_waitcnt lgkmcnt(13)
    v_mfma_f32_16x16x32_bf16 v[12:15], v[76:79], v[104:107], v[12:15]
    s_add_u32 s57, s57, 1
    s_cmp_ge_u32 s57, 20
    s_cselect_b32 s53, 1073741824, s53
    s_add_u32 m0, s26, 0
    s_nop 0
    buffer_load_dwordx4 v158, s[4:7], s54 offen lds
    s_add_u32 m0, s26, 8192
    s_nop 0
    buffer_load_dwordx4 v159, s[4:7], s54 offen lds
    v_mfma_f32_16x16x32_bf16 v[44:47], v[76:79], v[108:111], v[44:47]
    s_add_u32 s26, s26, 16384
    s_sub_u32 s55, s26, 49152
    s_cmp_ge_u32 s26, 147456
    s_cselect_b32 s26, s55, s26
    ds_read_b64_tr_b16 v[68:69], v144 offset:32
    ds_read_b64_tr_b16 v[70:71], v144 offset:7712
    s_waitcnt lgkmcnt(13)
    v_mfma_f32_16x16x32_bf16 v[16:19], v[80:83], v[104:107], v[16:19]
    s_lshl_b32 s54, s29, 7
    s_add_u32 s29, s29, 1
    s_cmp_eq_u32 s29, 10
    s_cselect_b32 s29, 0, s29
    s_add_u32 s27, s27, 1
    s_cmp_ge_u32 s27, 10
    s_cselect_b32 s54, 1073741824, s54
    v_mfma_f32_16x16x32_bf16 v[48:51], v[80:83], v[108:111], v[48:51]
    s_add_u32 m0, s52, 0
    s_nop 0
    buffer_load_dwordx4 v156, s[8:11], s53 offen lds
    s_add_u32 m0, s52, 8192
    s_nop 0
    buffer_load_dwordx4 v157, s[8:11], s53 offen lds
    s_waitcnt lgkmcnt(7)
    v_mfma_f32_16x16x32_bf16 v[136:139], v[120:123], v[160:163], v[136:139]
    ds_read_b64_tr_b16 v[72:73], v144 offset:64
    ds_read_b64_tr_b16 v[74:75], v144 offset:7744
    v_mfma_f32_16x16x32_bf16 v[20:23], v[84:87], v[104:107], v[20:23]
    s_add_u32 s52, s52, 16384
    s_sub_u32 s55, s52, 98304
    s_cmp_ge_u32 s52, 98304
    s_cselect_b32 s52, s55, s52
    s_mul_i32 s53, s56, 110592
    s_add_u32 s56, s56, 1
    s_cmp_eq_u32 s56, 20
    s_cselect_b32 s56, 0, s56
    v_mfma_f32_16x16x32_bf16 v[52:55], v[84:87], v[108:111], v[52:55]
    s_add_u32 s57, s57, 1
    s_cmp_ge_u32 s57, 20
    s_cselect_b32 s53, 1073741824, s53
    ds_read_b64_tr_b16 v[76:77], v144 offset:96
    v_mfma_f32_16x16x32_bf16 v[140:143], v[124:127], v[160:163], v[140:143]
    ds_read_b64_tr_b16 v[78:79], v144 offset:7776
    v_add_u32 v148, s51, v152
    v_add_u32 v150, s51, v154
    v_add_u32 v149, s47, v164
    v_add_u32 v151, s47, v165
    s_add_u32 s51, s51, 16384
    s_cmp_eq_u32 s51, 98304
    s_cselect_b32 s51, 0, s51
    s_waitcnt lgkmcnt(9)
    s_waitcnt lgkmcnt(7)
    v_mfma_f32_16x16x32_bf16 v[0:3], v[64:67], v[96:99], v[0:3]
    ds_read_b64_tr_b16 v[80:81], v144 offset:128
    ds_read_b64_tr_b16 v[82:83], v144 offset:7808
    v_mfma_f32_16x16x32_bf16 v[32:35], v[64:67], v[100:103], v[32:35]
    ds_read_b64_tr_b16 v[120:121], v146 offset:0
    ds_read_b64_tr_b16 v[122:123], v146 offset:7680
    s_waitcnt lgkmcnt(10)
    v_mfma_f32_16x16x32_bf16 v[128:131], v[160:163], v[112:115], v[128:131]
    s_waitcnt lgkmcnt(8)
    v_mfma_f32_16x16x32_bf16 v[4:7], v[68:71], v[96:99], v[4:7]
    ds_read_b64_tr_b16 v[84:85], v144 offset:160
    ds_read_b64_tr_b16 v[86:87], v144 offset:7840
    v_mfma_f32_16x16x32_bf16 v[36:39], v[68:71], v[100:103], v[36:39]
    ds_read_b64_tr_b16 v[124:125], v146 offset:32
    ds_read_b64_tr_b16 v[126:127], v146 offset:7712
    v_mfma_f32_16x16x32_bf16 v[132:135], v[112:115], v[112:115], v[132:135]
    s_waitcnt vmcnt(8)
    s_barrier
    s_waitcnt lgkmcnt(10)
    v_mfma_f32_16x16x32_bf16 v[8:11], v[72:75], v[96:99], v[8:11]
    s_add_u32 m0, s52, 0
    s_nop 0
    buffer_load_dwordx4 v156, s[8:11], s53 offen lds
    s_add_u32 m0, s52, 8192
    s_nop 0
    buffer_load_dwordx4 v157, s[8:11], s53 offen lds
    s_add_u32 s52, s52, 16384
    s_sub_u32 s55, s52, 98304
    s_cmp_ge_u32 s52, 98304
    s_cselect_b32 s52, s55, s52
    ds_read_b64_tr_b16 v[64:65], v148 offset:0
    v_mfma_f32_16x16x32_bf16 v[40:43], v[72:75], v[100:103], v[40:43]
    ds_read_b64_tr_b16 v[66:67], v148 offset:7680
    ds_read_b128 v[104:107], v149 offset:0
    ds_read_b128 v[108:111], v149 offset:2048
    ds_read_b128 v[116:119], v151
    s_waitcnt lgkmcnt(13)
    v_mfma_f32_16x16x32_bf16 v[12:15], v[76:79], v[96:99], v[12:15]
    s_mul_i32 s53, s56, 110592
    s_add_u32 s56, s56, 1
    s_cmp_eq_u32 s56, 20
    s_cselect_b32 s56, 0, s56
    s_add_u32 s57, s57, 1
    s_cmp_ge_u32 s57, 20
    s_cselect_b32 s53, 1073741824, s53
    s_add_u32 m0, s26, 0
    s_nop 0
    buffer_load_dwordx4 v158, s[4:7], s54 offen lds
    v_mfma_f32_16x16x32_bf16 v[44:47], v[76:79], v[100:103], v[44:47]
    ds_read_b64_tr_b16 v[68:69], v148 offset:32
    ds_read_b64_tr_b16 v[70:71], v148 offset:7712
    s_waitcnt lgkmcnt(13)
    v_mfma_f32_16x16x32_bf16 v[16:19], v[80:83], v[96:99], v[16:19]
    s_add_u32 m0, s26, 8192
    s_nop 0
    buffer_load_dwordx4 v159, s[4:7], s54 offen lds
    s_add_u32 s26, s26, 16384
    s_sub_u32 s55, s26, 49152
    s_cmp_ge_u32 s26, 147456
    s_cselect_b32 s26, s55, s26
    v_mfma_f32_16x16x32_bf16 v[48:51], v[80:83], v[100:103], v[48:51]
    ds_read_b64_tr_b16 v[72:73], v148 offset:64
    ds_read_b64_tr_b16 v[74:75], v148 offset:7744
    s_waitcnt lgkmcnt(9)
    v_mfma_f32_16x16x32_bf16 v[136:139], v[120:123], v[160:163], v[136:139]
    v_mfma_f32_16x16x32_bf16 v[20:23], v[84:87], v[96:99], v[20:23]
    s_lshl_b32 s54, s29, 7
    s_add_u32 s29, s29, 1
    s_cmp_eq_u32 s29, 10
    s_cselect_b32 s29, 0, s29
    s_add_u32 s27, s27, 1
    s_cmp_ge_u32 s27, 10
    s_cselect_b32 s54, 1073741824, s54
    v_mfma_f32_16x16x32_bf16 v[52:55], v[84:87], v[100:103], v[52:55]
    ds_read_b64_tr_b16 v[76:77], v148 offset:96
    ds_read_b64_tr_b16 v[78:79], v148 offset:7776
    v_mfma_f32_16x16x32_bf16 v[140:143], v[124:127], v[160:163], v[140:143]
    s_add_u32 s47, s47, 16384
    s_cmp_eq_u32 s47, 49152
    s_cselect_b32 s47, 0, s47
    v_add_u32 v144, s51, v152
    v_add_u32 v146, s51, v154
    v_add_u32 v145, s47, v153
    v_add_u32 v147, s47, v155
    s_add_u32 s51, s51, 16384
    s_cmp_eq_u32 s51, 98304
    s_cselect_b32 s51, 0, s51
    s_waitcnt lgkmcnt(9)
    s_waitcnt lgkmcnt(7)
    v_mfma_f32_16x16x32_bf16 v[0:3], v[64:67], v[104:107], v[0:3]
    ds_read_b64_tr_b16 v[80:81], v148 offset:128
    ds_read_b64_tr_b16 v[82:83], v148 offset:7808
    v_mfma_f32_16x16x32_bf16 v[32:35], v[64:67], v[108:111], v[32:35]
    ds_read_b64_tr_b16 v[120:121], v150 offset:0
    ds_read_b64_tr_b16 v[122:123], v150 offset:7680
    s_waitcnt lgkmcnt(10)
    v_mfma_f32_16x16x32_bf16 v[128:131], v[160:163], v[116:119], v[128:131]
    s_waitcnt lgkmcnt(8)
    v_mfma_f32_16x16x32_bf16 v[4:7], v[68:71], v[104:107], v[4:7]
    ds_read_b64_tr_b16 v[84:85], v148 offset:160
    ds_read_b64_tr_b16 v[86:87], v148 offset:7840
    v_mfma_f32_16x16x32_bf16 v[36:39], v[68:71], v[108:111], v[36:39]
    ds_read_b64_tr_b16 v[124:125], v150 offset:32
    ds_read_b64_tr_b16 v[126:127], v150 offset:7712
    v_mfma_f32_16x16x32_bf16 v[132:135], v[116:119], v[116:119], v[132:135]
    s_waitcnt vmcnt(6)
    s_barrier
    s_waitcnt lgkmcnt(10)
    v_mfma_f32_16x16x32_bf16 v[8:11], v[72:75], v[104:107], v[8:11]
    s_add_u32 m0, s52, 0
    s_nop 0
    buffer_load_dwordx4 v156, s[8:11], s53 offen lds
    s_add_u32 m0, s52, 8192
    s_nop 0
    buffer_load_dwordx4 v157, s[8:11], s53 offen lds
    ds_read_b64_tr_b16 v[64:65], v144 offset:0
    ds_read_b64_tr_b16 v[66:67], v144 offset:7680
    v_mfma_f32_16x16x32_bf16 v[40:43], v[72:75], v[108:111], v[40:43]
    ds_read_b128 v[96:99], v145 offset:0
    ds_read_b128 v[100:103], v145 offset:2048
    ds_read_b128 v[112:115], v147
    s_waitcnt lgkmcnt(13)
    v_mfma_f32_16x16x32_bf16 v[12:15], v[76:79], v[104:107], v[12:15]
    s_add_u32 s52, s52, 16384
    s_sub_u32 s55, s52, 98304
    s_cmp_ge_u32 s52, 98304
    s_cselect_b32 s52, s55, s52
    ds_read_b64_tr_b16 v[68:69], v144 offset:32
    v_mfma_f32_16x16x32_bf16 v[44:47], v[76:79], v[108:111], v[44:47]
    ds_read_b64_tr_b16 v[70:71], v144 offset:7712
    s_waitcnt lgkmcnt(13)
    v_mfma_f32_16x16x32_bf16 v[16:19], v[80:83], v[104:107], v[16:19]
    s_mul_i32 s53, s56, 110592
    s_add_u32 s56, s56, 1
    s_cmp_eq_u32 s56, 20
    s_cselect_b32 s56, 0, s56
    v_mfma_f32_16x16x32_bf16 v[48:51], v[80:83], v[108:111], v[48:51]
    ds_read_b64_tr_b16 v[72:73], v144 offset:64
    s_waitcnt lgkmcnt(8)
    v_mfma_f32_16x16x32_bf16 v[136:139], v[120:123], v[160:163], v[136:139]
    ds_read_b64_tr_b16 v[74:75], v144 offset:7744
    v_mfma_f32_16x16x32_bf16 v[20:23], v[84:87], v[104:107], v[20:23]
    s_add_u32 s57, s57, 1
    s_cmp_ge_u32 s57, 20
    s_cselect_b32 s53, 1073741824, s53
    v_mfma_f32_16x16x32_bf16 v[52:55], v[84:87], v[108:111], v[52:55]
    ds_read_b64_tr_b16 v[76:77], v144 offset:96
    v_mfma_f32_16x16x32_bf16 v[140:143], v[124:127], v[160:163], v[140:143]
    ds_read_b64_tr_b16 v[78:79], v144 offset:7776
K1_loop_f6:
    v_add_u32 v148, s51, v152
    v_add_u32 v150, s51, v154
    v_add_u32 v149, s47, v164
    v_add_u32 v151, s47, v165
    s_add_u32 s51, s51, 16384
    s_cmp_eq_u32 s51, 98304
    s_cselect_b32 s51, 0, s51
    s_waitcnt lgkmcnt(9)
    s_waitcnt lgkmcnt(7)
    v_mfma_f32_16x16x32_bf16 v[0:3], v[64:67], v[96:99], v[0:3]
    ds_read_b64_tr_b16 v[80:81], v144 offset:128
    ds_read_b64_tr_b16 v[82:83], v144 offset:7808
    v_mfma_f32_16x16x32_bf16 v[32:35], v[64:67], v[100:103], v[32:35]
    ds_read_b64_tr_b16 v[120:121], v146 offset:0
    ds_read_b64_tr_b16 v[122:123], v146 offset:7680
    s_waitcnt lgkmcnt(10)
    v_mfma_f32_16x16x32_bf16 v[128:131], v[160:163], v[112:115], v[128:131]
    s_waitcnt lgkmcnt(8)
    v_mfma_f32_16x16x32_bf16 v[4:7], v[68:71], v[96:99], v[4:7]
    ds_read_b64_tr_b16 v[84:85], v144 offset:160
    ds_read_b64_tr_b16 v[86:87], v144 offset:7840
    v_mfma_f32_16x16x32_bf16 v[36:39], v[68:71], v[100:103], v[36:39]
    ds_read_b64_tr_b16 v[124:125], v146 offset:32
    ds_read_b64_tr_b16 v[126:127], v146 offset:7712
    v_mfma_f32_16x16x32_bf16 v[132:135], v[112:115], v[112:115], v[132:135]
    s_waitcnt vmcnt(10)
    s_barrier
    s_waitcnt lgkmcnt(10)
    v_mfma_f32_16x16x32_bf16 v[8:11], v[72:75], v[96:99], v[8:11]
    s_add_u32 m0, s52, 0
    s_nop 0
    buffer_load_dwordx4 v156, s[8:11], s53 offen lds
    s_add_u32 m0, s52, 8192
    s_nop 0
    buffer_load_dwordx4 v157, s[8:11], s53 offen lds
    s_add_u32 s52, s52, 16384
    s_sub_u32 s55, s52, 98304
    s_cmp_ge_u32 s52, 98304
    s_cselect_b32 s52, s55, s52
    ds_read_b64_tr_b16 v[64:65], v148 offset:0
    v_mfma_f32_16x16x32_bf16 v[40:43], v[72:75], v[100:103], v[40:43]
    ds_read_b64_tr_b16 v[66:67], v148 offset:7680
    ds_read_b128 v[104:107], v149 offset:0
    ds_read_b128 v[108:111], v149 offset:2048
    ds_read_b128 v[116:119], v151
    s_waitcnt lgkmcnt(13)
    v_mfma_f32_16x16x32_bf16 v[12:15], v[76:79], v[96:99], v[12:15]
    s_mul_i32 s53, s56, 110592
    s_add_u32 s56, s56, 1
    s_cmp_eq_u32 s56, 20
    s_cselect_b32 s56, 0, s56
    s_add_u32 s57, s57, 1
    s_cmp_ge_u32 s57, 20
    s_cselect_b32 s53, 1073741824, s53
    s_add_u32 m0, s26, 0
    s_nop 0
    buffer_load_dwordx4 v158, s[4:7], s54 offen lds
    v_mfma_f32_16x16x32_bf16 v[44:47], v[76:79], v[100:103], v[44:47]
    ds_read_b64_tr_b16 v[68:69], v148 offset:32
    ds_read_b64_tr_b16 v[70:71], v148 offset:7712
    s_waitcnt lgkmcnt(13)
    v_mfma_f32_16x16x32_bf16 v[16:19], v[80:83], v[96:99], v[16:19]
    s_add_u32 m0, s26, 8192
    s_nop 0
    buffer_load_dwordx4 v159, s[4:7], s54 offen lds
    s_add_u32 s26, s26, 16384
    s_sub_u32 s55, s26, 49152
    s_cmp_ge_u32 s26, 147456
    s_cselect_b32 s26, s55, s26
    v_mfma_f32_16x16x32_bf16 v[48:51], v[80:83], v[100:103], v[48:51]
    ds_read_b64_tr_b16 v[72:73], v148 offset:64
    ds_read_b64_tr_b16 v[74:75], v148 offset:7744
    s_waitcnt lgkmcnt(9)
    v_mfma_f32_16x16x32_bf16 v[136:139], v[120:123], v[160:163], v[136:139]
    v_mfma_f32_16x16x32_bf16 v[20:23], v[84:87], v[96:99], v[20:23]
    s_lshl_b32 s54, s29, 7
    s_add_u32 s29, s29, 1
    s_cmp_eq_u32 s29, 10
    s_cselect_b32 s29, 0, s29
    s_add_u32 s27, s27, 1
    s_cmp_ge_u32 s27, 10
    s_cselect_b32 s54, 1073741824, s54
    v_mfma_f32_16x16x32_bf16 v[52:55], v[84:87], v[100:103], v[52:55]
    ds_read_b64_tr_b16 v[76:77], v148 offset:96
    ds_read_b64_tr_b16 v[78:79], v148 offset:7776
    v_mfma_f32_16x16x32_bf16 v[140:143], v[124:127], v[160:163], v[140:143]
    s_add_u32 s47, s47, 16384
    s_cmp_eq_u32 s47, 49152
    s_cselect_b32 s47, 0, s47
    v_add_u32 v144, s51, v152
    v_add_u32 v146, s51, v154
    v_add_u32 v145, s47, v153
    v_add_u32 v147, s47, v155
    s_add_u32 s51, s51, 16384
    s_cmp_eq_u32 s51, 98304
    s_cselect_b32 s51, 0, s51
    s_waitcnt lgkmcnt(9)
    s_waitcnt lgkmcnt(7)
    v_mfma_f32_16x16x32_bf16 v[0:3], v[64:67], v[104:107], v[0:3]
    ds_read_b64_tr_b16 v[80:81], v148 offset:128
    ds_read_b64_tr_b16 v[82:83], v148 offset:7808
    v_mfma_f32_16x16x32_bf16 v[32:35], v[64:67], v[108:111], v[32:35]
    ds_read_b64_tr_b16 v[120:121], v150 offset:0
    ds_read_b64_tr_b16 v[122:123], v150 offset:7680
    s_waitcnt lgkmcnt(10)
    v_mfma_f32_16x16x32_bf16 v[128:131], v[160:163], v[116:119], v[128:131]
    s_waitcnt lgkmcnt(8)
    v_mfma_f32_16x16x32_bf16 v[4:7], v[68:71], v[104:107], v[4:7]
    ds_read_b64_tr_b16 v[84:85], v148 offset:160
    ds_read_b64_tr_b16 v[86:87], v148 offset:7840
    v_mfma_f32_16x16x32_bf16 v[36:39], v[68:71], v[108:111], v[36:39]
    ds_read_b64_tr_b16 v[124:125], v150 offset:32
    ds_read_b64_tr_b16 v[126:127], v150 offset:7712
    v_mfma_f32_16x16x32_bf16 v[132:135], v[116:119], v[116:119], v[132:135]
    s_waitcnt vmcnt(6)
    s_barrier
    s_waitcnt lgkmcnt(10)
    v_mfma_f32_16x16x32_bf16 v[8:11], v[72:75], v[104:107], v[8:11]
    s_add_u32 m0, s52, 0
    s_nop 0
    buffer_load_dwordx4 v156, s[8:11], s53 offen lds
    s_add_u32 m0, s52, 8192
    s_nop 0
    buffer_load_dwordx4 v157, s[8:11], s53 offen lds
    ds_read_b64_tr_b16 v[64:65], v144 offset:0
    ds_read_b64_tr_b16 v[66:67], v144 offset:7680
    v_mfma_f32_16x16x32_bf16 v[40:43], v[72:75], v[108:111], v[40:43]
    ds_read_b128 v[96:99], v145 offset:0
    ds_read_b128 v[100:103], v145 offset:2048
    ds_read_b128 v[112:115], v147
    s_waitcnt lgkmcnt(13)
    v_mfma_f32_16x16x32_bf16 v[12:15], v[76:79], v[104:107], v[12:15]
    s_add_u32 s52, s52, 16384
    s_sub_u32 s55, s52, 98304
    s_cmp_ge_u32 s52, 98304
    s_cselect_b32 s52, s55, s52
    ds_read_b64_tr_b16 v[68:69], v144 offset:32
    v_mfma_f32_16x16x32_bf16 v[44:47], v[76:79], v[108:111], v[44:47]
    ds_read_b64_tr_b16 v[70:71], v144 offset:7712
    s_waitcnt lgkmcnt(13)
    v_mfma_f32_16x16x32_bf16 v[16:19], v[80:83], v[104:107], v[16:19]
    s_mul_i32 s53, s56, 110592
    s_add_u32 s56, s56, 1
    s_cmp_eq_u32 s56, 20
    s_cselect_b32 s56, 0, s56
    v_mfma_f32_16x16x32_bf16 v[48:51], v[80:83], v[108:111], v[48:51]
    ds_read_b64_tr_b16 v[72:73], v144 offset:64
    s_waitcnt lgkmcnt(8)
    v_mfma_f32_16x16x32_bf16 v[136:139], v[120:123], v[160:163], v[136:139]
    ds_read_b64_tr_b16 v[74:75], v144 offset:7744
    v_mfma_f32_16x16x32_bf16 v[20:23], v[84:87], v[104:107], v[20:23]
    s_add_u32 s57, s57, 1
    s_cmp_ge_u32 s57, 20
    s_cselect_b32 s53, 1073741824, s53
    v_mfma_f32_16x16x32_bf16 v[52:55], v[84:87], v[108:111], v[52:55]
    ds_read_b64_tr_b16 v[76:77], v144 offset:96
    v_mfma_f32_16x16x32_bf16 v[140:143], v[124:127], v[160:163], v[140:143]
    ds_read_b64_tr_b16 v[78:79], v144 offset:7776
    s_add_u32 s50, s50, 2
    s_cmp_lt_u32 s50, 20
    s_cbranch_scc1 K1_loop_f6
    s_waitcnt lgkmcnt(0)
K1_ffn_join:
    s_nop 7
    s_nop 3
    s_lshl_b32 s30, s25, 9
    s_lshl_b32 s31, s24, 7
    s_add_u32 s30, s30, s31
    s_add_u32 s30, s30, 155648
    v_lshl_add_u32 v188, v173, 4, s30
    v_and_b32 v189, 3, v172
    v_cmp_eq_u32 vcc, 1, v189
    s_nop 1
    v_cndmask_b32 v129, v132, v133, vcc
    v_cmp_eq_u32 vcc, 2, v189
    s_nop 1
    v_cndmask_b32 v129, v129, v134, vcc
    v_cmp_eq_u32 vcc, 3, v189
    s_nop 1
    v_cndmask_b32 v129, v129, v135, vcc
    ds_write_b128 v188, v[136:139]
    ds_write_b128 v188, v[140:143] offset:64
    s_lshl_b32 s30, s25, 7
    s_add_u32 s30, s30, 156672
    v_lshl_add_u32 v188, v174, 3, s30
    v_lshrrev_b32 v189, 2, v172
    v_lshlrev_b32 v190, 3, v171
    v_add_u32 v190, 157696, v190
    v_cmp_eq_u32 vcc, v189, v173
    s_nop 1
    v_cndmask_b32 v188, v190, v188, vcc
    ds_write_b64 v188, v[128:129]
    s_waitcnt vmcnt(0) lgkmcnt(0)
    s_barrier
    v_lshlrev_b32 v188, 3, v174
    v_add_u32 v188, 156672, v188
    ds_read_b64 v[128:129], v188
    ds_read_b64 v[130:131], v188 offset:128
    s_lshl_b32 s30, s25, 9
    s_add_u32 s30, s30, 155648
    v_lshl_add_u32 v188, v173, 4, s30
    ds_read_b128 v[64:67], v188 offset:0
    ds_read_b128 v[68:71], v188 offset:64
    ds_read_b128 v[72:75], v188 offset:128
    ds_read_b128 v[76:79], v188 offset:192
    ds_read_b128 v[80:83], v188 offset:256
    ds_read_b128 v[84:87], v188 offset:320
    ds_read_b128 v[88:91], v188 offset:384
    ds_read_b128 v[92:95], v188 offset:448
    s_mov_b32 s8, s60
    s_and_b32 s9, s61, 0xffff
    s_mov_b32 s10, 2211840
    s_mov_b32 s11, 0x20000
    s_mov_b32 s4, s58
    s_and_b32 s5, s59, 0xffff
    s_mov_b32 s6, 819200
    s_mov_b32 s7, 0x20000
    s_lshl_b32 s30, s2, 3
    s_add_u32 s30, s30, s23
    s_mul_i32 s31, s30, 9
    v_add_u32 v228, s31, v171
    v_lshlrev_b32 v228, 7, v228
    v_cmp_gt_u32 vcc, 9, v171
    s_nop 1
    v_cndmask_b32 v228, v209, v228, vcc
    v_lshl_add_u32 v229, s30, 2, v171
    v_lshlrev_b32 v229, 7, v229
    v_cmp_gt_u32 vcc, 4, v171
    s_nop 1
    v_cndmask_b32 v229, v209, v229, vcc
    buffer_load_dword v255, v228, s[8:11], 0 offen
    buffer_load_dword v255, v229, s[4:7], 0 offen
    s_mov_b32 s96, s62
    s_and_b32 s97, s63, 0xffff
    s_mov_b32 s98, 256
    s_mov_b32 s99, 0x20000
    v_mov_b32 v228, 0
    buffer_load_dword v254, v228, s[96:99], 0 offen sc1
    s_mov_b32 s30, 0x3acccccd
    s_mov_b32 s31, 0x3727c5ac
    s_mov_b32 s34, 0x3fb8aa3b
    s_mov_b32 s35, 0xbfb8aa3b
    s_waitcnt lgkmcnt(8)
    v_mul_f32 v128, s30, v128
    v_mul_f32 v129, s30, v129
    v_fma_f32 v129, -v128, v128, v129
    v_max_f32 v129, 0, v129
    v_cvt_pk_bf16_f32 v192, v128, v128
    v_lshlrev_b32 v192, 16, v192
    v_cvt_pk_bf16_f32 v193, v129, v129
    v_lshlrev_b32 v193, 16, v193
    v_add_f32 v193, s31, v193
    v_cvt_pk_bf16_f32 v193, v193, v193
    v_lshlrev_b32 v193, 16, v193
    v_sqrt_f32 v193, v193
    s_nop 0
    v_cvt_pk_bf16_f32 v193, v193, v193
    v_lshlrev_b32 v193, 16, v193
    v_rcp_f32 v96, v193
    s_nop 0
    v_mul_f32 v100, v192, v96
    v_mov_b32 v97, v96
    v_sub_f32 v100, 0, v100
    v_mov_b32 v101, v100
    v_mul_f32 v130, s30, v130
    v_mul_f32 v131, s30, v131
    v_fma_f32 v131, -v130, v130, v131
    v_max_f32 v131, 0, v131
    v_cvt_pk_bf16_f32 v196, v130, v130
    v_lshlrev_b32 v196, 16, v196
    v_cvt_pk_bf16_f32 v197, v131, v131
    v_lshlrev_b32 v197, 16, v197
    v_add_f32 v197, s31, v197
    v_cvt_pk_bf16_f32 v197, v197, v197
    v_lshlrev_b32 v197, 16, v197
    v_sqrt_f32 v197, v197
    s_nop 0
    v_cvt_pk_bf16_f32 v197, v197, v197
    v_lshlrev_b32 v197, 16, v197
    v_rcp_f32 v98, v197
    s_nop 0
    v_mul_f32 v102, v196, v98
    v_mov_b32 v99, v98
    v_sub_f32 v102, 0, v102
    v_mov_b32 v103, v102
    s_lshl_b32 s30, s20, 7
    v_add_u32 v189, s30, v174
    s_lshl_b32 s30, s25, 8
    s_add_u32 s30, s30, 147456
    v_lshl_add_u32 v188, v173, 3, s30
    ds_read_b64 v[112:113], v188 offset:0
    ds_read_b64 v[114:115], v188 offset:32
    ds_read_b64 v[116:117], v188 offset:64
    ds_read_b64 v[118:119], v188 offset:96
    ds_read_b64 v[120:121], v188 offset:128
    ds_read_b64 v[122:123], v188 offset:160
    ds_read_b64 v[124:125], v188 offset:192
    ds_read_b64 v[126:127], v188 offset:224
    v_lshl_add_u32 v190, v173, 11, v189
    v_lshlrev_b32 v190, 4, v190
    s_mul_i32 s36, s21, 7
    s_lshl_b32 s37, s25, 2
    s_add_u32 s36, s36, s37
    s_mov_b32 s33, 0x42200000
    v_mov_b32 v194, 2.0
    v_mov_b32 v195, 2.0
    v_mov_b32 v196, s34
    v_mov_b32 v197, s34
    s_waitcnt lgkmcnt(0)
    s_add_u32 s37, s36, 0
    s_lshl_b32 s38, s37, 17
    s_add_u32 s38, s38, 4194304
    s_cmp_lt_u32 s37, 54
    s_cselect_b32 s38, s38, 1073741824
    v_lshlrev_b32 v198, 16, v112
    v_and_b32 v199, 0xffff0000, v112
    v_lshlrev_b32 v200, 16, v113
    v_and_b32 v201, 0xffff0000, v113
    v_pk_fma_f32 v[202:203], v[64:65], v[100:101], v[198:199]
    v_pk_fma_f32 v[210:211], v[66:67], v[100:101], v[200:201]
    v_pk_fma_f32 v[218:219], v[64:65], v[102:103], v[198:199]
    v_pk_fma_f32 v[226:227], v[66:67], v[102:103], v[200:201]
    v_pk_fma_f32 v[202:203], v[0:1], v[96:97], v[202:203]
    v_pk_fma_f32 v[210:211], v[2:3], v[96:97], v[210:211]
    v_pk_fma_f32 v[218:219], v[32:33], v[98:99], v[218:219]
    v_pk_fma_f32 v[226:227], v[34:35], v[98:99], v[226:227]
    v_pk_mul_f32 v[204:205], v[202:203], v[196:197]
    v_pk_mul_f32 v[212:213], v[210:211], v[196:197]
    v_pk_mul_f32 v[220:221], v[218:219], v[196:197]
    v_pk_mul_f32 v[228:229], v[226:227], v[196:197]
    v_min_f32 v204, s33, v204
    v_min_f32 v205, s33, v205
    v_min_f32 v212, s33, v212
    v_min_f32 v213, s33, v213
    v_min_f32 v220, s33, v220
    v_min_f32 v221, s33, v221
    v_min_f32 v228, s33, v228
    v_min_f32 v229, s33, v229
    v_exp_f32 v204, v204
    v_exp_f32 v205, v205
    v_exp_f32 v212, v212
    v_exp_f32 v213, v213
    v_exp_f32 v220, v220
    v_exp_f32 v221, v221
    v_exp_f32 v228, v228
    v_exp_f32 v229, v229
    v_pk_add_f32 v[206:207], v[204:205], v[194:195]
    v_pk_add_f32 v[214:215], v[212:213], v[194:195]
    v_pk_add_f32 v[222:223], v[220:221], v[194:195]
    v_pk_add_f32 v[230:231], v[228:229], v[194:195]
    v_pk_mul_f32 v[206:207], v[206:207], v[204:205]
    v_pk_mul_f32 v[214:215], v[214:215], v[212:213]
    v_pk_mul_f32 v[222:223], v[222:223], v[220:221]
    v_pk_mul_f32 v[230:231], v[230:231], v[228:229]
    v_pk_add_f32 v[208:209], v[206:207], v[194:195]
    v_pk_add_f32 v[216:217], v[214:215], v[194:195]
    v_pk_add_f32 v[224:225], v[222:223], v[194:195]
    v_pk_add_f32 v[232:233], v[230:231], v[194:195]
    v_rcp_f32 v208, v208
    v_rcp_f32 v209, v209
    v_rcp_f32 v216, v216
    v_rcp_f32 v217, v217
    v_rcp_f32 v224, v224
    v_rcp_f32 v225, v225
    v_rcp_f32 v232, v232
    v_rcp_f32 v233, v233
    v_pk_mul_f32 v[206:207], v[206:207], v[208:209]
    v_pk_mul_f32 v[214:215], v[214:215], v[216:217]
    v_pk_mul_f32 v[222:223], v[222:223], v[224:225]
    v_pk_mul_f32 v[230:231], v[230:231], v[232:233]
    v_pk_mul_f32 v[206:207], v[206:207], v[202:203]
    v_pk_mul_f32 v[214:215], v[214:215], v[210:211]
    v_pk_mul_f32 v[222:223], v[222:223], v[218:219]
    v_pk_mul_f32 v[230:231], v[230:231], v[226:227]
    v_cvt_pk_bf16_f32 v0, v206, v207
    v_cvt_pk_bf16_f32 v1, v214, v215
    v_cvt_pk_bf16_f32 v32, v222, v223
    v_cvt_pk_bf16_f32 v33, v230, v231
    v_lshlrev_b32 v198, 16, v114
    v_and_b32 v199, 0xffff0000, v114
    v_lshlrev_b32 v200, 16, v115
    v_and_b32 v201, 0xffff0000, v115
    v_pk_fma_f32 v[202:203], v[68:69], v[100:101], v[198:199]
    v_pk_fma_f32 v[210:211], v[70:71], v[100:101], v[200:201]
    v_pk_fma_f32 v[218:219], v[68:69], v[102:103], v[198:199]
    v_pk_fma_f32 v[226:227], v[70:71], v[102:103], v[200:201]
    v_pk_fma_f32 v[202:203], v[4:5], v[96:97], v[202:203]
    v_pk_fma_f32 v[210:211], v[6:7], v[96:97], v[210:211]
    v_pk_fma_f32 v[218:219], v[36:37], v[98:99], v[218:219]
    v_pk_fma_f32 v[226:227], v[38:39], v[98:99], v[226:227]
    v_pk_mul_f32 v[204:205], v[202:203], v[196:197]
    v_pk_mul_f32 v[212:213], v[210:211], v[196:197]
    v_pk_mul_f32 v[220:221], v[218:219], v[196:197]
    v_pk_mul_f32 v[228:229], v[226:227], v[196:197]
    v_min_f32 v204, s33, v204
    v_min_f32 v205, s33, v205
    v_min_f32 v212, s33, v212
    v_min_f32 v213, s33, v213
    v_min_f32 v220, s33, v220
    v_min_f32 v221, s33, v221
    v_min_f32 v228, s33, v228
    v_min_f32 v229, s33, v229
    v_exp_f32 v204, v204
    v_exp_f32 v205, v205
    v_exp_f32 v212, v212
    v_exp_f32 v213, v213
    v_exp_f32 v220, v220
    v_exp_f32 v221, v221
    v_exp_f32 v228, v228
    v_exp_f32 v229, v229
    v_pk_add_f32 v[206:207], v[204:205], v[194:195]
    v_pk_add_f32 v[214:215], v[212:213], v[194:195]
    v_pk_add_f32 v[222:223], v[220:221], v[194:195]
    v_pk_add_f32 v[230:231], v[228:229], v[194:195]
    v_pk_mul_f32 v[206:207], v[206:207], v[204:205]
    v_pk_mul_f32 v[214:215], v[214:215], v[212:213]
    v_pk_mul_f32 v[222:223], v[222:223], v[220:221]
    v_pk_mul_f32 v[230:231], v[230:231], v[228:229]
    v_pk_add_f32 v[208:209], v[206:207], v[194:195]
    v_pk_add_f32 v[216:217], v[214:215], v[194:195]
    v_pk_add_f32 v[224:225], v[222:223], v[194:195]
    v_pk_add_f32 v[232:233], v[230:231], v[194:195]
    v_rcp_f32 v208, v208
    v_rcp_f32 v209, v209
    v_rcp_f32 v216, v216
    v_rcp_f32 v217, v217
    v_rcp_f32 v224, v224
    v_rcp_f32 v225, v225
    v_rcp_f32 v232, v232
    v_rcp_f32 v233, v233
    v_pk_mul_f32 v[206:207], v[206:207], v[208:209]
    v_pk_mul_f32 v[214:215], v[214:215], v[216:217]
    v_pk_mul_f32 v[222:223], v[222:223], v[224:225]
    v_pk_mul_f32 v[230:231], v[230:231], v[232:233]
    v_pk_mul_f32 v[206:207], v[206:207], v[202:203]
    v_pk_mul_f32 v[214:215], v[214:215], v[210:211]
    v_pk_mul_f32 v[222:223], v[222:223], v[218:219]
    v_pk_mul_f32 v[230:231], v[230:231], v[226:227]
    v_cvt_pk_bf16_f32 v2, v206, v207
    v_cvt_pk_bf16_f32 v3, v214, v215
    v_cvt_pk_bf16_f32 v34, v222, v223
    v_cvt_pk_bf16_f32 v35, v230, v231
    buffer_store_dwordx4 v[0:3], v190, s[12:15], s38 offen offset:0 sc1
    buffer_store_dwordx4 v[32:35], v190, s[12:15], s38 offen offset:256 sc1
    s_add_u32 s37, s36, 1
    s_lshl_b32 s38, s37, 17
    s_add_u32 s38, s38, 4194304
    s_cmp_lt_u32 s37, 54
    s_cselect_b32 s38, s38, 1073741824
    v_lshlrev_b32 v198, 16, v116
    v_and_b32 v199, 0xffff0000, v116
    v_lshlrev_b32 v200, 16, v117
    v_and_b32 v201, 0xffff0000, v117
    v_pk_fma_f32 v[202:203], v[72:73], v[100:101], v[198:199]
    v_pk_fma_f32 v[210:211], v[74:75], v[100:101], v[200:201]
    v_pk_fma_f32 v[218:219], v[72:73], v[102:103], v[198:199]
    v_pk_fma_f32 v[226:227], v[74:75], v[102:103], v[200:201]
    v_pk_fma_f32 v[202:203], v[8:9], v[96:97], v[202:203]
    v_pk_fma_f32 v[210:211], v[10:11], v[96:97], v[210:211]
    v_pk_fma_f32 v[218:219], v[40:41], v[98:99], v[218:219]
    v_pk_fma_f32 v[226:227], v[42:43], v[98:99], v[226:227]
    v_pk_mul_f32 v[204:205], v[202:203], v[196:197]
    v_pk_mul_f32 v[212:213], v[210:211], v[196:197]
    v_pk_mul_f32 v[220:221], v[218:219], v[196:197]
    v_pk_mul_f32 v[228:229], v[226:227], v[196:197]
    v_min_f32 v204, s33, v204
    v_min_f32 v205, s33, v205
    v_min_f32 v212, s33, v212
    v_min_f32 v213, s33, v213
    v_min_f32 v220, s33, v220
    v_min_f32 v221, s33, v221
    v_min_f32 v228, s33, v228
    v_min_f32 v229, s33, v229
    v_exp_f32 v204, v204
    v_exp_f32 v205, v205
    v_exp_f32 v212, v212
    v_exp_f32 v213, v213
    v_exp_f32 v220, v220
    v_exp_f32 v221, v221
    v_exp_f32 v228, v228
    v_exp_f32 v229, v229
    v_pk_add_f32 v[206:207], v[204:205], v[194:195]
    v_pk_add_f32 v[214:215], v[212:213], v[194:195]
    v_pk_add_f32 v[222:223], v[220:221], v[194:195]
    v_pk_add_f32 v[230:231], v[228:229], v[194:195]
    v_pk_mul_f32 v[206:207], v[206:207], v[204:205]
    v_pk_mul_f32 v[214:215], v[214:215], v[212:213]
    v_pk_mul_f32 v[222:223], v[222:223], v[220:221]
    v_pk_mul_f32 v[230:231], v[230:231], v[228:229]
    v_pk_add_f32 v[208:209], v[206:207], v[194:195]
    v_pk_add_f32 v[216:217], v[214:215], v[194:195]
    v_pk_add_f32 v[224:225], v[222:223], v[194:195]
    v_pk_add_f32 v[232:233], v[230:231], v[194:195]
    v_rcp_f32 v208, v208
    v_rcp_f32 v209, v209
    v_rcp_f32 v216, v216
    v_rcp_f32 v217, v217
    v_rcp_f32 v224, v224
    v_rcp_f32 v225, v225
    v_rcp_f32 v232, v232
    v_rcp_f32 v233, v233
    v_pk_mul_f32 v[206:207], v[206:207], v[208:209]
    v_pk_mul_f32 v[214:215], v[214:215], v[216:217]
    v_pk_mul_f32 v[222:223], v[222:223], v[224:225]
    v_pk_mul_f32 v[230:231], v[230:231], v[232:233]
    v_pk_mul_f32 v[206:207], v[206:207], v[202:203]
    v_pk_mul_f32 v[214:215], v[214:215], v[210:211]
    v_pk_mul_f32 v[222:223], v[222:223], v[218:219]
    v_pk_mul_f32 v[230:231], v[230:231], v[226:227]
    v_cvt_pk_bf16_f32 v8, v206, v207
    v_cvt_pk_bf16_f32 v9, v214, v215
    v_cvt_pk_bf16_f32 v40, v222, v223
    v_cvt_pk_bf16_f32 v41, v230, v231
    v_lshlrev_b32 v198, 16, v118
    v_and_b32 v199, 0xffff0000, v118
    v_lshlrev_b32 v200, 16, v119
    v_and_b32 v201, 0xffff0000, v119
    v_pk_fma_f32 v[202:203], v[76:77], v[100:101], v[198:199]
    v_pk_fma_f32 v[210:211], v[78:79], v[100:101], v[200:201]
    v_pk_fma_f32 v[218:219], v[76:77], v[102:103], v[198:199]
    v_pk_fma_f32 v[226:227], v[78:79], v[102:103], v[200:201]
    v_pk_fma_f32 v[202:203], v[12:13], v[96:97], v[202:203]
    v_pk_fma_f32 v[210:211], v[14:15], v[96:97], v[210:211]
    v_pk_fma_f32 v[218:219], v[44:45], v[98:99], v[218:219]
    v_pk_fma_f32 v[226:227], v[46:47], v[98:99], v[226:227]
    v_pk_mul_f32 v[204:205], v[202:203], v[196:197]
    v_pk_mul_f32 v[212:213], v[210:211], v[196:197]
    v_pk_mul_f32 v[220:221], v[218:219], v[196:197]
    v_pk_mul_f32 v[228:229], v[226:227], v[196:197]
    v_min_f32 v204, s33, v204
    v_min_f32 v205, s33, v205
    v_min_f32 v212, s33, v212
    v_min_f32 v213, s33, v213
    v_min_f32 v220, s33, v220
    v_min_f32 v221, s33, v221
    v_min_f32 v228, s33, v228
    v_min_f32 v229, s33, v229
    v_exp_f32 v204, v204
    v_exp_f32 v205, v205
    v_exp_f32 v212, v212
    v_exp_f32 v213, v213
    v_exp_f32 v220, v220
    v_exp_f32 v221, v221
    v_exp_f32 v228, v228
    v_exp_f32 v229, v229
    v_pk_add_f32 v[206:207], v[204:205], v[194:195]
    v_pk_add_f32 v[214:215], v[212:213], v[194:195]
    v_pk_add_f32 v[222:223], v[220:221], v[194:195]
    v_pk_add_f32 v[230:231], v[228:229], v[194:195]
    v_pk_mul_f32 v[206:207], v[206:207], v[204:205]
    v_pk_mul_f32 v[214:215], v[214:215], v[212:213]
    v_pk_mul_f32 v[222:223], v[222:223], v[220:221]
    v_pk_mul_f32 v[230:231], v[230:231], v[228:229]
    v_pk_add_f32 v[208:209], v[206:207], v[194:195]
    v_pk_add_f32 v[216:217], v[214:215], v[194:195]
    v_pk_add_f32 v[224:225], v[222:223], v[194:195]
    v_pk_add_f32 v[232:233], v[230:231], v[194:195]
    v_rcp_f32 v208, v208
    v_rcp_f32 v209, v209
    v_rcp_f32 v216, v216
    v_rcp_f32 v217, v217
    v_rcp_f32 v224, v224
    v_rcp_f32 v225, v225
    v_rcp_f32 v232, v232
    v_rcp_f32 v233, v233
    v_pk_mul_f32 v[206:207], v[206:207], v[208:209]
    v_pk_mul_f32 v[214:215], v[214:215], v[216:217]
    v_pk_mul_f32 v[222:223], v[222:223], v[224:225]
    v_pk_mul_f32 v[230:231], v[230:231], v[232:233]
    v_pk_mul_f32 v[206:207], v[206:207], v[202:203]
    v_pk_mul_f32 v[214:215], v[214:215], v[210:211]
    v_pk_mul_f32 v[222:223], v[222:223], v[218:219]
    v_pk_mul_f32 v[230:231], v[230:231], v[226:227]
    v_cvt_pk_bf16_f32 v10, v206, v207
    v_cvt_pk_bf16_f32 v11, v214, v215
    v_cvt_pk_bf16_f32 v42, v222, v223
    v_cvt_pk_bf16_f32 v43, v230, v231
    buffer_store_dwordx4 v[8:11], v190, s[12:15], s38 offen offset:0 sc1
    buffer_store_dwordx4 v[40:43], v190, s[12:15], s38 offen offset:256 sc1
    s_add_u32 s37, s36, 2
    s_lshl_b32 s38, s37, 17
    s_add_u32 s38, s38, 4194304
    s_cmp_lt_u32 s37, 54
    s_cselect_b32 s38, s38, 1073741824
    v_lshlrev_b32 v198, 16, v120
    v_and_b32 v199, 0xffff0000, v120
    v_lshlrev_b32 v200, 16, v121
    v_and_b32 v201, 0xffff0000, v121
    v_pk_fma_f32 v[202:203], v[80:81], v[100:101], v[198:199]
    v_pk_fma_f32 v[210:211], v[82:83], v[100:101], v[200:201]
    v_pk_fma_f32 v[218:219], v[80:81], v[102:103], v[198:199]
    v_pk_fma_f32 v[226:227], v[82:83], v[102:103], v[200:201]
    v_pk_fma_f32 v[202:203], v[16:17], v[96:97], v[202:203]
    v_pk_fma_f32 v[210:211], v[18:19], v[96:97], v[210:211]
    v_pk_fma_f32 v[218:219], v[48:49], v[98:99], v[218:219]
    v_pk_fma_f32 v[226:227], v[50:51], v[98:99], v[226:227]
    v_pk_mul_f32 v[204:205], v[202:203], v[196:197]
    v_pk_mul_f32 v[212:213], v[210:211], v[196:197]
    v_pk_mul_f32 v[220:221], v[218:219], v[196:197]
    v_pk_mul_f32 v[228:229], v[226:227], v[196:197]
    v_min_f32 v204, s33, v204
    v_min_f32 v205, s33, v205
    v_min_f32 v212, s33, v212
    v_min_f32 v213, s33, v213
    v_min_f32 v220, s33, v220
    v_min_f32 v221, s33, v221
    v_min_f32 v228, s33, v228
    v_min_f32 v229, s33, v229
    v_exp_f32 v204, v204
    v_exp_f32 v205, v205
    v_exp_f32 v212, v212
    v_exp_f32 v213, v213
    v_exp_f32 v220, v220
    v_exp_f32 v221, v221
    v_exp_f32 v228, v228
    v_exp_f32 v229, v229
    v_pk_add_f32 v[206:207], v[204:205], v[194:195]
    v_pk_add_f32 v[214:215], v[212:213], v[194:195]
    v_pk_add_f32 v[222:223], v[220:221], v[194:195]
    v_pk_add_f32 v[230:231], v[228:229], v[194:195]
    v_pk_mul_f32 v[206:207], v[206:207], v[204:205]
    v_pk_mul_f32 v[214:215], v[214:215], v[212:213]
    v_pk_mul_f32 v[222:223], v[222:223], v[220:221]
    v_pk_mul_f32 v[230:231], v[230:231], v[228:229]
    v_pk_add_f32 v[208:209], v[206:207], v[194:195]
    v_pk_add_f32 v[216:217], v[214:215], v[194:195]
    v_pk_add_f32 v[224:225], v[222:223], v[194:195]
    v_pk_add_f32 v[232:233], v[230:231], v[194:195]
    v_rcp_f32 v208, v208
    v_rcp_f32 v209, v209
    v_rcp_f32 v216, v216
    v_rcp_f32 v217, v217
    v_rcp_f32 v224, v224
    v_rcp_f32 v225, v225
    v_rcp_f32 v232, v232
    v_rcp_f32 v233, v233
    v_pk_mul_f32 v[206:207], v[206:207], v[208:209]
    v_pk_mul_f32 v[214:215], v[214:215], v[216:217]
    v_pk_mul_f32 v[222:223], v[222:223], v[224:225]
    v_pk_mul_f32 v[230:231], v[230:231], v[232:233]
    v_pk_mul_f32 v[206:207], v[206:207], v[202:203]
    v_pk_mul_f32 v[214:215], v[214:215], v[210:211]
    v_pk_mul_f32 v[222:223], v[222:223], v[218:219]
    v_pk_mul_f32 v[230:231], v[230:231], v[226:227]
    v_cvt_pk_bf16_f32 v16, v206, v207
    v_cvt_pk_bf16_f32 v17, v214, v215
    v_cvt_pk_bf16_f32 v48, v222, v223
    v_cvt_pk_bf16_f32 v49, v230, v231
    v_lshlrev_b32 v198, 16, v122
    v_and_b32 v199, 0xffff0000, v122
    v_lshlrev_b32 v200, 16, v123
    v_and_b32 v201, 0xffff0000, v123
    v_pk_fma_f32 v[202:203], v[84:85], v[100:101], v[198:199]
    v_pk_fma_f32 v[210:211], v[86:87], v[100:101], v[200:201]
    v_pk_fma_f32 v[218:219], v[84:85], v[102:103], v[198:199]
    v_pk_fma_f32 v[226:227], v[86:87], v[102:103], v[200:201]
    v_pk_fma_f32 v[202:203], v[20:21], v[96:97], v[202:203]
    v_pk_fma_f32 v[210:211], v[22:23], v[96:97], v[210:211]
    v_pk_fma_f32 v[218:219], v[52:53], v[98:99], v[218:219]
    v_pk_fma_f32 v[226:227], v[54:55], v[98:99], v[226:227]
    v_pk_mul_f32 v[204:205], v[202:203], v[196:197]
    v_pk_mul_f32 v[212:213], v[210:211], v[196:197]
    v_pk_mul_f32 v[220:221], v[218:219], v[196:197]
    v_pk_mul_f32 v[228:229], v[226:227], v[196:197]
    v_min_f32 v204, s33, v204
    v_min_f32 v205, s33, v205
    v_min_f32 v212, s33, v212
    v_min_f32 v213, s33, v213
    v_min_f32 v220, s33, v220
    v_min_f32 v221, s33, v221
    v_min_f32 v228, s33, v228
    v_min_f32 v229, s33, v229
    v_exp_f32 v204, v204
    v_exp_f32 v205, v205
    v_exp_f32 v212, v212
    v_exp_f32 v213, v213
    v_exp_f32 v220, v220
    v_exp_f32 v221, v221
    v_exp_f32 v228, v228
    v_exp_f32 v229, v229
    v_pk_add_f32 v[206:207], v[204:205], v[194:195]
    v_pk_add_f32 v[214:215], v[212:213], v[194:195]
    v_pk_add_f32 v[222:223], v[220:221], v[194:195]
    v_pk_add_f32 v[230:231], v[228:229], v[194:195]
    v_pk_mul_f32 v[206:207], v[206:207], v[204:205]
    v_pk_mul_f32 v[214:215], v[214:215], v[212:213]
    v_pk_mul_f32 v[222:223], v[222:223], v[220:221]
    v_pk_mul_f32 v[230:231], v[230:231], v[228:229]
    v_pk_add_f32 v[208:209], v[206:207], v[194:195]
    v_pk_add_f32 v[216:217], v[214:215], v[194:195]
    v_pk_add_f32 v[224:225], v[222:223], v[194:195]
    v_pk_add_f32 v[232:233], v[230:231], v[194:195]
    v_rcp_f32 v208, v208
    v_rcp_f32 v209, v209
    v_rcp_f32 v216, v216
    v_rcp_f32 v217, v217
    v_rcp_f32 v224, v224
    v_rcp_f32 v225, v225
    v_rcp_f32 v232, v232
    v_rcp_f32 v233, v233
    v_pk_mul_f32 v[206:207], v[206:207], v[208:209]
    v_pk_mul_f32 v[214:215], v[214:215], v[216:217]
    v_pk_mul_f32 v[222:223], v[222:223], v[224:225]
    v_pk_mul_f32 v[230:231], v[230:231], v[232:233]
    v_pk_mul_f32 v[206:207], v[206:207], v[202:203]
    v_pk_mul_f32 v[214:215], v[214:215], v[210:211]
    v_pk_mul_f32 v[222:223], v[222:223], v[218:219]
    v_pk_mul_f32 v[230:231], v[230:231], v[226:227]
    v_cvt_pk_bf16_f32 v18, v206, v207
    v_cvt_pk_bf16_f32 v19, v214, v215
    v_cvt_pk_bf16_f32 v50, v222, v223
    v_cvt_pk_bf16_f32 v51, v230, v231
    buffer_store_dwordx4 v[16:19], v190, s[12:15], s38 offen offset:0 sc1
    buffer_store_dwordx4 v[48:51], v190, s[12:15], s38 offen offset:256 sc1
    s_cmp_eq_u32 s25, 1
    s_cbranch_scc1 K1_ffn_done
    s_add_u32 s37, s36, 3
    s_lshl_b32 s38, s37, 17
    s_add_u32 s38, s38, 4194304
    s_cmp_lt_u32 s37, 54
    s_cselect_b32 s38, s38, 1073741824
    v_lshlrev_b32 v198, 16, v124
    v_and_b32 v199, 0xffff0000, v124
    v_lshlrev_b32 v200, 16, v125
    v_and_b32 v201, 0xffff0000, v125
    v_pk_fma_f32 v[202:203], v[88:89], v[100:101], v[198:199]
    v_pk_fma_f32 v[210:211], v[90:91], v[100:101], v[200:201]
    v_pk_fma_f32 v[218:219], v[88:89], v[102:103], v[198:199]
    v_pk_fma_f32 v[226:227], v[90:91], v[102:103], v[200:201]
    v_pk_fma_f32 v[202:203], v[24:25], v[96:97], v[202:203]
    v_pk_fma_f32 v[210:211], v[26:27], v[96:97], v[210:211]
    v_pk_fma_f32 v[218:219], v[56:57], v[98:99], v[218:219]
    v_pk_fma_f32 v[226:227], v[58:59], v[98:99], v[226:227]
    v_pk_mul_f32 v[204:205], v[202:203], v[196:197]
    v_pk_mul_f32 v[212:213], v[210:211], v[196:197]
    v_pk_mul_f32 v[220:221], v[218:219], v[196:197]
    v_pk_mul_f32 v[228:229], v[226:227], v[196:197]
    v_min_f32 v204, s33, v204
    v_min_f32 v205, s33, v205
    v_min_f32 v212, s33, v212
    v_min_f32 v213, s33, v213
    v_min_f32 v220, s33, v220
    v_min_f32 v221, s33, v221
    v_min_f32 v228, s33, v228
    v_min_f32 v229, s33, v229
    v_exp_f32 v204, v204
    v_exp_f32 v205, v205
    v_exp_f32 v212, v212
    v_exp_f32 v213, v213
    v_exp_f32 v220, v220
    v_exp_f32 v221, v221
    v_exp_f32 v228, v228
    v_exp_f32 v229, v229
    v_pk_add_f32 v[206:207], v[204:205], v[194:195]
    v_pk_add_f32 v[214:215], v[212:213], v[194:195]
    v_pk_add_f32 v[222:223], v[220:221], v[194:195]
    v_pk_add_f32 v[230:231], v[228:229], v[194:195]
    v_pk_mul_f32 v[206:207], v[206:207], v[204:205]
    v_pk_mul_f32 v[214:215], v[214:215], v[212:213]
    v_pk_mul_f32 v[222:223], v[222:223], v[220:221]
    v_pk_mul_f32 v[230:231], v[230:231], v[228:229]
    v_pk_add_f32 v[208:209], v[206:207], v[194:195]
    v_pk_add_f32 v[216:217], v[214:215], v[194:195]
    v_pk_add_f32 v[224:225], v[222:223], v[194:195]
    v_pk_add_f32 v[232:233], v[230:231], v[194:195]
    v_rcp_f32 v208, v208
    v_rcp_f32 v209, v209
    v_rcp_f32 v216, v216
    v_rcp_f32 v217, v217
    v_rcp_f32 v224, v224
    v_rcp_f32 v225, v225
    v_rcp_f32 v232, v232
    v_rcp_f32 v233, v233
    v_pk_mul_f32 v[206:207], v[206:207], v[208:209]
    v_pk_mul_f32 v[214:215], v[214:215], v[216:217]
    v_pk_mul_f32 v[222:223], v[222:223], v[224:225]
    v_pk_mul_f32 v[230:231], v[230:231], v[232:233]
    v_pk_mul_f32 v[206:207], v[206:207], v[202:203]
    v_pk_mul_f32 v[214:215], v[214:215], v[210:211]
    v_pk_mul_f32 v[222:223], v[222:223], v[218:219]
    v_pk_mul_f32 v[230:231], v[230:231], v[226:227]
    v_cvt_pk_bf16_f32 v24, v206, v207
    v_cvt_pk_bf16_f32 v25, v214, v215
    v_cvt_pk_bf16_f32 v56, v222, v223
    v_cvt_pk_bf16_f32 v57, v230, v231
    v_lshlrev_b32 v198, 16, v126
    v_and_b32 v199, 0xffff0000, v126
    v_lshlrev_b32 v200, 16, v127
    v_and_b32 v201, 0xffff0000, v127
    v_pk_fma_f32 v[202:203], v[92:93], v[100:101], v[198:199]
    v_pk_fma_f32 v[210:211], v[94:95], v[100:101], v[200:201]
    v_pk_fma_f32 v[218:219], v[92:93], v[102:103], v[198:199]
    v_pk_fma_f32 v[226:227], v[94:95], v[102:103], v[200:201]
    v_pk_fma_f32 v[202:203], v[28:29], v[96:97], v[202:203]
    v_pk_fma_f32 v[210:211], v[30:31], v[96:97], v[210:211]
    v_pk_fma_f32 v[218:219], v[60:61], v[98:99], v[218:219]
    v_pk_fma_f32 v[226:227], v[62:63], v[98:99], v[226:227]
    v_pk_mul_f32 v[204:205], v[202:203], v[196:197]
    v_pk_mul_f32 v[212:213], v[210:211], v[196:197]
    v_pk_mul_f32 v[220:221], v[218:219], v[196:197]
    v_pk_mul_f32 v[228:229], v[226:227], v[196:197]
    v_min_f32 v204, s33, v204
    v_min_f32 v205, s33, v205
    v_min_f32 v212, s33, v212
    v_min_f32 v213, s33, v213
    v_min_f32 v220, s33, v220
    v_min_f32 v221, s33, v221
    v_min_f32 v228, s33, v228
    v_min_f32 v229, s33, v229
    v_exp_f32 v204, v204
    v_exp_f32 v205, v205
    v_exp_f32 v212, v212
    v_exp_f32 v213, v213
    v_exp_f32 v220, v220
    v_exp_f32 v221, v221
    v_exp_f32 v228, v228
    v_exp_f32 v229, v229
    v_pk_add_f32 v[206:207], v[204:205], v[194:195]
    v_pk_add_f32 v[214:215], v[212:213], v[194:195]
    v_pk_add_f32 v[222:223], v[220:221], v[194:195]
    v_pk_add_f32 v[230:231], v[228:229], v[194:195]
    v_pk_mul_f32 v[206:207], v[206:207], v[204:205]
    v_pk_mul_f32 v[214:215], v[214:215], v[212:213]
    v_pk_mul_f32 v[222:223], v[222:223], v[220:221]
    v_pk_mul_f32 v[230:231], v[230:231], v[228:229]
    v_pk_add_f32 v[208:209], v[206:207], v[194:195]
    v_pk_add_f32 v[216:217], v[214:215], v[194:195]
    v_pk_add_f32 v[224:225], v[222:223], v[194:195]
    v_pk_add_f32 v[232:233], v[230:231], v[194:195]
    v_rcp_f32 v208, v208
    v_rcp_f32 v209, v209
    v_rcp_f32 v216, v216
    v_rcp_f32 v217, v217
    v_rcp_f32 v224, v224
    v_rcp_f32 v225, v225
    v_rcp_f32 v232, v232
    v_rcp_f32 v233, v233
    v_pk_mul_f32 v[206:207], v[206:207], v[208:209]
    v_pk_mul_f32 v[214:215], v[214:215], v[216:217]
    v_pk_mul_f32 v[222:223], v[222:223], v[224:225]
    v_pk_mul_f32 v[230:231], v[230:231], v[232:233]
    v_pk_mul_f32 v[206:207], v[206:207], v[202:203]
    v_pk_mul_f32 v[214:215], v[214:215], v[210:211]
    v_pk_mul_f32 v[222:223], v[222:223], v[218:219]
    v_pk_mul_f32 v[230:231], v[230:231], v[226:227]
    v_cvt_pk_bf16_f32 v26, v206, v207
    v_cvt_pk_bf16_f32 v27, v214, v215
    v_cvt_pk_bf16_f32 v58, v222, v223
    v_cvt_pk_bf16_f32 v59, v230, v231
    buffer_store_dwordx4 v[24:27], v190, s[12:15], s38 offen offset:0 sc1
    buffer_store_dwordx4 v[56:59], v190, s[12:15], s38 offen offset:256 sc1
K1_ffn_done:
    s_lshl_b32 s30, s20, 8
    s_add_u32 s30, s30, 17043456
    s_branch KM_join
K1_exit:
    s_endpgm
KM_join:
    s_nop 7
    s_nop 3
    s_mov_b32 s95, 200000
    s_waitcnt vmcnt(0) lgkmcnt(0)
    v_lshl_add_u32 v0, s23, 6, v171
    s_cmp_lg_u32 s23, 0
    s_cbranch_scc1 KM_hsok
    v_mov_b32 v4, 0
KM_hs:
    v_readfirstlane_b32 s31, v254
    s_cmp_eq_u32 s31, 1
    s_cbranch_scc1 KM_hsok
    s_sleep 8
    s_sub_u32 s95, s95, 1
    s_cbranch_scc1 K1_exit
    buffer_load_dword v254, v4, s[96:99], 0 offen sc1
    s_waitcnt vmcnt(0)
    s_branch KM_hs
KM_hsok:
    s_barrier
    s_cmp_lg_u32 s23, 0
    s_cbranch_scc1 KM_nosig
    s_mov_b64 exec, 1
    v_mov_b32 v4, 1
    v_mov_b32 v5, s30
    buffer_atomic_add v4, v5, s[12:15], 0 offen sc1
    s_mov_b64 exec, -1
KM_nosig:
    s_cmp_ge_u32 s2, 256
    s_cbranch_scc1 K2_exit
    s_load_dwordx2 s[38:39], s[0:1], 0
    s_load_dwordx4 s[52:55], s[0:1], 16
    s_load_dwordx4 s[40:43], s[0:1], 56
    s_load_dwordx4 s[44:47], s[0:1], 72
    s_and_b32 s30, s2, 7
    s_lshr_b32 s31, s2, 3
    s_lshr_b32 s20, s30, 1
    s_lshl_b32 s20, s20, 3
    s_and_b32 s33, s31, 7
    s_add_u32 s20, s20, s33
    s_and_b32 s21, s30, 1
    s_lshl_b32 s21, s21, 2
    s_lshr_b32 s33, s31, 3
    s_add_u32 s21, s21, s33
    s_and_b32 s58, s2, 15
    s_lshr_b32 s59, s2, 4
    v_and_b32 v243, 63, v0
    v_lshrrev_b32 v160, 6, v0
    s_nop 0
    v_readfirstlane_b32 s23, v160
    s_mul_i32 s28, s23, 36864
    s_mul_i32 s32, s21, 160
    s_waitcnt lgkmcnt(0)
    s_mov_b32 s4, s46
    s_and_b32 s5, s47, 0xffff
    s_mov_b32 s6, 21250048
    s_mov_b32 s7, 0x20000
    s_mov_b32 s12, s38
    s_and_b32 s13, s39, 0xffff
    s_mov_b32 s14, 2621440
    s_mov_b32 s15, 0x20000
    s_mov_b32 s16, s42
    s_and_b32 s17, s43, 0xffff
    s_mov_b32 s18, 2621440
    s_mov_b32 s19, 0x20000
    s_mov_b32 s60, s52
    s_and_b32 s61, s53, 0xffff
    s_mov_b32 s62, 25600
    s_mov_b32 s63, 0x20000
    s_mov_b32 s96, s44
    s_and_b32 s97, s45, 0xffff
    s_mov_b32 s98, 256
    s_mov_b32 s99, 0x20000
    s_mov_b32 s8, s40
    s_and_b32 s9, s41, 0xffff
    s_mov_b32 s10, 2211840
    s_mov_b32 s11, 0x20000
    s_mov_b32 s48, s54
    s_and_b32 s49, s55, 0xffff
    s_mov_b32 s50, 819200
    s_mov_b32 s51, 0x20000
    v_mov_b32 v160, 159744
    v_mov_b32 v161, 0
    ds_write_b32 v160, v161
    s_waitcnt lgkmcnt(0)
    s_barrier
    s_cmp_ge_u32 s23, 4
    s_cbranch_scc1 K2_ko
    s_mul_i32 s24, s23, 14
    s_cmp_eq_u32 s23, 3
    s_cselect_b32 s30, 1, 0
    s_sub_u32 s24, s24, s30
    s_cmp_lt_u32 s23, 2
    s_cselect_b32 s25, 14, 13
    s_mul_i32 s26, s24, 40960
    s_lshl_b32 s29, s24, 17
    s_add_u32 s29, s29, 4194304
    s_lshl_b32 s56, s21, 2
    s_add_u32 s56, s56, s20
    s_and_b32 s56, s56, 31
    s_mul_i32 s56, s56, 13
    s_lshr_b32 s56, s56, 5
    s_lshl_b32 s31, s20, 6
    v_add_u32 v246, s31, v243
    v_lshlrev_b32 v246, 4, v246
    v_add_u32 v161, 0, v243
    v_mul_u32_u24 v162, 205, v161
    v_lshrrev_b32 v162, 11, v162
    v_mul_u32_u24 v163, 10, v162
    v_sub_u32 v163, v161, v163
    v_mul_u32_u24 v164, 1280, v162
    v_lshl_add_u32 v164, v163, 4, v164
    v_add_u32 v247, s32, v164
    v_add_u32 v161, 64, v243
    v_mul_u32_u24 v162, 205, v161
    v_lshrrev_b32 v162, 11, v162
    v_mul_u32_u24 v163, 10, v162
    v_sub_u32 v163, v161, v163
    v_mul_u32_u24 v164, 1280, v162
    v_lshl_add_u32 v164, v163, 4, v164
    v_add_u32 v248, s32, v164
    v_add_u32 v161, 128, v243
    v_mul_u32_u24 v162, 205, v161
    v_lshrrev_b32 v162, 11, v162
    v_mul_u32_u24 v163, 10, v162
    v_sub_u32 v163, v161, v163
    v_mul_u32_u24 v164, 1280, v162
    v_lshl_add_u32 v164, v163, 4, v164
    v_add_u32 v249, s32, v164
    v_add_u32 v161, 192, v243
    v_mul_u32_u24 v162, 205, v161
    v_lshrrev_b32 v162, 11, v162
    v_mul_u32_u24 v163, 10, v162
    v_sub_u32 v163, v161, v163
    v_mul_u32_u24 v164, 1280, v162
    v_lshl_add_u32 v164, v163, 4, v164
    v_add_u32 v250, s32, v164
    v_add_u32 v161, 256, v243
    v_mul_u32_u24 v162, 205, v161
    v_lshrrev_b32 v162, 11, v162
    v_mul_u32_u24 v163, 10, v162
    v_sub_u32 v163, v161, v163
    v_mul_u32_u24 v164, 1280, v162
    v_lshl_add_u32 v164, v163, 4, v164
    v_add_u32 v251, s32, v164
    v_and_b32 v243, 63, v0
    v_and_b32 v244, 15, v0
    v_bfe_u32 v245, v0, 4, 2
    v_lshrrev_b32 v161, 2, v244
    v_lshl_add_u32 v161, v245, 2, v161
    v_mul_u32_u24 v161, 160, v161
    v_and_b32 v162, 3, v244
    v_lshl_add_u32 v161, v162, 3, v161
    v_add_u32 v241, s28, v161
    v_lshlrev_b32 v161, 4, v244
    v_lshl_add_u32 v161, v245, 10, v161
    v_add_u32 v242, s28, v161
    v_mov_b32 v252, v0
    v_add_u32 v161, 0, v243
    v_mul_u32_u24 v162, 205, v161
    v_lshrrev_b32 v162, 11, v162
    v_mul_u32_u24 v163, 10, v162
    v_sub_u32 v163, v161, v163
    v_lshl_add_u32 v163, v163, 4, s32
    v_bfe_u32 v164, v162, 2, 2
    v_lshrrev_b32 v165, 4, v162
    v_mul_u32_u24 v165, 20, v165
    v_and_b32 v166, 3, v162
    v_add_u32 v165, v165, v166
    v_add_u32 v167, 0, v164
    v_mul_u32_u24 v168, 52, v167
    v_lshrrev_b32 v168, 8, v168
    v_mul_u32_u24 v169, 5, v168
    v_sub_u32 v169, v167, v169
    v_mul_u32_u24 v168, 40, v168
    v_lshl_add_u32 v168, v169, 2, v168
    v_add_u32 v168, v168, v165
    v_mul_u32_u24 v168, 1280, v168
    v_add_u32 v216, v168, v163
    v_add_u32 v167, 4, v164
    v_mul_u32_u24 v168, 52, v167
    v_lshrrev_b32 v168, 8, v168
    v_mul_u32_u24 v169, 5, v168
    v_sub_u32 v169, v167, v169
    v_mul_u32_u24 v168, 40, v168
    v_lshl_add_u32 v168, v169, 2, v168
    v_add_u32 v168, v168, v165
    v_mul_u32_u24 v168, 1280, v168
    v_add_u32 v221, v168, v163
    v_add_u32 v167, 8, v164
    v_mul_u32_u24 v168, 52, v167
    v_lshrrev_b32 v168, 8, v168
    v_mul_u32_u24 v169, 5, v168
    v_sub_u32 v169, v167, v169
    v_mul_u32_u24 v168, 40, v168
    v_lshl_add_u32 v168, v169, 2, v168
    v_add_u32 v168, v168, v165
    v_mul_u32_u24 v168, 1280, v168
    v_add_u32 v226, v168, v163
    v_add_u32 v167, 12, v164
    v_mul_u32_u24 v168, 52, v167
    v_lshrrev_b32 v168, 8, v168
    v_mul_u32_u24 v169, 5, v168
    v_sub_u32 v169, v167, v169
    v_mul_u32_u24 v168, 40, v168
    v_lshl_add_u32 v168, v169, 2, v168
    v_add_u32 v168, v168, v165
    v_mul_u32_u24 v168, 1280, v168
    v_add_u32 v231, v168, v163
    v_add_u32 v167, 16, v164
    v_mul_u32_u24 v168, 52, v167
    v_lshrrev_b32 v168, 8, v168
    v_mul_u32_u24 v169, 5, v168
    v_sub_u32 v169, v167, v169
    v_mul_u32_u24 v168, 40, v168
    v_lshl_add_u32 v168, v169, 2, v168
    v_add_u32 v168, v168, v165
    v_mul_u32_u24 v168, 1280, v168
    v_add_u32 v236, v168, v163
    v_add_u32 v161, 64, v243
    v_mul_u32_u24 v162, 205, v161
    v_lshrrev_b32 v162, 11, v162
    v_mul_u32_u24 v163, 10, v162
    v_sub_u32 v163, v161, v163
    v_lshl_add_u32 v163, v163, 4, s32
    v_bfe_u32 v164, v162, 2, 2
    v_lshrrev_b32 v165, 4, v162
    v_mul_u32_u24 v165, 20, v165
    v_and_b32 v166, 3, v162
    v_add_u32 v165, v165, v166
    v_add_u32 v167, 0, v164
    v_mul_u32_u24 v168, 52, v167
    v_lshrrev_b32 v168, 8, v168
    v_mul_u32_u24 v169, 5, v168
    v_sub_u32 v169, v167, v169
    v_mul_u32_u24 v168, 40, v168
    v_lshl_add_u32 v168, v169, 2, v168
    v_add_u32 v168, v168, v165
    v_mul_u32_u24 v168, 1280, v168
    v_add_u32 v217, v168, v163
    v_add_u32 v167, 4, v164
    v_mul_u32_u24 v168, 52, v167
    v_lshrrev_b32 v168, 8, v168
    v_mul_u32_u24 v169, 5, v168
    v_sub_u32 v169, v167, v169
    v_mul_u32_u24 v168, 40, v168
    v_lshl_add_u32 v168, v169, 2, v168
    v_add_u32 v168, v168, v165
    v_mul_u32_u24 v168, 1280, v168
    v_add_u32 v222, v168, v163
    v_add_u32 v167, 8, v164
    v_mul_u32_u24 v168, 52, v167
    v_lshrrev_b32 v168, 8, v168
    v_mul_u32_u24 v169, 5, v168
    v_sub_u32 v169, v167, v169
    v_mul_u32_u24 v168, 40, v168
    v_lshl_add_u32 v168, v169, 2, v168
    v_add_u32 v168, v168, v165
    v_mul_u32_u24 v168, 1280, v168
    v_add_u32 v227, v168, v163
    v_add_u32 v167, 12, v164
    v_mul_u32_u24 v168, 52, v167
    v_lshrrev_b32 v168, 8, v168
    v_mul_u32_u24 v169, 5, v168
    v_sub_u32 v169, v167, v169
    v_mul_u32_u24 v168, 40, v168
    v_lshl_add_u32 v168, v169, 2, v168
    v_add_u32 v168, v168, v165
    v_mul_u32_u24 v168, 1280, v168
    v_add_u32 v232, v168, v163
    v_add_u32 v167, 16, v164
    v_mul_u32_u24 v168, 52, v167
    v_lshrrev_b32 v168, 8, v168
    v_mul_u32_u24 v169, 5, v168
    v_sub_u32 v169, v167, v169
    v_mul_u32_u24 v168, 40, v168
    v_lshl_add_u32 v168, v169, 2, v168
    v_add_u32 v168, v168, v165
    v_mul_u32_u24 v168, 1280, v168
    v_add_u32 v237, v168, v163
    v_add_u32 v161, 128, v243
    v_mul_u32_u24 v162, 205, v161
    v_lshrrev_b32 v162, 11, v162
    v_mul_u32_u24 v163, 10, v162
    v_sub_u32 v163, v161, v163
    v_lshl_add_u32 v163, v163, 4, s32
    v_bfe_u32 v164, v162, 2, 2
    v_lshrrev_b32 v165, 4, v162
    v_mul_u32_u24 v165, 20, v165
    v_and_b32 v166, 3, v162
    v_add_u32 v165, v165, v166
    v_add_u32 v167, 0, v164
    v_mul_u32_u24 v168, 52, v167
    v_lshrrev_b32 v168, 8, v168
    v_mul_u32_u24 v169, 5, v168
    v_sub_u32 v169, v167, v169
    v_mul_u32_u24 v168, 40, v168
    v_lshl_add_u32 v168, v169, 2, v168
    v_add_u32 v168, v168, v165
    v_mul_u32_u24 v168, 1280, v168
    v_add_u32 v218, v168, v163
    v_add_u32 v167, 4, v164
    v_mul_u32_u24 v168, 52, v167
    v_lshrrev_b32 v168, 8, v168
    v_mul_u32_u24 v169, 5, v168
    v_sub_u32 v169, v167, v169
    v_mul_u32_u24 v168, 40, v168
    v_lshl_add_u32 v168, v169, 2, v168
    v_add_u32 v168, v168, v165
    v_mul_u32_u24 v168, 1280, v168
    v_add_u32 v223, v168, v163
    v_add_u32 v167, 8, v164
    v_mul_u32_u24 v168, 52, v167
    v_lshrrev_b32 v168, 8, v168
    v_mul_u32_u24 v169, 5, v168
    v_sub_u32 v169, v167, v169
    v_mul_u32_u24 v168, 40, v168
    v_lshl_add_u32 v168, v169, 2, v168
    v_add_u32 v168, v168, v165
    v_mul_u32_u24 v168, 1280, v168
    v_add_u32 v228, v168, v163
    v_add_u32 v167, 12, v164
    v_mul_u32_u24 v168, 52, v167
    v_lshrrev_b32 v168, 8, v168
    v_mul_u32_u24 v169, 5, v168
    v_sub_u32 v169, v167, v169
    v_mul_u32_u24 v168, 40, v168
    v_lshl_add_u32 v168, v169, 2, v168
    v_add_u32 v168, v168, v165
    v_mul_u32_u24 v168, 1280, v168
    v_add_u32 v233, v168, v163
    v_add_u32 v167, 16, v164
    v_mul_u32_u24 v168, 52, v167
    v_lshrrev_b32 v168, 8, v168
    v_mul_u32_u24 v169, 5, v168
    v_sub_u32 v169, v167, v169
    v_mul_u32_u24 v168, 40, v168
    v_lshl_add_u32 v168, v169, 2, v168
    v_add_u32 v168, v168, v165
    v_mul_u32_u24 v168, 1280, v168
    v_add_u32 v238, v168, v163
    v_add_u32 v161, 192, v243
    v_mul_u32_u24 v162, 205, v161
    v_lshrrev_b32 v162, 11, v162
    v_mul_u32_u24 v163, 10, v162
    v_sub_u32 v163, v161, v163
    v_lshl_add_u32 v163, v163, 4, s32
    v_bfe_u32 v164, v162, 2, 2
    v_lshrrev_b32 v165, 4, v162
    v_mul_u32_u24 v165, 20, v165
    v_and_b32 v166, 3, v162
    v_add_u32 v165, v165, v166
    v_add_u32 v167, 0, v164
    v_mul_u32_u24 v168, 52, v167
    v_lshrrev_b32 v168, 8, v168
    v_mul_u32_u24 v169, 5, v168
    v_sub_u32 v169, v167, v169
    v_mul_u32_u24 v168, 40, v168
    v_lshl_add_u32 v168, v169, 2, v168
    v_add_u32 v168, v168, v165
    v_mul_u32_u24 v168, 1280, v168
    v_add_u32 v219, v168, v163
    v_add_u32 v167, 4, v164
    v_mul_u32_u24 v168, 52, v167
    v_lshrrev_b32 v168, 8, v168
    v_mul_u32_u24 v169, 5, v168
    v_sub_u32 v169, v167, v169
    v_mul_u32_u24 v168, 40, v168
    v_lshl_add_u32 v168, v169, 2, v168
    v_add_u32 v168, v168, v165
    v_mul_u32_u24 v168, 1280, v168
    v_add_u32 v224, v168, v163
    v_add_u32 v167, 8, v164
    v_mul_u32_u24 v168, 52, v167
    v_lshrrev_b32 v168, 8, v168
    v_mul_u32_u24 v169, 5, v168
    v_sub_u32 v169, v167, v169
    v_mul_u32_u24 v168, 40, v168
    v_lshl_add_u32 v168, v169, 2, v168
    v_add_u32 v168, v168, v165
    v_mul_u32_u24 v168, 1280, v168
    v_add_u32 v229, v168, v163
    v_add_u32 v167, 12, v164
    v_mul_u32_u24 v168, 52, v167
    v_lshrrev_b32 v168, 8, v168
    v_mul_u32_u24 v169, 5, v168
    v_sub_u32 v169, v167, v169
    v_mul_u32_u24 v168, 40, v168
    v_lshl_add_u32 v168, v169, 2, v168
    v_add_u32 v168, v168, v165
    v_mul_u32_u24 v168, 1280, v168
    v_add_u32 v234, v168, v163
    v_add_u32 v167, 16, v164
    v_mul_u32_u24 v168, 52, v167
    v_lshrrev_b32 v168, 8, v168
    v_mul_u32_u24 v169, 5, v168
    v_sub_u32 v169, v167, v169
    v_mul_u32_u24 v168, 40, v168
    v_lshl_add_u32 v168, v169, 2, v168
    v_add_u32 v168, v168, v165
    v_mul_u32_u24 v168, 1280, v168
    v_add_u32 v239, v168, v163
    v_add_u32 v161, 256, v243
    v_mul_u32_u24 v162, 205, v161
    v_lshrrev_b32 v162, 11, v162
    v_mul_u32_u24 v163, 10, v162
    v_sub_u32 v163, v161, v163
    v_lshl_add_u32 v163, v163, 4, s32
    v_bfe_u32 v164, v162, 2, 2
    v_lshrrev_b32 v165, 4, v162
    v_mul_u32_u24 v165, 20, v165
    v_and_b32 v166, 3, v162
    v_add_u32 v165, v165, v166
    v_add_u32 v167, 0, v164
    v_mul_u32_u24 v168, 52, v167
    v_lshrrev_b32 v168, 8, v168
    v_mul_u32_u24 v169, 5, v168
    v_sub_u32 v169, v167, v169
    v_mul_u32_u24 v168, 40, v168
    v_lshl_add_u32 v168, v169, 2, v168
    v_add_u32 v168, v168, v165
    v_mul_u32_u24 v168, 1280, v168
    v_add_u32 v220, v168, v163
    v_add_u32 v167, 4, v164
    v_mul_u32_u24 v168, 52, v167
    v_lshrrev_b32 v168, 8, v168
    v_mul_u32_u24 v169, 5, v168
    v_sub_u32 v169, v167, v169
    v_mul_u32_u24 v168, 40, v168
    v_lshl_add_u32 v168, v169, 2, v168
    v_add_u32 v168, v168, v165
    v_mul_u32_u24 v168, 1280, v168
    v_add_u32 v225, v168, v163
    v_add_u32 v167, 8, v164
    v_mul_u32_u24 v168, 52, v167
    v_lshrrev_b32 v168, 8, v168
    v_mul_u32_u24 v169, 5, v168
    v_sub_u32 v169, v167, v169
    v_mul_u32_u24 v168, 40, v168
    v_lshl_add_u32 v168, v169, 2, v168
    v_add_u32 v168, v168, v165
    v_mul_u32_u24 v168, 1280, v168
    v_add_u32 v230, v168, v163
    v_add_u32 v167, 12, v164
    v_mul_u32_u24 v168, 52, v167
    v_lshrrev_b32 v168, 8, v168
    v_mul_u32_u24 v169, 5, v168
    v_sub_u32 v169, v167, v169
    v_mul_u32_u24 v168, 40, v168
    v_lshl_add_u32 v168, v169, 2, v168
    v_add_u32 v168, v168, v165
    v_mul_u32_u24 v168, 1280, v168
    v_add_u32 v235, v168, v163
    v_add_u32 v167, 16, v164
    v_mul_u32_u24 v168, 52, v167
    v_lshrrev_b32 v168, 8, v168
    v_mul_u32_u24 v169, 5, v168
    v_sub_u32 v169, v167, v169
    v_mul_u32_u24 v168, 40, v168
    v_lshl_add_u32 v168, v169, 2, v168
    v_add_u32 v168, v168, v165
    v_mul_u32_u24 v168, 1280, v168
    v_add_u32 v240, v168, v163
    s_lshr_b32 s30, s20, 1
    s_lshl_b32 s30, s30, 8
    s_add_u32 s30, s30, 17043456
    v_mov_b32 v253, s30
KM_pa:
    buffer_load_dword v254, v253, s[4:7], 0 offen sc1
    s_waitcnt vmcnt(0)
    v_readfirstlane_b32 s30, v254
    s_cmp_ge_u32 s30, 8
    s_cbranch_scc1 KM_paok
    s_sleep 8
    s_sub_u32 s95, s95, 1
    s_cbranch_scc1 K2_exit
    s_branch KM_pa
KM_paok:
    s_mul_i32 s27, s56, 40960
    s_add_u32 s27, s27, s26
    s_lshl_b32 s57, s56, 17
    s_add_u32 s57, s57, s29
    s_add_u32 s56, s56, 1
    s_cmp_eq_u32 s56, s25
    s_cselect_b32 s56, 0, s56
    s_add_u32 m0, s28, 0
    s_nop 0
    buffer_load_dwordx4 v247, s[8:11], s27 offen lds
    s_add_u32 m0, s28, 1024
    s_nop 0
    buffer_load_dwordx4 v248, s[8:11], s27 offen lds
    s_add_u32 m0, s28, 2048
    s_nop 0
    buffer_load_dwordx4 v249, s[8:11], s27 offen lds
    s_add_u32 m0, s28, 3072
    s_nop 0
    buffer_load_dwordx4 v250, s[8:11], s27 offen lds
    s_add_u32 m0, s28, 4096
    s_nop 0
    buffer_load_dwordx4 v251, s[8:11], s27 offen lds
    s_add_u32 m0, s28, 5120
    s_nop 0
    buffer_load_dwordx4 v246, s[4:7], s57 offen sc1 lds
    s_add_u32 s57, s57, 32768
    s_add_u32 m0, s28, 6144
    s_nop 0
    buffer_load_dwordx4 v246, s[4:7], s57 offen sc1 lds
    s_add_u32 s57, s57, 32768
    s_add_u32 m0, s28, 7168
    s_nop 0
    buffer_load_dwordx4 v246, s[4:7], s57 offen sc1 lds
    s_add_u32 s57, s57, 32768
    s_add_u32 m0, s28, 8192
    s_nop 0
    buffer_load_dwordx4 v246, s[4:7], s57 offen sc1 lds
    s_mul_i32 s27, s56, 40960
    s_add_u32 s27, s27, s26
    s_lshl_b32 s57, s56, 17
    s_add_u32 s57, s57, s29
    s_add_u32 s56, s56, 1
    s_cmp_eq_u32 s56, s25
    s_cselect_b32 s56, 0, s56
    s_add_u32 m0, s28, 9216
    s_nop 0
    buffer_load_dwordx4 v247, s[8:11], s27 offen lds
    s_add_u32 m0, s28, 10240
    s_nop 0
    buffer_load_dwordx4 v248, s[8:11], s27 offen lds
    s_add_u32 m0, s28, 11264
    s_nop 0
    buffer_load_dwordx4 v249, s[8:11], s27 offen lds
    s_add_u32 m0, s28, 12288
    s_nop 0
    buffer_load_dwordx4 v250, s[8:11], s27 offen lds
    s_add_u32 m0, s28, 13312
    s_nop 0
    buffer_load_dwordx4 v251, s[8:11], s27 offen lds
    s_add_u32 m0, s28, 14336
    s_nop 0
    buffer_load_dwordx4 v246, s[4:7], s57 offen sc1 lds
    s_add_u32 s57, s57, 32768
    s_add_u32 m0, s28, 15360
    s_nop 0
    buffer_load_dwordx4 v246, s[4:7], s57 offen sc1 lds
    s_add_u32 s57, s57, 32768
    s_add_u32 m0, s28, 16384
    s_nop 0
    buffer_load_dwordx4 v246, s[4:7], s57 offen sc1 lds
    s_add_u32 s57, s57, 32768
    s_add_u32 m0, s28, 17408
    s_nop 0
    buffer_load_dwordx4 v246, s[4:7], s57 offen sc1 lds
    s_mul_i32 s27, s56, 40960
    s_add_u32 s27, s27, s26
    s_lshl_b32 s57, s56, 17
    s_add_u32 s57, s57, s29
    s_add_u32 s56, s56, 1
    s_cmp_eq_u32 s56, s25
    s_cselect_b32 s56, 0, s56
    s_add_u32 m0, s28, 18432
    s_nop 0
    buffer_load_dwordx4 v247, s[8:11], s27 offen lds
    s_add_u32 m0, s28, 19456
    s_nop 0
    buffer_load_dwordx4 v248, s[8:11], s27 offen lds
    s_add_u32 m0, s28, 20480
    s_nop 0
    buffer_load_dwordx4 v249, s[8:11], s27 offen lds
    s_add_u32 m0, s28, 21504
    s_nop 0
    buffer_load_dwordx4 v250, s[8:11], s27 offen lds
    s_add_u32 m0, s28, 22528
    s_nop 0
    buffer_load_dwordx4 v251, s[8:11], s27 offen lds
    s_add_u32 m0, s28, 23552
    s_nop 0
    buffer_load_dwordx4 v246, s[4:7], s57 offen sc1 lds
    s_add_u32 s57, s57, 32768
    s_add_u32 m0, s28, 24576
    s_nop 0
    buffer_load_dwordx4 v246, s[4:7], s57 offen sc1 lds
    s_add_u32 s57, s57, 32768
    s_add_u32 m0, s28, 25600
    s_nop 0
    buffer_load_dwordx4 v246, s[4:7], s57 offen sc1 lds
    s_add_u32 s57, s57, 32768
    s_add_u32 m0, s28, 26624
    s_nop 0
    buffer_load_dwordx4 v246, s[4:7], s57 offen sc1 lds
    s_waitcnt vmcnt(18)
    ds_read_b128 v[160:163], v242 offset:5120
    ds_read_b128 v[164:167], v242 offset:5376
    ds_read_b128 v[168:171], v242 offset:5632
    ds_read_b128 v[172:175], v242 offset:5888
    ds_read_b64_tr_b16 v[192:193], v241 offset:0
    ds_read_b64_tr_b16 v[194:195], v241 offset:2560
    ds_read_b64_tr_b16 v[196:197], v241 offset:32
    ds_read_b64_tr_b16 v[198:199], v241 offset:2592
    ds_read_b64_tr_b16 v[200:201], v241 offset:64
    ds_read_b64_tr_b16 v[202:203], v241 offset:2624
    s_waitcnt lgkmcnt(4)
    v_mfma_f32_16x16x32_bf16 v[0:3], v[192:195], v[160:163], 0
    v_mfma_f32_16x16x32_bf16 v[20:23], v[192:195], v[164:167], 0
    s_mul_i32 s27, s56, 40960
    s_add_u32 s27, s27, s26
    s_lshl_b32 s57, s56, 17
    s_add_u32 s57, s57, s29
    s_add_u32 s56, s56, 1
    s_cmp_eq_u32 s56, s25
    s_cselect_b32 s56, 0, s56
    s_add_u32 m0, s28, 27648
    s_nop 0
    buffer_load_dwordx4 v247, s[8:11], s27 offen lds
    v_mfma_f32_16x16x32_bf16 v[40:43], v[192:195], v[168:171], 0
    v_mfma_f32_16x16x32_bf16 v[60:63], v[192:195], v[172:175], 0
    s_add_u32 m0, s28, 28672
    s_nop 0
    buffer_load_dwordx4 v248, s[8:11], s27 offen lds
    ds_read_b64_tr_b16 v[204:205], v241 offset:96
    ds_read_b64_tr_b16 v[206:207], v241 offset:2656
    s_waitcnt lgkmcnt(4)
    v_mfma_f32_16x16x32_bf16 v[4:7], v[196:199], v[160:163], 0
    v_mfma_f32_16x16x32_bf16 v[24:27], v[196:199], v[164:167], 0
    s_add_u32 m0, s28, 29696
    s_nop 0
    buffer_load_dwordx4 v249, s[8:11], s27 offen lds
    v_mfma_f32_16x16x32_bf16 v[44:47], v[196:199], v[168:171], 0
    v_mfma_f32_16x16x32_bf16 v[64:67], v[196:199], v[172:175], 0
    s_add_u32 m0, s28, 30720
    s_nop 0
    buffer_load_dwordx4 v250, s[8:11], s27 offen lds
    ds_read_b64_tr_b16 v[208:209], v241 offset:128
    ds_read_b64_tr_b16 v[210:211], v241 offset:2688
    s_waitcnt lgkmcnt(4)
    v_mfma_f32_16x16x32_bf16 v[8:11], v[200:203], v[160:163], 0
    v_mfma_f32_16x16x32_bf16 v[28:31], v[200:203], v[164:167], 0
    s_add_u32 m0, s28, 31744
    s_nop 0
    buffer_load_dwordx4 v251, s[8:11], s27 offen lds
    s_add_u32 m0, s28, 32768
    s_nop 0
    buffer_load_dwordx4 v246, s[4:7], s57 offen sc1 lds
    s_add_u32 s57, s57, 32768
    v_mfma_f32_16x16x32_bf16 v[48:51], v[200:203], v[168:171], 0
    v_mfma_f32_16x16x32_bf16 v[68:71], v[200:203], v[172:175], 0
    s_add_u32 m0, s28, 33792
    s_nop 0
    buffer_load_dwordx4 v246, s[4:7], s57 offen sc1 lds
    s_add_u32 s57, s57, 32768
    s_add_u32 m0, s28, 34816
    s_nop 0
    buffer_load_dwordx4 v246, s[4:7], s57 offen sc1 lds
    s_add_u32 s57, s57, 32768
    s_add_u32 m0, s28, 35840
    s_nop 0
    buffer_load_dwordx4 v246, s[4:7], s57 offen sc1 lds
    s_waitcnt vmcnt(18)
    ds_read_b128 v[176:179], v242 offset:14336
    ds_read_b128 v[180:183], v242 offset:14592
    ds_read_b128 v[184:187], v242 offset:14848
    ds_read_b128 v[188:191], v242 offset:15104
    ds_read_b64_tr_b16 v[212:213], v241 offset:9216
    ds_read_b64_tr_b16 v[214:215], v241 offset:11776
    s_waitcnt lgkmcnt(8)
    v_mfma_f32_16x16x32_bf16 v[12:15], v[204:207], v[160:163], 0
    v_mfma_f32_16x16x32_bf16 v[32:35], v[204:207], v[164:167], 0
    v_mfma_f32_16x16x32_bf16 v[52:55], v[204:207], v[168:171], 0
    v_mfma_f32_16x16x32_bf16 v[72:75], v[204:207], v[172:175], 0
    ds_read_b64_tr_b16 v[192:193], v241 offset:9248
    ds_read_b64_tr_b16 v[194:195], v241 offset:11808
    s_waitcnt lgkmcnt(8)
    v_mfma_f32_16x16x32_bf16 v[16:19], v[208:211], v[160:163], 0
    v_mfma_f32_16x16x32_bf16 v[36:39], v[208:211], v[164:167], 0
    v_mfma_f32_16x16x32_bf16 v[56:59], v[208:211], v[168:171], 0
    v_mfma_f32_16x16x32_bf16 v[76:79], v[208:211], v[172:175], 0
    ds_read_b64_tr_b16 v[196:197], v241 offset:9280
    ds_read_b64_tr_b16 v[198:199], v241 offset:11840
    s_waitcnt lgkmcnt(4)
    v_mfma_f32_16x16x32_bf16 v[0:3], v[212:215], v[176:179], v[0:3]
    v_mfma_f32_16x16x32_bf16 v[20:23], v[212:215], v[180:183], v[20:23]
    s_mul_i32 s27, s56, 40960
    s_add_u32 s27, s27, s26
    s_lshl_b32 s57, s56, 17
    s_add_u32 s57, s57, s29
    s_add_u32 s56, s56, 1
    s_cmp_eq_u32 s56, s25
    s_cselect_b32 s56, 0, s56
    s_add_u32 m0, s28, 0
    s_nop 0
    buffer_load_dwordx4 v247, s[8:11], s27 offen lds
    v_mfma_f32_16x16x32_bf16 v[40:43], v[212:215], v[184:187], v[40:43]
    v_mfma_f32_16x16x32_bf16 v[60:63], v[212:215], v[188:191], v[60:63]
    s_add_u32 m0, s28, 1024
    s_nop 0
    buffer_load_dwordx4 v248, s[8:11], s27 offen lds
    ds_read_b64_tr_b16 v[200:201], v241 offset:9312
    ds_read_b64_tr_b16 v[202:203], v241 offset:11872
    s_waitcnt lgkmcnt(4)
    v_mfma_f32_16x16x32_bf16 v[4:7], v[192:195], v[176:179], v[4:7]
    v_mfma_f32_16x16x32_bf16 v[24:27], v[192:195], v[180:183], v[24:27]
    s_add_u32 m0, s28, 2048
    s_nop 0
    buffer_load_dwordx4 v249, s[8:11], s27 offen lds
    v_mfma_f32_16x16x32_bf16 v[44:47], v[192:195], v[184:187], v[44:47]
    v_mfma_f32_16x16x32_bf16 v[64:67], v[192:195], v[188:191], v[64:67]
    s_add_u32 m0, s28, 3072
    s_nop 0
    buffer_load_dwordx4 v250, s[8:11], s27 offen lds
    ds_read_b64_tr_b16 v[204:205], v241 offset:9344
    ds_read_b64_tr_b16 v[206:207], v241 offset:11904
    s_waitcnt lgkmcnt(4)
    v_mfma_f32_16x16x32_bf16 v[8:11], v[196:199], v[176:179], v[8:11]
    v_mfma_f32_16x16x32_bf16 v[28:31], v[196:199], v[180:183], v[28:31]
    s_add_u32 m0, s28, 4096
    s_nop 0
    buffer_load_dwordx4 v251, s[8:11], s27 offen lds
    s_add_u32 m0, s28, 5120
    s_nop 0
    buffer_load_dwordx4 v246, s[4:7], s57 offen sc1 lds
    s_add_u32 s57, s57, 32768
    v_mfma_f32_16x16x32_bf16 v[48:51], v[196:199], v[184:187], v[48:51]
    v_mfma_f32_16x16x32_bf16 v[68:71], v[196:199], v[188:191], v[68:71]
    s_add_u32 m0, s28, 6144
    s_nop 0
    buffer_load_dwordx4 v246, s[4:7], s57 offen sc1 lds
    s_add_u32 s57, s57, 32768
    s_add_u32 m0, s28, 7168
    s_nop 0
    buffer_load_dwordx4 v246, s[4:7], s57 offen sc1 lds
    s_add_u32 s57, s57, 32768
    s_add_u32 m0, s28, 8192
    s_nop 0
    buffer_load_dwordx4 v246, s[4:7], s57 offen sc1 lds
    s_waitcnt vmcnt(18)
    ds_read_b128 v[160:163], v242 offset:23552
    ds_read_b128 v[164:167], v242 offset:23808
    ds_read_b128 v[168:171], v242 offset:24064
    ds_read_b128 v[172:175], v242 offset:24320
    ds_read_b64_tr_b16 v[208:209], v241 offset:18432
    ds_read_b64_tr_b16 v[210:211], v241 offset:20992
    s_waitcnt lgkmcnt(8)
    v_mfma_f32_16x16x32_bf16 v[12:15], v[200:203], v[176:179], v[12:15]
    v_mfma_f32_16x16x32_bf16 v[32:35], v[200:203], v[180:183], v[32:35]
    v_mfma_f32_16x16x32_bf16 v[52:55], v[200:203], v[184:187], v[52:55]
    v_mfma_f32_16x16x32_bf16 v[72:75], v[200:203], v[188:191], v[72:75]
    ds_read_b64_tr_b16 v[212:213], v241 offset:18464
    ds_read_b64_tr_b16 v[214:215], v241 offset:21024
    s_waitcnt lgkmcnt(8)
    v_mfma_f32_16x16x32_bf16 v[16:19], v[204:207], v[176:179], v[16:19]
    v_mfma_f32_16x16x32_bf16 v[36:39], v[204:207], v[180:183], v[36:39]
    v_mfma_f32_16x16x32_bf16 v[56:59], v[204:207], v[184:187], v[56:59]
    v_mfma_f32_16x16x32_bf16 v[76:79], v[204:207], v[188:191], v[76:79]
    ds_read_b64_tr_b16 v[192:193], v241 offset:18496
    ds_read_b64_tr_b16 v[194:195], v241 offset:21056
    s_waitcnt lgkmcnt(4)
    v_mfma_f32_16x16x32_bf16 v[0:3], v[208:211], v[160:163], v[0:3]
    v_mfma_f32_16x16x32_bf16 v[20:23], v[208:211], v[164:167], v[20:23]
    s_mul_i32 s27, s56, 40960
    s_add_u32 s27, s27, s26
    s_lshl_b32 s57, s56, 17
    s_add_u32 s57, s57, s29
    s_add_u32 s56, s56, 1
    s_cmp_eq_u32 s56, s25
    s_cselect_b32 s56, 0, s56
    s_add_u32 m0, s28, 9216
    s_nop 0
    buffer_load_dwordx4 v247, s[8:11], s27 offen lds
    v_mfma_f32_16x16x32_bf16 v[40:43], v[208:211], v[168:171], v[40:43]
    v_mfma_f32_16x16x32_bf16 v[60:63], v[208:211], v[172:175], v[60:63]
    s_add_u32 m0, s28, 10240
    s_nop 0
    buffer_load_dwordx4 v248, s[8:11], s27 offen lds
    ds_read_b64_tr_b16 v[196:197], v241 offset:18528
    ds_read_b64_tr_b16 v[198:199], v241 offset:21088
    s_waitcnt lgkmcnt(4)
    v_mfma_f32_16x16x32_bf16 v[4:7], v[212:215], v[160:163], v[4:7]
    v_mfma_f32_16x16x32_bf16 v[24:27], v[212:215], v[164:167], v[24:27]
    s_add_u32 m0, s28, 11264
    s_nop 0
    buffer_load_dwordx4 v249, s[8:11], s27 offen lds
    v_mfma_f32_16x16x32_bf16 v[44:47], v[212:215], v[168:171], v[44:47]
    v_mfma_f32_16x16x32_bf16 v[64:67], v[212:215], v[172:175], v[64:67]
    s_add_u32 m0, s28, 12288
    s_nop 0
    buffer_load_dwordx4 v250, s[8:11], s27 offen lds
    ds_read_b64_tr_b16 v[200:201], v241 offset:18560
    ds_read_b64_tr_b16 v[202:203], v241 offset:21120
    s_waitcnt lgkmcnt(4)
    v_mfma_f32_16x16x32_bf16 v[8:11], v[192:195], v[160:163], v[8:11]
    v_mfma_f32_16x16x32_bf16 v[28:31], v[192:195], v[164:167], v[28:31]
    s_add_u32 m0, s28, 13312
    s_nop 0
    buffer_load_dwordx4 v251, s[8:11], s27 offen lds
    s_add_u32 m0, s28, 14336
    s_nop 0
    buffer_load_dwordx4 v246, s[4:7], s57 offen sc1 lds
    s_add_u32 s57, s57, 32768
    v_mfma_f32_16x16x32_bf16 v[48:51], v[192:195], v[168:171], v[48:51]
    v_mfma_f32_16x16x32_bf16 v[68:71], v[192:195], v[172:175], v[68:71]
    s_add_u32 m0, s28, 15360
    s_nop 0
    buffer_load_dwordx4 v246, s[4:7], s57 offen sc1 lds
    s_add_u32 s57, s57, 32768
    s_add_u32 m0, s28, 16384
    s_nop 0
    buffer_load_dwordx4 v246, s[4:7], s57 offen sc1 lds
    s_add_u32 s57, s57, 32768
    s_add_u32 m0, s28, 17408
    s_nop 0
    buffer_load_dwordx4 v246, s[4:7], s57 offen sc1 lds
    s_waitcnt vmcnt(18)
    ds_read_b128 v[176:179], v242 offset:32768
    ds_read_b128 v[180:183], v242 offset:33024
    ds_read_b128 v[184:187], v242 offset:33280
    ds_read_b128 v[188:191], v242 offset:33536
    ds_read_b64_tr_b16 v[204:205], v241 offset:27648
    ds_read_b64_tr_b16 v[206:207], v241 offset:30208
    s_waitcnt lgkmcnt(8)
    v_mfma_f32_16x16x32_bf16 v[12:15], v[196:199], v[160:163], v[12:15]
    v_mfma_f32_16x16x32_bf16 v[32:35], v[196:199], v[164:167], v[32:35]
    v_mfma_f32_16x16x32_bf16 v[52:55], v[196:199], v[168:171], v[52:55]
    v_mfma_f32_16x16x32_bf16 v[72:75], v[196:199], v[172:175], v[72:75]
    ds_read_b64_tr_b16 v[208:209], v241 offset:27680
    ds_read_b64_tr_b16 v[210:211], v241 offset:30240
    s_waitcnt lgkmcnt(8)
    v_mfma_f32_16x16x32_bf16 v[16:19], v[200:203], v[160:163], v[16:19]
    v_mfma_f32_16x16x32_bf16 v[36:39], v[200:203], v[164:167], v[36:39]
    v_mfma_f32_16x16x32_bf16 v[56:59], v[200:203], v[168:171], v[56:59]
    v_mfma_f32_16x16x32_bf16 v[76:79], v[200:203], v[172:175], v[76:79]
    ds_read_b64_tr_b16 v[212:213], v241 offset:27712
    ds_read_b64_tr_b16 v[214:215], v241 offset:30272
    s_waitcnt lgkmcnt(4)
    v_mfma_f32_16x16x32_bf16 v[0:3], v[204:207], v[176:179], v[0:3]
    v_mfma_f32_16x16x32_bf16 v[20:23], v[204:207], v[180:183], v[20:23]
    s_mul_i32 s27, s56, 40960
    s_add_u32 s27, s27, s26
    s_lshl_b32 s57, s56, 17
    s_add_u32 s57, s57, s29
    s_add_u32 s56, s56, 1
    s_cmp_eq_u32 s56, s25
    s_cselect_b32 s56, 0, s56
    s_add_u32 m0, s28, 18432
    s_nop 0
    buffer_load_dwordx4 v247, s[8:11], s27 offen lds
    v_mfma_f32_16x16x32_bf16 v[40:43], v[204:207], v[184:187], v[40:43]
    v_mfma_f32_16x16x32_bf16 v[60:63], v[204:207], v[188:191], v[60:63]
    s_add_u32 m0, s28, 19456
    s_nop 0
    buffer_load_dwordx4 v248, s[8:11], s27 offen lds
    ds_read_b64_tr_b16 v[192:193], v241 offset:27744
    ds_read_b64_tr_b16 v[194:195], v241 offset:30304
    s_waitcnt lgkmcnt(4)
    v_mfma_f32_16x16x32_bf16 v[4:7], v[208:211], v[176:179], v[4:7]
    v_mfma_f32_16x16x32_bf16 v[24:27], v[208:211], v[180:183], v[24:27]
    s_add_u32 m0, s28, 20480
    s_nop 0
    buffer_load_dwordx4 v249, s[8:11], s27 offen lds
    v_mfma_f32_16x16x32_bf16 v[44:47], v[208:211], v[184:187], v[44:47]
    v_mfma_f32_16x16x32_bf16 v[64:67], v[208:211], v[188:191], v[64:67]
    s_add_u32 m0, s28, 21504
    s_nop 0
    buffer_load_dwordx4 v250, s[8:11], s27 offen lds
    ds_read_b64_tr_b16 v[196:197], v241 offset:27776
    ds_read_b64_tr_b16 v[198:199], v241 offset:30336
    s_waitcnt lgkmcnt(4)
    v_mfma_f32_16x16x32_bf16 v[8:11], v[212:215], v[176:179], v[8:11]
    v_mfma_f32_16x16x32_bf16 v[28:31], v[212:215], v[180:183], v[28:31]
    s_add_u32 m0, s28, 22528
    s_nop 0
    buffer_load_dwordx4 v251, s[8:11], s27 offen lds
    s_add_u32 m0, s28, 23552
    s_nop 0
    buffer_load_dwordx4 v246, s[4:7], s57 offen sc1 lds
    s_add_u32 s57, s57, 32768
    v_mfma_f32_16x16x32_bf16 v[48:51], v[212:215], v[184:187], v[48:51]
    v_mfma_f32_16x16x32_bf16 v[68:71], v[212:215], v[188:191], v[68:71]
    s_add_u32 m0, s28, 24576
    s_nop 0
    buffer_load_dwordx4 v246, s[4:7], s57 offen sc1 lds
    s_add_u32 s57, s57, 32768
    s_add_u32 m0, s28, 25600
    s_nop 0
    buffer_load_dwordx4 v246, s[4:7], s57 offen sc1 lds
    s_add_u32 s57, s57, 32768
    s_add_u32 m0, s28, 26624
    s_nop 0
    buffer_load_dwordx4 v246, s[4:7], s57 offen sc1 lds
    s_waitcnt vmcnt(18)
    ds_read_b128 v[160:163], v242 offset:5120
    ds_read_b128 v[164:167], v242 offset:5376
    ds_read_b128 v[168:171], v242 offset:5632
    ds_read_b128 v[172:175], v242 offset:5888
    ds_read_b64_tr_b16 v[200:201], v241 offset:0
    ds_read_b64_tr_b16 v[202:203], v241 offset:2560
    s_waitcnt lgkmcnt(8)
    v_mfma_f32_16x16x32_bf16 v[12:15], v[192:195], v[176:179], v[12:15]
    v_mfma_f32_16x16x32_bf16 v[32:35], v[192:195], v[180:183], v[32:35]
    v_mfma_f32_16x16x32_bf16 v[52:55], v[192:195], v[184:187], v[52:55]
    v_mfma_f32_16x16x32_bf16 v[72:75], v[192:195], v[188:191], v[72:75]
    ds_read_b64_tr_b16 v[204:205], v241 offset:32
    ds_read_b64_tr_b16 v[206:207], v241 offset:2592
    s_waitcnt lgkmcnt(8)
    v_mfma_f32_16x16x32_bf16 v[16:19], v[196:199], v[176:179], v[16:19]
    v_mfma_f32_16x16x32_bf16 v[36:39], v[196:199], v[180:183], v[36:39]
    v_mfma_f32_16x16x32_bf16 v[56:59], v[196:199], v[184:187], v[56:59]
    v_mfma_f32_16x16x32_bf16 v[76:79], v[196:199], v[188:191], v[76:79]
    ds_read_b64_tr_b16 v[208:209], v241 offset:64
    ds_read_b64_tr_b16 v[210:211], v241 offset:2624
    s_waitcnt lgkmcnt(4)
    v_mfma_f32_16x16x32_bf16 v[0:3], v[200:203], v[160:163], v[0:3]
    v_mfma_f32_16x16x32_bf16 v[20:23], v[200:203], v[164:167], v[20:23]
    s_mul_i32 s27, s56, 40960
    s_add_u32 s27, s27, s26
    s_lshl_b32 s57, s56, 17
    s_add_u32 s57, s57, s29
    s_add_u32 s56, s56, 1
    s_cmp_eq_u32 s56, s25
    s_cselect_b32 s56, 0, s56
    s_add_u32 m0, s28, 27648
    s_nop 0
    buffer_load_dwordx4 v247, s[8:11], s27 offen lds
    v_mfma_f32_16x16x32_bf16 v[40:43], v[200:203], v[168:171], v[40:43]
    v_mfma_f32_16x16x32_bf16 v[60:63], v[200:203], v[172:175], v[60:63]
    s_add_u32 m0, s28, 28672
    s_nop 0
    buffer_load_dwordx4 v248, s[8:11], s27 offen lds
    ds_read_b64_tr_b16 v[212:213], v241 offset:96
    ds_read_b64_tr_b16 v[214:215], v241 offset:2656
    s_waitcnt lgkmcnt(4)
    v_mfma_f32_16x16x32_bf16 v[4:7], v[204:207], v[160:163], v[4:7]
    v_mfma_f32_16x16x32_bf16 v[24:27], v[204:207], v[164:167], v[24:27]
    s_add_u32 m0, s28, 29696
    s_nop 0
    buffer_load_dwordx4 v249, s[8:11], s27 offen lds
    v_mfma_f32_16x16x32_bf16 v[44:47], v[204:207], v[168:171], v[44:47]
    v_mfma_f32_16x16x32_bf16 v[64:67], v[204:207], v[172:175], v[64:67]
    s_add_u32 m0, s28, 30720
    s_nop 0
    buffer_load_dwordx4 v250, s[8:11], s27 offen lds
    ds_read_b64_tr_b16 v[192:193], v241 offset:128
    ds_read_b64_tr_b16 v[194:195], v241 offset:2688
    s_waitcnt lgkmcnt(4)
    v_mfma_f32_16x16x32_bf16 v[8:11], v[208:211], v[160:163], v[8:11]
    v_mfma_f32_16x16x32_bf16 v[28:31], v[208:211], v[164:167], v[28:31]
    s_add_u32 m0, s28, 31744
    s_nop 0
    buffer_load_dwordx4 v251, s[8:11], s27 offen lds
    s_add_u32 m0, s28, 32768
    s_nop 0
    buffer_load_dwordx4 v246, s[4:7], s57 offen sc1 lds
    s_add_u32 s57, s57, 32768
    v_mfma_f32_16x16x32_bf16 v[48:51], v[208:211], v[168:171], v[48:51]
    v_mfma_f32_16x16x32_bf16 v[68:71], v[208:211], v[172:175], v[68:71]
    s_add_u32 m0, s28, 33792
    s_nop 0
    buffer_load_dwordx4 v246, s[4:7], s57 offen sc1 lds
    s_add_u32 s57, s57, 32768
    s_add_u32 m0, s28, 34816
    s_nop 0
    buffer_load_dwordx4 v246, s[4:7], s57 offen sc1 lds
    s_add_u32 s57, s57, 32768
    s_add_u32 m0, s28, 35840
    s_nop 0
    buffer_load_dwordx4 v246, s[4:7], s57 offen sc1 lds
    s_waitcnt vmcnt(18)
    ds_read_b128 v[176:179], v242 offset:14336
    ds_read_b128 v[180:183], v242 offset:14592
    ds_read_b128 v[184:187], v242 offset:14848
    ds_read_b128 v[188:191], v242 offset:15104
    ds_read_b64_tr_b16 v[196:197], v241 offset:9216
    ds_read_b64_tr_b16 v[198:199], v241 offset:11776
    s_waitcnt lgkmcnt(8)
    v_mfma_f32_16x16x32_bf16 v[12:15], v[212:215], v[160:163], v[12:15]
    v_mfma_f32_16x16x32_bf16 v[32:35], v[212:215], v[164:167], v[32:35]
    v_mfma_f32_16x16x32_bf16 v[52:55], v[212:215], v[168:171], v[52:55]
    v_mfma_f32_16x16x32_bf16 v[72:75], v[212:215], v[172:175], v[72:75]
    ds_read_b64_tr_b16 v[200:201], v241 offset:9248
    ds_read_b64_tr_b16 v[202:203], v241 offset:11808
    s_waitcnt lgkmcnt(8)
    v_mfma_f32_16x16x32_bf16 v[16:19], v[192:195], v[160:163], v[16:19]
    v_mfma_f32_16x16x32_bf16 v[36:39], v[192:195], v[164:167], v[36:39]
    v_mfma_f32_16x16x32_bf16 v[56:59], v[192:195], v[168:171], v[56:59]
    v_mfma_f32_16x16x32_bf16 v[76:79], v[192:195], v[172:175], v[76:79]
    ds_read_b64_tr_b16 v[204:205], v241 offset:9280
    ds_read_b64_tr_b16 v[206:207], v241 offset:11840
    s_waitcnt lgkmcnt(4)
    v_mfma_f32_16x16x32_bf16 v[0:3], v[196:199], v[176:179], v[0:3]
    v_mfma_f32_16x16x32_bf16 v[20:23], v[196:199], v[180:183], v[20:23]
    s_mul_i32 s27, s56, 40960
    s_add_u32 s27, s27, s26
    s_lshl_b32 s57, s56, 17
    s_add_u32 s57, s57, s29
    s_add_u32 s56, s56, 1
    s_cmp_eq_u32 s56, s25
    s_cselect_b32 s56, 0, s56
    s_add_u32 m0, s28, 0
    s_nop 0
    buffer_load_dwordx4 v247, s[8:11], s27 offen lds
    v_mfma_f32_16x16x32_bf16 v[40:43], v[196:199], v[184:187], v[40:43]
    v_mfma_f32_16x16x32_bf16 v[60:63], v[196:199], v[188:191], v[60:63]
    s_add_u32 m0, s28, 1024
    s_nop 0
    buffer_load_dwordx4 v248, s[8:11], s27 offen lds
    ds_read_b64_tr_b16 v[208:209], v241 offset:9312
    ds_read_b64_tr_b16 v[210:211], v241 offset:11872
    s_waitcnt lgkmcnt(4)
    v_mfma_f32_16x16x32_bf16 v[4:7], v[200:203], v[176:179], v[4:7]
    v_mfma_f32_16x16x32_bf16 v[24:27], v[200:203], v[180:183], v[24:27]
    s_add_u32 m0, s28, 2048
    s_nop 0
    buffer_load_dwordx4 v249, s[8:11], s27 offen lds
    v_mfma_f32_16x16x32_bf16 v[44:47], v[200:203], v[184:187], v[44:47]
    v_mfma_f32_16x16x32_bf16 v[64:67], v[200:203], v[188:191], v[64:67]
    s_add_u32 m0, s28, 3072
    s_nop 0
    buffer_load_dwordx4 v250, s[8:11], s27 offen lds
    ds_read_b64_tr_b16 v[212:213], v241 offset:9344
    ds_read_b64_tr_b16 v[214:215], v241 offset:11904
    s_waitcnt lgkmcnt(4)
    v_mfma_f32_16x16x32_bf16 v[8:11], v[204:207], v[176:179], v[8:11]
    v_mfma_f32_16x16x32_bf16 v[28:31], v[204:207], v[180:183], v[28:31]
    s_add_u32 m0, s28, 4096
    s_nop 0
    buffer_load_dwordx4 v251, s[8:11], s27 offen lds
    s_add_u32 m0, s28, 5120
    s_nop 0
    buffer_load_dwordx4 v246, s[4:7], s57 offen sc1 lds
    s_add_u32 s57, s57, 32768
    v_mfma_f32_16x16x32_bf16 v[48:51], v[204:207], v[184:187], v[48:51]
    v_mfma_f32_16x16x32_bf16 v[68:71], v[204:207], v[188:191], v[68:71]
    s_add_u32 m0, s28, 6144
    s_nop 0
    buffer_load_dwordx4 v246, s[4:7], s57 offen sc1 lds
    s_add_u32 s57, s57, 32768
    s_add_u32 m0, s28, 7168
    s_nop 0
    buffer_load_dwordx4 v246, s[4:7], s57 offen sc1 lds
    s_add_u32 s57, s57, 32768
    s_add_u32 m0, s28, 8192
    s_nop 0
    buffer_load_dwordx4 v246, s[4:7], s57 offen sc1 lds
    s_waitcnt vmcnt(18)
    ds_read_b128 v[160:163], v242 offset:23552
    ds_read_b128 v[164:167], v242 offset:23808
    ds_read_b128 v[168:171], v242 offset:24064
    ds_read_b128 v[172:175], v242 offset:24320
    ds_read_b64_tr_b16 v[192:193], v241 offset:18432
    ds_read_b64_tr_b16 v[194:195], v241 offset:20992
    s_waitcnt lgkmcnt(8)
    v_mfma_f32_16x16x32_bf16 v[12:15], v[208:211], v[176:179], v[12:15]
    v_mfma_f32_16x16x32_bf16 v[32:35], v[208:211], v[180:183], v[32:35]
    v_mfma_f32_16x16x32_bf16 v[52:55], v[208:211], v[184:187], v[52:55]
    v_mfma_f32_16x16x32_bf16 v[72:75], v[208:211], v[188:191], v[72:75]
    ds_read_b64_tr_b16 v[196:197], v241 offset:18464
    ds_read_b64_tr_b16 v[198:199], v241 offset:21024
    s_waitcnt lgkmcnt(8)
    v_mfma_f32_16x16x32_bf16 v[16:19], v[212:215], v[176:179], v[16:19]
    v_mfma_f32_16x16x32_bf16 v[36:39], v[212:215], v[180:183], v[36:39]
    v_mfma_f32_16x16x32_bf16 v[56:59], v[212:215], v[184:187], v[56:59]
    v_mfma_f32_16x16x32_bf16 v[76:79], v[212:215], v[188:191], v[76:79]
    ds_read_b64_tr_b16 v[200:201], v241 offset:18496
    ds_read_b64_tr_b16 v[202:203], v241 offset:21056
    s_waitcnt lgkmcnt(4)
    v_mfma_f32_16x16x32_bf16 v[0:3], v[192:195], v[160:163], v[0:3]
    v_mfma_f32_16x16x32_bf16 v[20:23], v[192:195], v[164:167], v[20:23]
    s_mul_i32 s27, s56, 40960
    s_add_u32 s27, s27, s26
    s_lshl_b32 s57, s56, 17
    s_add_u32 s57, s57, s29
    s_add_u32 s56, s56, 1
    s_cmp_eq_u32 s56, s25
    s_cselect_b32 s56, 0, s56
    s_add_u32 m0, s28, 9216
    s_nop 0
    buffer_load_dwordx4 v247, s[8:11], s27 offen lds
    v_mfma_f32_16x16x32_bf16 v[40:43], v[192:195], v[168:171], v[40:43]
    v_mfma_f32_16x16x32_bf16 v[60:63], v[192:195], v[172:175], v[60:63]
    s_add_u32 m0, s28, 10240
    s_nop 0
    buffer_load_dwordx4 v248, s[8:11], s27 offen lds
    ds_read_b64_tr_b16 v[204:205], v241 offset:18528
    ds_read_b64_tr_b16 v[206:207], v241 offset:21088
    s_waitcnt lgkmcnt(4)
    v_mfma_f32_16x16x32_bf16 v[4:7], v[196:199], v[160:163], v[4:7]
    v_mfma_f32_16x16x32_bf16 v[24:27], v[196:199], v[164:167], v[24:27]
    s_add_u32 m0, s28, 11264
    s_nop 0
    buffer_load_dwordx4 v249, s[8:11], s27 offen lds
    v_mfma_f32_16x16x32_bf16 v[44:47], v[196:199], v[168:171], v[44:47]
    v_mfma_f32_16x16x32_bf16 v[64:67], v[196:199], v[172:175], v[64:67]
    s_add_u32 m0, s28, 12288
    s_nop 0
    buffer_load_dwordx4 v250, s[8:11], s27 offen lds
    ds_read_b64_tr_b16 v[208:209], v241 offset:18560
    ds_read_b64_tr_b16 v[210:211], v241 offset:21120
    s_waitcnt lgkmcnt(4)
    v_mfma_f32_16x16x32_bf16 v[8:11], v[200:203], v[160:163], v[8:11]
    v_mfma_f32_16x16x32_bf16 v[28:31], v[200:203], v[164:167], v[28:31]
    s_add_u32 m0, s28, 13312
    s_nop 0
    buffer_load_dwordx4 v251, s[8:11], s27 offen lds
    s_add_u32 m0, s28, 14336
    s_nop 0
    buffer_load_dwordx4 v246, s[4:7], s57 offen sc1 lds
    s_add_u32 s57, s57, 32768
    v_mfma_f32_16x16x32_bf16 v[48:51], v[200:203], v[168:171], v[48:51]
    v_mfma_f32_16x16x32_bf16 v[68:71], v[200:203], v[172:175], v[68:71]
    s_add_u32 m0, s28, 15360
    s_nop 0
    buffer_load_dwordx4 v246, s[4:7], s57 offen sc1 lds
    s_add_u32 s57, s57, 32768
    s_add_u32 m0, s28, 16384
    s_nop 0
    buffer_load_dwordx4 v246, s[4:7], s57 offen sc1 lds
    s_add_u32 s57, s57, 32768
    s_add_u32 m0, s28, 17408
    s_nop 0
    buffer_load_dwordx4 v246, s[4:7], s57 offen sc1 lds
    s_waitcnt vmcnt(18)
    ds_read_b128 v[176:179], v242 offset:32768
    ds_read_b128 v[180:183], v242 offset:33024
    ds_read_b128 v[184:187], v242 offset:33280
    ds_read_b128 v[188:191], v242 offset:33536
    ds_read_b64_tr_b16 v[212:213], v241 offset:27648
    ds_read_b64_tr_b16 v[214:215], v241 offset:30208
    s_waitcnt lgkmcnt(8)
    v_mfma_f32_16x16x32_bf16 v[12:15], v[204:207], v[160:163], v[12:15]
    v_mfma_f32_16x16x32_bf16 v[32:35], v[204:207], v[164:167], v[32:35]
    v_mfma_f32_16x16x32_bf16 v[52:55], v[204:207], v[168:171], v[52:55]
    v_mfma_f32_16x16x32_bf16 v[72:75], v[204:207], v[172:175], v[72:75]
    ds_read_b64_tr_b16 v[192:193], v241 offset:27680
    ds_read_b64_tr_b16 v[194:195], v241 offset:30240
    s_waitcnt lgkmcnt(8)
    v_mfma_f32_16x16x32_bf16 v[16:19], v[208:211], v[160:163], v[16:19]
    v_mfma_f32_16x16x32_bf16 v[36:39], v[208:211], v[164:167], v[36:39]
    v_mfma_f32_16x16x32_bf16 v[56:59], v[208:211], v[168:171], v[56:59]
    v_mfma_f32_16x16x32_bf16 v[76:79], v[208:211], v[172:175], v[76:79]
    ds_read_b64_tr_b16 v[196:197], v241 offset:27712
    ds_read_b64_tr_b16 v[198:199], v241 offset:30272
    s_waitcnt lgkmcnt(4)
    v_mfma_f32_16x16x32_bf16 v[0:3], v[212:215], v[176:179], v[0:3]
    v_mfma_f32_16x16x32_bf16 v[20:23], v[212:215], v[180:183], v[20:23]
    s_mul_i32 s27, s56, 40960
    s_add_u32 s27, s27, s26
    s_lshl_b32 s57, s56, 17
    s_add_u32 s57, s57, s29
    s_add_u32 s56, s56, 1
    s_cmp_eq_u32 s56, s25
    s_cselect_b32 s56, 0, s56
    s_add_u32 m0, s28, 18432
    s_nop 0
    buffer_load_dwordx4 v247, s[8:11], s27 offen lds
    v_mfma_f32_16x16x32_bf16 v[40:43], v[212:215], v[184:187], v[40:43]
    v_mfma_f32_16x16x32_bf16 v[60:63], v[212:215], v[188:191], v[60:63]
    s_add_u32 m0, s28, 19456
    s_nop 0
    buffer_load_dwordx4 v248, s[8:11], s27 offen lds
    ds_read_b64_tr_b16 v[200:201], v241 offset:27744
    ds_read_b64_tr_b16 v[202:203], v241 offset:30304
    s_waitcnt lgkmcnt(4)
    v_mfma_f32_16x16x32_bf16 v[4:7], v[192:195], v[176:179], v[4:7]
    v_mfma_f32_16x16x32_bf16 v[24:27], v[192:195], v[180:183], v[24:27]
    s_add_u32 m0, s28, 20480
    s_nop 0
    buffer_load_dwordx4 v249, s[8:11], s27 offen lds
    v_mfma_f32_16x16x32_bf16 v[44:47], v[192:195], v[184:187], v[44:47]
    v_mfma_f32_16x16x32_bf16 v[64:67], v[192:195], v[188:191], v[64:67]
    s_add_u32 m0, s28, 21504
    s_nop 0
    buffer_load_dwordx4 v250, s[8:11], s27 offen lds
    ds_read_b64_tr_b16 v[204:205], v241 offset:27776
    ds_read_b64_tr_b16 v[206:207], v241 offset:30336
    s_waitcnt lgkmcnt(4)
    v_mfma_f32_16x16x32_bf16 v[8:11], v[196:199], v[176:179], v[8:11]
    v_mfma_f32_16x16x32_bf16 v[28:31], v[196:199], v[180:183], v[28:31]
    s_add_u32 m0, s28, 22528
    s_nop 0
    buffer_load_dwordx4 v251, s[8:11], s27 offen lds
    s_add_u32 m0, s28, 23552
    s_nop 0
    buffer_load_dwordx4 v246, s[4:7], s57 offen sc1 lds
    s_add_u32 s57, s57, 32768
    v_mfma_f32_16x16x32_bf16 v[48:51], v[196:199], v[184:187], v[48:51]
    v_mfma_f32_16x16x32_bf16 v[68:71], v[196:199], v[188:191], v[68:71]
    s_add_u32 m0, s28, 24576
    s_nop 0
    buffer_load_dwordx4 v246, s[4:7], s57 offen sc1 lds
    s_add_u32 s57, s57, 32768
    s_add_u32 m0, s28, 25600
    s_nop 0
    buffer_load_dwordx4 v246, s[4:7], s57 offen sc1 lds
    s_add_u32 s57, s57, 32768
    s_add_u32 m0, s28, 26624
    s_nop 0
    buffer_load_dwordx4 v246, s[4:7], s57 offen sc1 lds
    s_waitcnt vmcnt(18)
    ds_read_b128 v[160:163], v242 offset:5120
    ds_read_b128 v[164:167], v242 offset:5376
    ds_read_b128 v[168:171], v242 offset:5632
    ds_read_b128 v[172:175], v242 offset:5888
    ds_read_b64_tr_b16 v[208:209], v241 offset:0
    ds_read_b64_tr_b16 v[210:211], v241 offset:2560
    s_waitcnt lgkmcnt(8)
    v_mfma_f32_16x16x32_bf16 v[12:15], v[200:203], v[176:179], v[12:15]
    v_mfma_f32_16x16x32_bf16 v[32:35], v[200:203], v[180:183], v[32:35]
    v_mfma_f32_16x16x32_bf16 v[52:55], v[200:203], v[184:187], v[52:55]
    v_mfma_f32_16x16x32_bf16 v[72:75], v[200:203], v[188:191], v[72:75]
    ds_read_b64_tr_b16 v[212:213], v241 offset:32
    ds_read_b64_tr_b16 v[214:215], v241 offset:2592
    s_waitcnt lgkmcnt(8)
    v_mfma_f32_16x16x32_bf16 v[16:19], v[204:207], v[176:179], v[16:19]
    v_mfma_f32_16x16x32_bf16 v[36:39], v[204:207], v[180:183], v[36:39]
    v_mfma_f32_16x16x32_bf16 v[56:59], v[204:207], v[184:187], v[56:59]
    v_mfma_f32_16x16x32_bf16 v[76:79], v[204:207], v[188:191], v[76:79]
    ds_read_b64_tr_b16 v[192:193], v241 offset:64
    ds_read_b64_tr_b16 v[194:195], v241 offset:2624
    s_waitcnt lgkmcnt(4)
    v_mfma_f32_16x16x32_bf16 v[0:3], v[208:211], v[160:163], v[0:3]
    v_mfma_f32_16x16x32_bf16 v[20:23], v[208:211], v[164:167], v[20:23]
    s_mul_i32 s27, s56, 40960
    s_add_u32 s27, s27, s26
    s_lshl_b32 s57, s56, 17
    s_add_u32 s57, s57, s29
    s_add_u32 s56, s56, 1
    s_cmp_eq_u32 s56, s25
    s_cselect_b32 s56, 0, s56
    s_add_u32 m0, s28, 27648
    s_nop 0
    buffer_load_dwordx4 v247, s[8:11], s27 offen lds
    v_mfma_f32_16x16x32_bf16 v[40:43], v[208:211], v[168:171], v[40:43]
    v_mfma_f32_16x16x32_bf16 v[60:63], v[208:211], v[172:175], v[60:63]
    s_add_u32 m0, s28, 28672
    s_nop 0
    buffer_load_dwordx4 v248, s[8:11], s27 offen lds
    ds_read_b64_tr_b16 v[196:197], v241 offset:96
    ds_read_b64_tr_b16 v[198:199], v241 offset:2656
    s_waitcnt lgkmcnt(4)
    v_mfma_f32_16x16x32_bf16 v[4:7], v[212:215], v[160:163], v[4:7]
    v_mfma_f32_16x16x32_bf16 v[24:27], v[212:215], v[164:167], v[24:27]
    s_add_u32 m0, s28, 29696
    s_nop 0
    buffer_load_dwordx4 v249, s[8:11], s27 offen lds
    v_mfma_f32_16x16x32_bf16 v[44:47], v[212:215], v[168:171], v[44:47]
    v_mfma_f32_16x16x32_bf16 v[64:67], v[212:215], v[172:175], v[64:67]
    s_add_u32 m0, s28, 30720
    s_nop 0
    buffer_load_dwordx4 v250, s[8:11], s27 offen lds
    ds_read_b64_tr_b16 v[200:201], v241 offset:128
    ds_read_b64_tr_b16 v[202:203], v241 offset:2688
    s_waitcnt lgkmcnt(4)
    v_mfma_f32_16x16x32_bf16 v[8:11], v[192:195], v[160:163], v[8:11]
    v_mfma_f32_16x16x32_bf16 v[28:31], v[192:195], v[164:167], v[28:31]
    s_add_u32 m0, s28, 31744
    s_nop 0
    buffer_load_dwordx4 v251, s[8:11], s27 offen lds
    s_add_u32 m0, s28, 32768
    s_nop 0
    buffer_load_dwordx4 v246, s[4:7], s57 offen sc1 lds
    s_add_u32 s57, s57, 32768
    v_mfma_f32_16x16x32_bf16 v[48:51], v[192:195], v[168:171], v[48:51]
    v_mfma_f32_16x16x32_bf16 v[68:71], v[192:195], v[172:175], v[68:71]
    s_add_u32 m0, s28, 33792
    s_nop 0
    buffer_load_dwordx4 v246, s[4:7], s57 offen sc1 lds
    s_add_u32 s57, s57, 32768
    s_add_u32 m0, s28, 34816
    s_nop 0
    buffer_load_dwordx4 v246, s[4:7], s57 offen sc1 lds
    s_add_u32 s57, s57, 32768
    s_add_u32 m0, s28, 35840
    s_nop 0
    buffer_load_dwordx4 v246, s[4:7], s57 offen sc1 lds
    s_waitcnt vmcnt(18)
    ds_read_b128 v[176:179], v242 offset:14336
    ds_read_b128 v[180:183], v242 offset:14592
    ds_read_b128 v[184:187], v242 offset:14848
    ds_read_b128 v[188:191], v242 offset:15104
    ds_read_b64_tr_b16 v[204:205], v241 offset:9216
    ds_read_b64_tr_b16 v[206:207], v241 offset:11776
    s_waitcnt lgkmcnt(8)
    v_mfma_f32_16x16x32_bf16 v[12:15], v[196:199], v[160:163], v[12:15]
    v_mfma_f32_16x16x32_bf16 v[32:35], v[196:199], v[164:167], v[32:35]
    v_mfma_f32_16x16x32_bf16 v[52:55], v[196:199], v[168:171], v[52:55]
    v_mfma_f32_16x16x32_bf16 v[72:75], v[196:199], v[172:175], v[72:75]
    ds_read_b64_tr_b16 v[208:209], v241 offset:9248
    ds_read_b64_tr_b16 v[210:211], v241 offset:11808
    s_waitcnt lgkmcnt(8)
    v_mfma_f32_16x16x32_bf16 v[16:19], v[200:203], v[160:163], v[16:19]
    v_mfma_f32_16x16x32_bf16 v[36:39], v[200:203], v[164:167], v[36:39]
    v_mfma_f32_16x16x32_bf16 v[56:59], v[200:203], v[168:171], v[56:59]
    v_mfma_f32_16x16x32_bf16 v[76:79], v[200:203], v[172:175], v[76:79]
    ds_read_b64_tr_b16 v[212:213], v241 offset:9280
    ds_read_b64_tr_b16 v[214:215], v241 offset:11840
    s_waitcnt lgkmcnt(4)
    v_mfma_f32_16x16x32_bf16 v[0:3], v[204:207], v[176:179], v[0:3]
    v_mfma_f32_16x16x32_bf16 v[20:23], v[204:207], v[180:183], v[20:23]
    s_mul_i32 s27, s56, 40960
    s_add_u32 s27, s27, s26
    s_lshl_b32 s57, s56, 17
    s_add_u32 s57, s57, s29
    s_add_u32 s56, s56, 1
    s_cmp_eq_u32 s56, s25
    s_cselect_b32 s56, 0, s56
    s_add_u32 m0, s28, 0
    s_nop 0
    buffer_load_dwordx4 v247, s[8:11], s27 offen lds
    v_mfma_f32_16x16x32_bf16 v[40:43], v[204:207], v[184:187], v[40:43]
    v_mfma_f32_16x16x32_bf16 v[60:63], v[204:207], v[188:191], v[60:63]
    s_add_u32 m0, s28, 1024
    s_nop 0
    buffer_load_dwordx4 v248, s[8:11], s27 offen lds
    ds_read_b64_tr_b16 v[192:193], v241 offset:9312
    ds_read_b64_tr_b16 v[194:195], v241 offset:11872
    s_waitcnt lgkmcnt(4)
    v_mfma_f32_16x16x32_bf16 v[4:7], v[208:211], v[176:179], v[4:7]
    v_mfma_f32_16x16x32_bf16 v[24:27], v[208:211], v[180:183], v[24:27]
    s_add_u32 m0, s28, 2048
    s_nop 0
    buffer_load_dwordx4 v249, s[8:11], s27 offen lds
    v_mfma_f32_16x16x32_bf16 v[44:47], v[208:211], v[184:187], v[44:47]
    v_mfma_f32_16x16x32_bf16 v[64:67], v[208:211], v[188:191], v[64:67]
    s_add_u32 m0, s28, 3072
    s_nop 0
    buffer_load_dwordx4 v250, s[8:11], s27 offen lds
    ds_read_b64_tr_b16 v[196:197], v241 offset:9344
    ds_read_b64_tr_b16 v[198:199], v241 offset:11904
    s_waitcnt lgkmcnt(4)
    v_mfma_f32_16x16x32_bf16 v[8:11], v[212:215], v[176:179], v[8:11]
    v_mfma_f32_16x16x32_bf16 v[28:31], v[212:215], v[180:183], v[28:31]
    s_add_u32 m0, s28, 4096
    s_nop 0
    buffer_load_dwordx4 v251, s[8:11], s27 offen lds
    s_add_u32 m0, s28, 5120
    s_nop 0
    buffer_load_dwordx4 v246, s[4:7], s57 offen sc1 lds
    s_add_u32 s57, s57, 32768
    v_mfma_f32_16x16x32_bf16 v[48:51], v[212:215], v[184:187], v[48:51]
    v_mfma_f32_16x16x32_bf16 v[68:71], v[212:215], v[188:191], v[68:71]
    s_add_u32 m0, s28, 6144
    s_nop 0
    buffer_load_dwordx4 v246, s[4:7], s57 offen sc1 lds
    s_add_u32 s57, s57, 32768
    s_add_u32 m0, s28, 7168
    s_nop 0
    buffer_load_dwordx4 v246, s[4:7], s57 offen sc1 lds
    s_add_u32 s57, s57, 32768
    s_add_u32 m0, s28, 8192
    s_nop 0
    buffer_load_dwordx4 v246, s[4:7], s57 offen sc1 lds
    s_waitcnt vmcnt(18)
    ds_read_b128 v[160:163], v242 offset:23552
    ds_read_b128 v[164:167], v242 offset:23808
    ds_read_b128 v[168:171], v242 offset:24064
    ds_read_b128 v[172:175], v242 offset:24320
    ds_read_b64_tr_b16 v[200:201], v241 offset:18432
    ds_read_b64_tr_b16 v[202:203], v241 offset:20992
    s_waitcnt lgkmcnt(8)
    v_mfma_f32_16x16x32_bf16 v[12:15], v[192:195], v[176:179], v[12:15]
    v_mfma_f32_16x16x32_bf16 v[32:35], v[192:195], v[180:183], v[32:35]
    v_mfma_f32_16x16x32_bf16 v[52:55], v[192:195], v[184:187], v[52:55]
    v_mfma_f32_16x16x32_bf16 v[72:75], v[192:195], v[188:191], v[72:75]
    ds_read_b64_tr_b16 v[204:205], v241 offset:18464
    ds_read_b64_tr_b16 v[206:207], v241 offset:21024
    s_waitcnt lgkmcnt(8)
    v_mfma_f32_16x16x32_bf16 v[16:19], v[196:199], v[176:179], v[16:19]
    v_mfma_f32_16x16x32_bf16 v[36:39], v[196:199], v[180:183], v[36:39]
    v_mfma_f32_16x16x32_bf16 v[56:59], v[196:199], v[184:187], v[56:59]
    v_mfma_f32_16x16x32_bf16 v[76:79], v[196:199], v[188:191], v[76:79]
    ds_read_b64_tr_b16 v[208:209], v241 offset:18496
    ds_read_b64_tr_b16 v[210:211], v241 offset:21056
    s_waitcnt lgkmcnt(4)
    v_mfma_f32_16x16x32_bf16 v[0:3], v[200:203], v[160:163], v[0:3]
    v_mfma_f32_16x16x32_bf16 v[20:23], v[200:203], v[164:167], v[20:23]
    s_mul_i32 s27, s56, 40960
    s_add_u32 s27, s27, s26
    s_lshl_b32 s57, s56, 17
    s_add_u32 s57, s57, s29
    s_cmp_eq_u32 s25, 14
    s_cselect_b32 s27, s27, 1073741824
    s_cselect_b32 s57, s57, 1073741824
    s_add_u32 s56, s56, 1
    s_cmp_eq_u32 s56, s25
    s_cselect_b32 s56, 0, s56
    s_add_u32 m0, s28, 9216
    s_nop 0
    buffer_load_dwordx4 v247, s[8:11], s27 offen lds
    v_mfma_f32_16x16x32_bf16 v[40:43], v[200:203], v[168:171], v[40:43]
    v_mfma_f32_16x16x32_bf16 v[60:63], v[200:203], v[172:175], v[60:63]
    s_add_u32 m0, s28, 10240
    s_nop 0
    buffer_load_dwordx4 v248, s[8:11], s27 offen lds
    ds_read_b64_tr_b16 v[212:213], v241 offset:18528
    ds_read_b64_tr_b16 v[214:215], v241 offset:21088
    s_waitcnt lgkmcnt(4)
    v_mfma_f32_16x16x32_bf16 v[4:7], v[204:207], v[160:163], v[4:7]
    v_mfma_f32_16x16x32_bf16 v[24:27], v[204:207], v[164:167], v[24:27]
    s_add_u32 m0, s28, 11264
    s_nop 0
    buffer_load_dwordx4 v249, s[8:11], s27 offen lds
    v_mfma_f32_16x16x32_bf16 v[44:47], v[204:207], v[168:171], v[44:47]
    v_mfma_f32_16x16x32_bf16 v[64:67], v[204:207], v[172:175], v[64:67]
    s_add_u32 m0, s28, 12288
    s_nop 0
    buffer_load_dwordx4 v250, s[8:11], s27 offen lds
    ds_read_b64_tr_b16 v[192:193], v241 offset:18560
    ds_read_b64_tr_b16 v[194:195], v241 offset:21120
    s_waitcnt lgkmcnt(4)
    v_mfma_f32_16x16x32_bf16 v[8:11], v[208:211], v[160:163], v[8:11]
    v_mfma_f32_16x16x32_bf16 v[28:31], v[208:211], v[164:167], v[28:31]
    s_add_u32 m0, s28, 13312
    s_nop 0
    buffer_load_dwordx4 v251, s[8:11], s27 offen lds
    s_add_u32 m0, s28, 14336
    s_nop 0
    buffer_load_dwordx4 v246, s[4:7], s57 offen sc1 lds
    s_add_u32 s57, s57, 32768
    v_mfma_f32_16x16x32_bf16 v[48:51], v[208:211], v[168:171], v[48:51]
    v_mfma_f32_16x16x32_bf16 v[68:71], v[208:211], v[172:175], v[68:71]
    s_add_u32 m0, s28, 15360
    s_nop 0
    buffer_load_dwordx4 v246, s[4:7], s57 offen sc1 lds
    s_add_u32 s57, s57, 32768
    s_add_u32 m0, s28, 16384
    s_nop 0
    buffer_load_dwordx4 v246, s[4:7], s57 offen sc1 lds
    s_add_u32 s57, s57, 32768
    s_add_u32 m0, s28, 17408
    s_nop 0
    buffer_load_dwordx4 v246, s[4:7], s57 offen sc1 lds
    s_waitcnt vmcnt(18)
    ds_read_b128 v[176:179], v242 offset:32768
    ds_read_b128 v[180:183], v242 offset:33024
    ds_read_b128 v[184:187], v242 offset:33280
    ds_read_b128 v[188:191], v242 offset:33536
    ds_read_b64_tr_b16 v[196:197], v241 offset:27648
    ds_read_b64_tr_b16 v[198:199], v241 offset:30208
    s_waitcnt lgkmcnt(8)
    v_mfma_f32_16x16x32_bf16 v[12:15], v[212:215], v[160:163], v[12:15]
    v_mfma_f32_16x16x32_bf16 v[32:35], v[212:215], v[164:167], v[32:35]
    v_mfma_f32_16x16x32_bf16 v[52:55], v[212:215], v[168:171], v[52:55]
    v_mfma_f32_16x16x32_bf16 v[72:75], v[212:215], v[172:175], v[72:75]
    ds_read_b64_tr_b16 v[200:201], v241 offset:27680
    ds_read_b64_tr_b16 v[202:203], v241 offset:30240
    s_waitcnt lgkmcnt(8)
    v_mfma_f32_16x16x32_bf16 v[16:19], v[192:195], v[160:163], v[16:19]
    v_mfma_f32_16x16x32_bf16 v[36:39], v[192:195], v[164:167], v[36:39]
    v_mfma_f32_16x16x32_bf16 v[56:59], v[192:195], v[168:171], v[56:59]
    v_mfma_f32_16x16x32_bf16 v[76:79], v[192:195], v[172:175], v[76:79]
    ds_read_b64_tr_b16 v[204:205], v241 offset:27712
    ds_read_b64_tr_b16 v[206:207], v241 offset:30272
    s_waitcnt lgkmcnt(4)
    v_mfma_f32_16x16x32_bf16 v[0:3], v[196:199], v[176:179], v[0:3]
    v_mfma_f32_16x16x32_bf16 v[20:23], v[196:199], v[180:183], v[20:23]
    s_mul_i32 s27, s23, 204800
    s_add_u32 m0, s28, 18432
    s_nop 0
    buffer_load_dwordx4 v216, s[48:51], s27 offen lds
    v_mfma_f32_16x16x32_bf16 v[40:43], v[196:199], v[184:187], v[40:43]
    v_mfma_f32_16x16x32_bf16 v[60:63], v[196:199], v[188:191], v[60:63]
    s_add_u32 m0, s28, 19456
    s_nop 0
    buffer_load_dwordx4 v217, s[48:51], s27 offen lds
    ds_read_b64_tr_b16 v[208:209], v241 offset:27744
    ds_read_b64_tr_b16 v[210:211], v241 offset:30304
    s_waitcnt lgkmcnt(4)
    v_mfma_f32_16x16x32_bf16 v[4:7], v[200:203], v[176:179], v[4:7]
    v_mfma_f32_16x16x32_bf16 v[24:27], v[200:203], v[180:183], v[24:27]
    s_add_u32 m0, s28, 20480
    s_nop 0
    buffer_load_dwordx4 v218, s[48:51], s27 offen lds
    v_mfma_f32_16x16x32_bf16 v[44:47], v[200:203], v[184:187], v[44:47]
    v_mfma_f32_16x16x32_bf16 v[64:67], v[200:203], v[188:191], v[64:67]
    s_add_u32 m0, s28, 21504
    s_nop 0
    buffer_load_dwordx4 v219, s[48:51], s27 offen lds
    ds_read_b64_tr_b16 v[212:213], v241 offset:27776
    ds_read_b64_tr_b16 v[214:215], v241 offset:30336
    s_waitcnt lgkmcnt(4)
    v_mfma_f32_16x16x32_bf16 v[8:11], v[204:207], v[176:179], v[8:11]
    v_mfma_f32_16x16x32_bf16 v[28:31], v[204:207], v[180:183], v[28:31]
    s_add_u32 m0, s28, 22528
    s_nop 0
    buffer_load_dwordx4 v220, s[48:51], s27 offen lds
    v_mfma_f32_16x16x32_bf16 v[48:51], v[204:207], v[184:187], v[48:51]
    v_mfma_f32_16x16x32_bf16 v[68:71], v[204:207], v[188:191], v[68:71]
    s_waitcnt vmcnt(14)
    ds_read_b128 v[160:163], v242 offset:5120
    ds_read_b128 v[164:167], v242 offset:5376
    ds_read_b128 v[168:171], v242 offset:5632
    ds_read_b128 v[172:175], v242 offset:5888
    ds_read_b64_tr_b16 v[192:193], v241 offset:0
    ds_read_b64_tr_b16 v[194:195], v241 offset:2560
    s_waitcnt lgkmcnt(8)
    v_mfma_f32_16x16x32_bf16 v[12:15], v[208:211], v[176:179], v[12:15]
    v_mfma_f32_16x16x32_bf16 v[32:35], v[208:211], v[180:183], v[32:35]
    v_mfma_f32_16x16x32_bf16 v[52:55], v[208:211], v[184:187], v[52:55]
    v_mfma_f32_16x16x32_bf16 v[72:75], v[208:211], v[188:191], v[72:75]
    ds_read_b64_tr_b16 v[196:197], v241 offset:32
    ds_read_b64_tr_b16 v[198:199], v241 offset:2592
    s_waitcnt lgkmcnt(8)
    v_mfma_f32_16x16x32_bf16 v[16:19], v[212:215], v[176:179], v[16:19]
    v_mfma_f32_16x16x32_bf16 v[36:39], v[212:215], v[180:183], v[36:39]
    v_mfma_f32_16x16x32_bf16 v[56:59], v[212:215], v[184:187], v[56:59]
    v_mfma_f32_16x16x32_bf16 v[76:79], v[212:215], v[188:191], v[76:79]
    ds_read_b64_tr_b16 v[200:201], v241 offset:64
    ds_read_b64_tr_b16 v[202:203], v241 offset:2624
    s_waitcnt lgkmcnt(4)
    v_mfma_f32_16x16x32_bf16 v[0:3], v[192:195], v[160:163], v[0:3]
    v_mfma_f32_16x16x32_bf16 v[20:23], v[192:195], v[164:167], v[20:23]
    s_mul_i32 s27, s23, 204800
    s_add_u32 m0, s28, 27648
    s_nop 0
    buffer_load_dwordx4 v221, s[48:51], s27 offen lds
    v_mfma_f32_16x16x32_bf16 v[40:43], v[192:195], v[168:171], v[40:43]
    v_mfma_f32_16x16x32_bf16 v[60:63], v[192:195], v[172:175], v[60:63]
    s_add_u32 m0, s28, 28672
    s_nop 0
    buffer_load_dwordx4 v222, s[48:51], s27 offen lds
    ds_read_b64_tr_b16 v[204:205], v241 offset:96
    ds_read_b64_tr_b16 v[206:207], v241 offset:2656
    s_waitcnt lgkmcnt(4)
    v_mfma_f32_16x16x32_bf16 v[4:7], v[196:199], v[160:163], v[4:7]
    v_mfma_f32_16x16x32_bf16 v[24:27], v[196:199], v[164:167], v[24:27]
    s_add_u32 m0, s28, 29696
    s_nop 0
    buffer_load_dwordx4 v223, s[48:51], s27 offen lds
    v_mfma_f32_16x16x32_bf16 v[44:47], v[196:199], v[168:171], v[44:47]
    v_mfma_f32_16x16x32_bf16 v[64:67], v[196:199], v[172:175], v[64:67]
    s_add_u32 m0, s28, 30720
    s_nop 0
    buffer_load_dwordx4 v224, s[48:51], s27 offen lds
    ds_read_b64_tr_b16 v[208:209], v241 offset:128
    ds_read_b64_tr_b16 v[210:211], v241 offset:2688
    s_waitcnt lgkmcnt(4)
    v_mfma_f32_16x16x32_bf16 v[8:11], v[200:203], v[160:163], v[8:11]
    v_mfma_f32_16x16x32_bf16 v[28:31], v[200:203], v[164:167], v[28:31]
    s_add_u32 m0, s28, 31744
    s_nop 0
    buffer_load_dwordx4 v225, s[48:51], s27 offen lds
    v_mfma_f32_16x16x32_bf16 v[48:51], v[200:203], v[168:171], v[48:51]
    v_mfma_f32_16x16x32_bf16 v[68:71], v[200:203], v[172:175], v[68:71]
    s_waitcnt vmcnt(10)
    ds_read_b128 v[176:179], v242 offset:14336
    ds_read_b128 v[180:183], v242 offset:14592
    ds_read_b128 v[184:187], v242 offset:14848
    ds_read_b128 v[188:191], v242 offset:15104
    ds_read_b64_tr_b16 v[212:213], v241 offset:9216
    ds_read_b64_tr_b16 v[214:215], v241 offset:11776
    s_waitcnt lgkmcnt(8)
    v_mfma_f32_16x16x32_bf16 v[12:15], v[204:207], v[160:163], v[12:15]
    v_mfma_f32_16x16x32_bf16 v[32:35], v[204:207], v[164:167], v[32:35]
    v_mfma_f32_16x16x32_bf16 v[52:55], v[204:207], v[168:171], v[52:55]
    v_mfma_f32_16x16x32_bf16 v[72:75], v[204:207], v[172:175], v[72:75]
    ds_read_b64_tr_b16 v[192:193], v241 offset:9248
    ds_read_b64_tr_b16 v[194:195], v241 offset:11808
    s_waitcnt lgkmcnt(8)
    v_mfma_f32_16x16x32_bf16 v[16:19], v[208:211], v[160:163], v[16:19]
    v_mfma_f32_16x16x32_bf16 v[36:39], v[208:211], v[164:167], v[36:39]
    v_mfma_f32_16x16x32_bf16 v[56:59], v[208:211], v[168:171], v[56:59]
    v_mfma_f32_16x16x32_bf16 v[76:79], v[208:211], v[172:175], v[76:79]
    ds_read_b64_tr_b16 v[196:197], v241 offset:9280
    ds_read_b64_tr_b16 v[198:199], v241 offset:11840
    s_waitcnt lgkmcnt(4)
    v_mfma_f32_16x16x32_bf16 v[0:3], v[212:215], v[176:179], v[0:3]
    v_mfma_f32_16x16x32_bf16 v[20:23], v[212:215], v[180:183], v[20:23]
    s_mul_i32 s27, s23, 204800
    s_add_u32 m0, s28, 0
    s_nop 0
    buffer_load_dwordx4 v226, s[48:51], s27 offen lds
    v_mfma_f32_16x16x32_bf16 v[40:43], v[212:215], v[184:187], v[40:43]
    v_mfma_f32_16x16x32_bf16 v[60:63], v[212:215], v[188:191], v[60:63]
    s_add_u32 m0, s28, 1024
    s_nop 0
    buffer_load_dwordx4 v227, s[48:51], s27 offen lds
    ds_read_b64_tr_b16 v[200:201], v241 offset:9312
    ds_read_b64_tr_b16 v[202:203], v241 offset:11872
    s_waitcnt lgkmcnt(4)
    v_mfma_f32_16x16x32_bf16 v[4:7], v[192:195], v[176:179], v[4:7]
    v_mfma_f32_16x16x32_bf16 v[24:27], v[192:195], v[180:183], v[24:27]
    s_add_u32 m0, s28, 2048
    s_nop 0
    buffer_load_dwordx4 v228, s[48:51], s27 offen lds
    v_mfma_f32_16x16x32_bf16 v[44:47], v[192:195], v[184:187], v[44:47]
    v_mfma_f32_16x16x32_bf16 v[64:67], v[192:195], v[188:191], v[64:67]
    s_add_u32 m0, s28, 3072
    s_nop 0
    buffer_load_dwordx4 v229, s[48:51], s27 offen lds
    ds_read_b64_tr_b16 v[204:205], v241 offset:9344
    ds_read_b64_tr_b16 v[206:207], v241 offset:11904
    s_waitcnt lgkmcnt(4)
    v_mfma_f32_16x16x32_bf16 v[8:11], v[196:199], v[176:179], v[8:11]
    v_mfma_f32_16x16x32_bf16 v[28:31], v[196:199], v[180:183], v[28:31]
    s_add_u32 m0, s28, 4096
    s_nop 0
    buffer_load_dwordx4 v230, s[48:51], s27 offen lds
    v_mfma_f32_16x16x32_bf16 v[48:51], v[196:199], v[184:187], v[48:51]
    v_mfma_f32_16x16x32_bf16 v[68:71], v[196:199], v[188:191], v[68:71]
    s_lshr_b32 s30, s20, 1
    s_lshl_b32 s30, s30, 8
    s_add_u32 s30, s30, 17039360
    v_mov_b32 v253, s30
K2_poll:
    buffer_load_dword v254, v253, s[4:7], 0 offen sc1
    s_waitcnt vmcnt(0)
    v_readfirstlane_b32 s30, v254
    s_cmp_ge_u32 s30, 64
    s_cbranch_scc1 K2_go
    s_sleep 4
    s_sub_u32 s95, s95, 1
    s_cbranch_scc1 K2_exit
    s_branch K2_poll
K2_go:
    s_mul_i32 s57, s23, 655360
    s_add_u32 s57, s57, 14417920
    s_add_u32 m0, s28, 23552
    s_nop 0
    buffer_load_dwordx4 v246, s[4:7], s57 offen sc1 lds
    s_add_u32 s57, s57, 32768
    s_add_u32 m0, s28, 24576
    s_nop 0
    buffer_load_dwordx4 v246, s[4:7], s57 offen sc1 lds
    s_add_u32 s57, s57, 32768
    s_add_u32 m0, s28, 25600
    s_nop 0
    buffer_load_dwordx4 v246, s[4:7], s57 offen sc1 lds
    s_add_u32 s57, s57, 32768
    s_add_u32 m0, s28, 26624
    s_nop 0
    buffer_load_dwordx4 v246, s[4:7], s57 offen sc1 lds
    s_mul_i32 s57, s23, 655360
    s_add_u32 s57, s57, 14548992
    s_add_u32 m0, s28, 32768
    s_nop 0
    buffer_load_dwordx4 v246, s[4:7], s57 offen sc1 lds
    s_add_u32 s57, s57, 32768
    s_add_u32 m0, s28, 33792
    s_nop 0
    buffer_load_dwordx4 v246, s[4:7], s57 offen sc1 lds
    s_add_u32 s57, s57, 32768
    s_add_u32 m0, s28, 34816
    s_nop 0
    buffer_load_dwordx4 v246, s[4:7], s57 offen sc1 lds
    s_add_u32 s57, s57, 32768
    s_add_u32 m0, s28, 35840
    s_nop 0
    buffer_load_dwordx4 v246, s[4:7], s57 offen sc1 lds
    s_mul_i32 s57, s23, 655360
    s_add_u32 s57, s57, 14680064
    s_add_u32 m0, s28, 5120
    s_nop 0
    buffer_load_dwordx4 v246, s[4:7], s57 offen sc1 lds
    s_add_u32 s57, s57, 32768
    s_add_u32 m0, s28, 6144
    s_nop 0
    buffer_load_dwordx4 v246, s[4:7], s57 offen sc1 lds
    s_add_u32 s57, s57, 32768
    s_add_u32 m0, s28, 7168
    s_nop 0
    buffer_load_dwordx4 v246, s[4:7], s57 offen sc1 lds
    s_add_u32 s57, s57, 32768
    s_add_u32 m0, s28, 8192
    s_nop 0
    buffer_load_dwordx4 v246, s[4:7], s57 offen sc1 lds
    s_waitcnt vmcnt(8)
    ds_read_b128 v[160:163], v242 offset:23552
    ds_read_b128 v[164:167], v242 offset:23808
    ds_read_b128 v[168:171], v242 offset:24064
    ds_read_b128 v[172:175], v242 offset:24320
    ds_read_b64_tr_b16 v[208:209], v241 offset:18432
    ds_read_b64_tr_b16 v[210:211], v241 offset:20992
    s_waitcnt lgkmcnt(8)
    v_mfma_f32_16x16x32_bf16 v[12:15], v[200:203], v[176:179], v[12:15]
    v_mfma_f32_16x16x32_bf16 v[32:35], v[200:203], v[180:183], v[32:35]
    v_mfma_f32_16x16x32_bf16 v[52:55], v[200:203], v[184:187], v[52:55]
    v_mfma_f32_16x16x32_bf16 v[72:75], v[200:203], v[188:191], v[72:75]
    ds_read_b64_tr_b16 v[212:213], v241 offset:18464
    ds_read_b64_tr_b16 v[214:215], v241 offset:21024
    s_waitcnt lgkmcnt(8)
    v_mfma_f32_16x16x32_bf16 v[16:19], v[204:207], v[176:179], v[16:19]
    v_mfma_f32_16x16x32_bf16 v[36:39], v[204:207], v[180:183], v[36:39]
    v_mfma_f32_16x16x32_bf16 v[56:59], v[204:207], v[184:187], v[56:59]
    v_mfma_f32_16x16x32_bf16 v[76:79], v[204:207], v[188:191], v[76:79]
    ds_read_b64_tr_b16 v[192:193], v241 offset:18496
    ds_read_b64_tr_b16 v[194:195], v241 offset:21056
    s_waitcnt lgkmcnt(4)
    v_mfma_f32_16x16x32_bf16 v[80:83], v[208:211], v[160:163], 0
    v_mfma_f32_16x16x32_bf16 v[100:103], v[208:211], v[164:167], 0
    s_mul_i32 s27, s23, 204800
    s_add_u32 m0, s28, 9216
    s_nop 0
    buffer_load_dwordx4 v231, s[48:51], s27 offen lds
    v_mfma_f32_16x16x32_bf16 v[120:123], v[208:211], v[168:171], 0
    v_mfma_f32_16x16x32_bf16 v[140:143], v[208:211], v[172:175], 0
    s_add_u32 m0, s28, 10240
    s_nop 0
    buffer_load_dwordx4 v232, s[48:51], s27 offen lds
    ds_read_b64_tr_b16 v[196:197], v241 offset:18528
    ds_read_b64_tr_b16 v[198:199], v241 offset:21088
    s_waitcnt lgkmcnt(4)
    v_mfma_f32_16x16x32_bf16 v[84:87], v[212:215], v[160:163], 0
    v_mfma_f32_16x16x32_bf16 v[104:107], v[212:215], v[164:167], 0
    s_add_u32 m0, s28, 11264
    s_nop 0
    buffer_load_dwordx4 v233, s[48:51], s27 offen lds
    v_mfma_f32_16x16x32_bf16 v[124:127], v[212:215], v[168:171], 0
    v_mfma_f32_16x16x32_bf16 v[144:147], v[212:215], v[172:175], 0
    s_add_u32 m0, s28, 12288
    s_nop 0
    buffer_load_dwordx4 v234, s[48:51], s27 offen lds
    ds_read_b64_tr_b16 v[200:201], v241 offset:18560
    ds_read_b64_tr_b16 v[202:203], v241 offset:21120
    s_waitcnt lgkmcnt(4)
    v_mfma_f32_16x16x32_bf16 v[88:91], v[192:195], v[160:163], 0
    v_mfma_f32_16x16x32_bf16 v[108:111], v[192:195], v[164:167], 0
    s_add_u32 m0, s28, 13312
    s_nop 0
    buffer_load_dwordx4 v235, s[48:51], s27 offen lds
    s_mul_i32 s57, s23, 655360
    s_add_u32 s57, s57, 14811136
    s_add_u32 m0, s28, 14336
    s_nop 0
    buffer_load_dwordx4 v246, s[4:7], s57 offen sc1 lds
    s_add_u32 s57, s57, 32768
    v_mfma_f32_16x16x32_bf16 v[128:131], v[192:195], v[168:171], 0
    v_mfma_f32_16x16x32_bf16 v[148:151], v[192:195], v[172:175], 0
    s_add_u32 m0, s28, 15360
    s_nop 0
    buffer_load_dwordx4 v246, s[4:7], s57 offen sc1 lds
    s_add_u32 s57, s57, 32768
    s_add_u32 m0, s28, 16384
    s_nop 0
    buffer_load_dwordx4 v246, s[4:7], s57 offen sc1 lds
    s_add_u32 s57, s57, 32768
    s_add_u32 m0, s28, 17408
    s_nop 0
    buffer_load_dwordx4 v246, s[4:7], s57 offen sc1 lds
    s_waitcnt vmcnt(13)
    ds_read_b128 v[176:179], v242 offset:32768
    ds_read_b128 v[180:183], v242 offset:33024
    ds_read_b128 v[184:187], v242 offset:33280
    ds_read_b128 v[188:191], v242 offset:33536
    ds_read_b64_tr_b16 v[204:205], v241 offset:27648
    ds_read_b64_tr_b16 v[206:207], v241 offset:30208
    s_waitcnt lgkmcnt(8)
    v_mfma_f32_16x16x32_bf16 v[92:95], v[196:199], v[160:163], 0
    v_mfma_f32_16x16x32_bf16 v[112:115], v[196:199], v[164:167], 0
    v_mfma_f32_16x16x32_bf16 v[132:135], v[196:199], v[168:171], 0
    v_mfma_f32_16x16x32_bf16 v[152:155], v[196:199], v[172:175], 0
    ds_read_b64_tr_b16 v[208:209], v241 offset:27680
    ds_read_b64_tr_b16 v[210:211], v241 offset:30240
    s_waitcnt lgkmcnt(8)
    v_mfma_f32_16x16x32_bf16 v[96:99], v[200:203], v[160:163], 0
    v_mfma_f32_16x16x32_bf16 v[116:119], v[200:203], v[164:167], 0
    v_mfma_f32_16x16x32_bf16 v[136:139], v[200:203], v[168:171], 0
    v_mfma_f32_16x16x32_bf16 v[156:159], v[200:203], v[172:175], 0
    ds_read_b64_tr_b16 v[212:213], v241 offset:27712
    ds_read_b64_tr_b16 v[214:215], v241 offset:30272
    s_waitcnt lgkmcnt(4)
    v_mfma_f32_16x16x32_bf16 v[80:83], v[204:207], v[176:179], v[80:83]
    v_mfma_f32_16x16x32_bf16 v[100:103], v[204:207], v[180:183], v[100:103]
    s_mul_i32 s27, s23, 204800
    s_add_u32 m0, s28, 18432
    s_nop 0
    buffer_load_dwordx4 v236, s[48:51], s27 offen lds
    v_mfma_f32_16x16x32_bf16 v[120:123], v[204:207], v[184:187], v[120:123]
    v_mfma_f32_16x16x32_bf16 v[140:143], v[204:207], v[188:191], v[140:143]
    s_add_u32 m0, s28, 19456
    s_nop 0
    buffer_load_dwordx4 v237, s[48:51], s27 offen lds
    ds_read_b64_tr_b16 v[192:193], v241 offset:27744
    ds_read_b64_tr_b16 v[194:195], v241 offset:30304
    s_waitcnt lgkmcnt(4)
    v_mfma_f32_16x16x32_bf16 v[84:87], v[208:211], v[176:179], v[84:87]
    v_mfma_f32_16x16x32_bf16 v[104:107], v[208:211], v[180:183], v[104:107]
    s_add_u32 m0, s28, 20480
    s_nop 0
    buffer_load_dwordx4 v238, s[48:51], s27 offen lds
    v_mfma_f32_16x16x32_bf16 v[124:127], v[208:211], v[184:187], v[124:127]
    v_mfma_f32_16x16x32_bf16 v[144:147], v[208:211], v[188:191], v[144:147]
    s_add_u32 m0, s28, 21504
    s_nop 0
    buffer_load_dwordx4 v239, s[48:51], s27 offen lds
    ds_read_b64_tr_b16 v[196:197], v241 offset:27776
    ds_read_b64_tr_b16 v[198:199], v241 offset:30336
    s_waitcnt lgkmcnt(4)
    v_mfma_f32_16x16x32_bf16 v[88:91], v[212:215], v[176:179], v[88:91]
    v_mfma_f32_16x16x32_bf16 v[108:111], v[212:215], v[180:183], v[108:111]
    s_add_u32 m0, s28, 22528
    s_nop 0
    buffer_load_dwordx4 v240, s[48:51], s27 offen lds
    s_mul_i32 s57, s23, 655360
    s_add_u32 s57, s57, 14942208
    s_add_u32 m0, s28, 23552
    s_nop 0
    buffer_load_dwordx4 v246, s[4:7], s57 offen sc1 lds
    s_add_u32 s57, s57, 32768
    v_mfma_f32_16x16x32_bf16 v[128:131], v[212:215], v[184:187], v[128:131]
    v_mfma_f32_16x16x32_bf16 v[148:151], v[212:215], v[188:191], v[148:151]
    s_add_u32 m0, s28, 24576
    s_nop 0
    buffer_load_dwordx4 v246, s[4:7], s57 offen sc1 lds
    s_add_u32 s57, s57, 32768
    s_add_u32 m0, s28, 25600
    s_nop 0
    buffer_load_dwordx4 v246, s[4:7], s57 offen sc1 lds
    s_add_u32 s57, s57, 32768
    s_add_u32 m0, s28, 26624
    s_nop 0
    buffer_load_dwordx4 v246, s[4:7], s57 offen sc1 lds
    s_waitcnt vmcnt(18)
    ds_read_b128 v[160:163], v242 offset:5120
    ds_read_b128 v[164:167], v242 offset:5376
    ds_read_b128 v[168:171], v242 offset:5632
    ds_read_b128 v[172:175], v242 offset:5888
    ds_read_b64_tr_b16 v[200:201], v241 offset:0
    ds_read_b64_tr_b16 v[202:203], v241 offset:2560
    s_waitcnt lgkmcnt(8)
    v_mfma_f32_16x16x32_bf16 v[92:95], v[192:195], v[176:179], v[92:95]
    v_mfma_f32_16x16x32_bf16 v[112:115], v[192:195], v[180:183], v[112:115]
    v_mfma_f32_16x16x32_bf16 v[132:135], v[192:195], v[184:187], v[132:135]
    v_mfma_f32_16x16x32_bf16 v[152:155], v[192:195], v[188:191], v[152:155]
    ds_read_b64_tr_b16 v[204:205], v241 offset:32
    ds_read_b64_tr_b16 v[206:207], v241 offset:2592
    s_waitcnt lgkmcnt(8)
    v_mfma_f32_16x16x32_bf16 v[96:99], v[196:199], v[176:179], v[96:99]
    v_mfma_f32_16x16x32_bf16 v[116:119], v[196:199], v[180:183], v[116:119]
    v_mfma_f32_16x16x32_bf16 v[136:139], v[196:199], v[184:187], v[136:139]
    v_mfma_f32_16x16x32_bf16 v[156:159], v[196:199], v[188:191], v[156:159]
    ds_read_b64_tr_b16 v[208:209], v241 offset:64
    ds_read_b64_tr_b16 v[210:211], v241 offset:2624
    s_waitcnt lgkmcnt(4)
    v_mfma_f32_16x16x32_bf16 v[80:83], v[200:203], v[160:163], v[80:83]
    v_mfma_f32_16x16x32_bf16 v[100:103], v[200:203], v[164:167], v[100:103]
    v_mfma_f32_16x16x32_bf16 v[120:123], v[200:203], v[168:171], v[120:123]
    v_mfma_f32_16x16x32_bf16 v[140:143], v[200:203], v[172:175], v[140:143]
    ds_read_b64_tr_b16 v[212:213], v241 offset:96
    ds_read_b64_tr_b16 v[214:215], v241 offset:2656
    s_waitcnt lgkmcnt(4)
    v_mfma_f32_16x16x32_bf16 v[84:87], v[204:207], v[160:163], v[84:87]
    v_mfma_f32_16x16x32_bf16 v[104:107], v[204:207], v[164:167], v[104:107]
    v_mfma_f32_16x16x32_bf16 v[124:127], v[204:207], v[168:171], v[124:127]
    v_mfma_f32_16x16x32_bf16 v[144:147], v[204:207], v[172:175], v[144:147]
    ds_read_b64_tr_b16 v[192:193], v241 offset:128
    ds_read_b64_tr_b16 v[194:195], v241 offset:2688
    s_waitcnt lgkmcnt(4)
    v_mfma_f32_16x16x32_bf16 v[88:91], v[208:211], v[160:163], v[88:91]
    v_mfma_f32_16x16x32_bf16 v[108:111], v[208:211], v[164:167], v[108:111]
    v_mfma_f32_16x16x32_bf16 v[128:131], v[208:211], v[168:171], v[128:131]
    v_mfma_f32_16x16x32_bf16 v[148:151], v[208:211], v[172:175], v[148:151]
    s_waitcnt vmcnt(9)
    ds_read_b128 v[176:179], v242 offset:14336
    ds_read_b128 v[180:183], v242 offset:14592
    ds_read_b128 v[184:187], v242 offset:14848
    ds_read_b128 v[188:191], v242 offset:15104
    ds_read_b64_tr_b16 v[196:197], v241 offset:9216
    ds_read_b64_tr_b16 v[198:199], v241 offset:11776
    s_waitcnt lgkmcnt(8)
    v_mfma_f32_16x16x32_bf16 v[92:95], v[212:215], v[160:163], v[92:95]
    v_mfma_f32_16x16x32_bf16 v[112:115], v[212:215], v[164:167], v[112:115]
    v_mfma_f32_16x16x32_bf16 v[132:135], v[212:215], v[168:171], v[132:135]
    v_mfma_f32_16x16x32_bf16 v[152:155], v[212:215], v[172:175], v[152:155]
    ds_read_b64_tr_b16 v[200:201], v241 offset:9248
    ds_read_b64_tr_b16 v[202:203], v241 offset:11808
    s_waitcnt lgkmcnt(8)
    v_mfma_f32_16x16x32_bf16 v[96:99], v[192:195], v[160:163], v[96:99]
    v_mfma_f32_16x16x32_bf16 v[116:119], v[192:195], v[164:167], v[116:119]
    v_mfma_f32_16x16x32_bf16 v[136:139], v[192:195], v[168:171], v[136:139]
    v_mfma_f32_16x16x32_bf16 v[156:159], v[192:195], v[172:175], v[156:159]
    ds_read_b64_tr_b16 v[204:205], v241 offset:9280
    ds_read_b64_tr_b16 v[206:207], v241 offset:11840
    s_waitcnt lgkmcnt(4)
    v_mfma_f32_16x16x32_bf16 v[80:83], v[196:199], v[176:179], v[80:83]
    v_mfma_f32_16x16x32_bf16 v[100:103], v[196:199], v[180:183], v[100:103]
    v_mfma_f32_16x16x32_bf16 v[120:123], v[196:199], v[184:187], v[120:123]
    v_mfma_f32_16x16x32_bf16 v[140:143], v[196:199], v[188:191], v[140:143]
    ds_read_b64_tr_b16 v[208:209], v241 offset:9312
    ds_read_b64_tr_b16 v[210:211], v241 offset:11872
    s_waitcnt lgkmcnt(4)
    v_mfma_f32_16x16x32_bf16 v[84:87], v[200:203], v[176:179], v[84:87]
    v_mfma_f32_16x16x32_bf16 v[104:107], v[200:203], v[180:183], v[104:107]
    v_mfma_f32_16x16x32_bf16 v[124:127], v[200:203], v[184:187], v[124:127]
    v_mfma_f32_16x16x32_bf16 v[144:147], v[200:203], v[188:191], v[144:147]
    ds_read_b64_tr_b16 v[212:213], v241 offset:9344
    ds_read_b64_tr_b16 v[214:215], v241 offset:11904
    s_waitcnt lgkmcnt(4)
    v_mfma_f32_16x16x32_bf16 v[88:91], v[204:207], v[176:179], v[88:91]
    v_mfma_f32_16x16x32_bf16 v[108:111], v[204:207], v[180:183], v[108:111]
    v_mfma_f32_16x16x32_bf16 v[128:131], v[204:207], v[184:187], v[128:131]
    v_mfma_f32_16x16x32_bf16 v[148:151], v[204:207], v[188:191], v[148:151]
    s_waitcnt vmcnt(0)
    ds_read_b128 v[160:163], v242 offset:23552
    ds_read_b128 v[164:167], v242 offset:23808
    ds_read_b128 v[168:171], v242 offset:24064
    ds_read_b128 v[172:175], v242 offset:24320
    ds_read_b64_tr_b16 v[192:193], v241 offset:18432
    ds_read_b64_tr_b16 v[194:195], v241 offset:20992
    s_waitcnt lgkmcnt(8)
    v_mfma_f32_16x16x32_bf16 v[92:95], v[208:211], v[176:179], v[92:95]
    v_mfma_f32_16x16x32_bf16 v[112:115], v[208:211], v[180:183], v[112:115]
    v_mfma_f32_16x16x32_bf16 v[132:135], v[208:211], v[184:187], v[132:135]
    v_mfma_f32_16x16x32_bf16 v[152:155], v[208:211], v[188:191], v[152:155]
    ds_read_b64_tr_b16 v[196:197], v241 offset:18464
    ds_read_b64_tr_b16 v[198:199], v241 offset:21024
    s_waitcnt lgkmcnt(8)
    v_mfma_f32_16x16x32_bf16 v[96:99], v[212:215], v[176:179], v[96:99]
    v_mfma_f32_16x16x32_bf16 v[116:119], v[212:215], v[180:183], v[116:119]
    v_mfma_f32_16x16x32_bf16 v[136:139], v[212:215], v[184:187], v[136:139]
    v_mfma_f32_16x16x32_bf16 v[156:159], v[212:215], v[188:191], v[156:159]
    ds_read_b64_tr_b16 v[200:201], v241 offset:18496
    ds_read_b64_tr_b16 v[202:203], v241 offset:21056
    s_waitcnt lgkmcnt(4)
    v_mfma_f32_16x16x32_bf16 v[80:83], v[192:195], v[160:163], v[80:83]
    v_mfma_f32_16x16x32_bf16 v[100:103], v[192:195], v[164:167], v[100:103]
    v_mfma_f32_16x16x32_bf16 v[120:123], v[192:195], v[168:171], v[120:123]
    v_mfma_f32_16x16x32_bf16 v[140:143], v[192:195], v[172:175], v[140:143]
    ds_read_b64_tr_b16 v[204:205], v241 offset:18528
    ds_read_b64_tr_b16 v[206:207], v241 offset:21088
    s_waitcnt lgkmcnt(4)
    v_mfma_f32_16x16x32_bf16 v[84:87], v[196:199], v[160:163], v[84:87]
    v_mfma_f32_16x16x32_bf16 v[104:107], v[196:199], v[164:167], v[104:107]
    v_mfma_f32_16x16x32_bf16 v[124:127], v[196:199], v[168:171], v[124:127]
    v_mfma_f32_16x16x32_bf16 v[144:147], v[196:199], v[172:175], v[144:147]
    ds_read_b64_tr_b16 v[208:209], v241 offset:18560
    ds_read_b64_tr_b16 v[210:211], v241 offset:21120
    s_waitcnt lgkmcnt(4)
    v_mfma_f32_16x16x32_bf16 v[88:91], v[200:203], v[160:163], v[88:91]
    v_mfma_f32_16x16x32_bf16 v[108:111], v[200:203], v[164:167], v[108:111]
    v_mfma_f32_16x16x32_bf16 v[128:131], v[200:203], v[168:171], v[128:131]
    v_mfma_f32_16x16x32_bf16 v[148:151], v[200:203], v[172:175], v[148:151]
    s_waitcnt lgkmcnt(2)
    v_mfma_f32_16x16x32_bf16 v[92:95], v[204:207], v[160:163], v[92:95]
    v_mfma_f32_16x16x32_bf16 v[112:115], v[204:207], v[164:167], v[112:115]
    v_mfma_f32_16x16x32_bf16 v[132:135], v[204:207], v[168:171], v[132:135]
    v_mfma_f32_16x16x32_bf16 v[152:155], v[204:207], v[172:175], v[152:155]
    s_waitcnt lgkmcnt(0)
    v_mfma_f32_16x16x32_bf16 v[96:99], v[208:211], v[160:163], v[96:99]
    v_mfma_f32_16x16x32_bf16 v[116:119], v[208:211], v[164:167], v[116:119]
    v_mfma_f32_16x16x32_bf16 v[136:139], v[208:211], v[168:171], v[136:139]
    v_mfma_f32_16x16x32_bf16 v[156:159], v[208:211], v[172:175], v[156:159]
    s_waitcnt lgkmcnt(0)
    s_lshl_b32 s31, s20, 6
    s_lshl_b32 s30, s23, 4
    s_add_u32 s31, s31, s30
    s_mul_i32 s33, s23, 2816
    s_add_u32 s33, s33, 122880
    v_add_u32 v185, 0, v243
    v_mul_u32_u24 v186, 3277, v185
    v_lshrrev_b32 v186, 16, v186
    v_mul_u32_u24 v187, 20, v186
    v_sub_u32 v187, v185, v187
    v_mul_u32_u24 v188, 176, v186
    v_lshl_add_u32 v188, v187, 3, v188
    v_add_u32 v175, s33, v188
    v_add_u32 v186, s31, v186
    v_mul_u32_u24 v186, 1280, v186
    v_lshl_add_u32 v186, v187, 3, v186
    v_add_u32 v170, s32, v186
    buffer_load_dwordx2 v[160:161], v170, s[12:15], 0 offen
    v_add_u32 v185, 64, v243
    v_mul_u32_u24 v186, 3277, v185
    v_lshrrev_b32 v186, 16, v186
    v_mul_u32_u24 v187, 20, v186
    v_sub_u32 v187, v185, v187
    v_mul_u32_u24 v188, 176, v186
    v_lshl_add_u32 v188, v187, 3, v188
    v_add_u32 v176, s33, v188
    v_add_u32 v186, s31, v186
    v_mul_u32_u24 v186, 1280, v186
    v_lshl_add_u32 v186, v187, 3, v186
    v_add_u32 v171, s32, v186
    buffer_load_dwordx2 v[162:163], v171, s[12:15], 0 offen
    v_add_u32 v185, 128, v243
    v_mul_u32_u24 v186, 3277, v185
    v_lshrrev_b32 v186, 16, v186
    v_mul_u32_u24 v187, 20, v186
    v_sub_u32 v187, v185, v187
    v_mul_u32_u24 v188, 176, v186
    v_lshl_add_u32 v188, v187, 3, v188
    v_add_u32 v177, s33, v188
    v_add_u32 v186, s31, v186
    v_mul_u32_u24 v186, 1280, v186
    v_lshl_add_u32 v186, v187, 3, v186
    v_add_u32 v172, s32, v186
    buffer_load_dwordx2 v[164:165], v172, s[12:15], 0 offen
    v_add_u32 v185, 192, v243
    v_mul_u32_u24 v186, 3277, v185
    v_lshrrev_b32 v186, 16, v186
    v_mul_u32_u24 v187, 20, v186
    v_sub_u32 v187, v185, v187
    v_mul_u32_u24 v188, 176, v186
    v_lshl_add_u32 v188, v187, 3, v188
    v_add_u32 v178, s33, v188
    v_add_u32 v186, s31, v186
    v_mul_u32_u24 v186, 1280, v186
    v_lshl_add_u32 v186, v187, 3, v186
    v_add_u32 v173, s32, v186
    buffer_load_dwordx2 v[166:167], v173, s[12:15], 0 offen
    v_add_u32 v185, 256, v243
    v_mul_u32_u24 v186, 3277, v185
    v_lshrrev_b32 v186, 16, v186
    v_mul_u32_u24 v187, 20, v186
    v_sub_u32 v187, v185, v187
    v_mul_u32_u24 v188, 176, v186
    v_lshl_add_u32 v188, v187, 3, v188
    v_add_u32 v179, s33, v188
    v_add_u32 v186, s31, v186
    v_mul_u32_u24 v186, 1280, v186
    v_lshl_add_u32 v186, v187, 3, v186
    v_add_u32 v174, s32, v186
    buffer_load_dwordx2 v[168:169], v174, s[12:15], 0 offen
    v_lshlrev_b32 v185, 4, v243
    s_barrier
    s_cmp_eq_u32 s23, 0
    s_cbranch_scc1 K2_skipw0
    s_sub_u32 s30, s23, 1
    s_and_b32 s30, s30, 3
    s_mul_i32 s30, s30, 10240
    s_add_u32 s30, s30, 0
    v_add_u32 v186, s30, v185
    ds_write_b128 v186, v[0:3] offset:0
    ds_write_b128 v186, v[4:7] offset:1024
    ds_write_b128 v186, v[8:11] offset:2048
    ds_write_b128 v186, v[12:15] offset:3072
    ds_write_b128 v186, v[16:19] offset:4096
    ds_write_b128 v186, v[80:83] offset:5120
    ds_write_b128 v186, v[84:87] offset:6144
    ds_write_b128 v186, v[88:91] offset:7168
    ds_write_b128 v186, v[92:95] offset:8192
    ds_write_b128 v186, v[96:99] offset:9216
K2_skipw0:
    s_cmp_eq_u32 s23, 1
    s_cbranch_scc1 K2_skipw1
    s_sub_u32 s30, s23, 2
    s_and_b32 s30, s30, 3
    s_mul_i32 s30, s30, 10240
    s_add_u32 s30, s30, 30720
    v_add_u32 v186, s30, v185
    ds_write_b128 v186, v[20:23] offset:0
    ds_write_b128 v186, v[24:27] offset:1024
    ds_write_b128 v186, v[28:31] offset:2048
    ds_write_b128 v186, v[32:35] offset:3072
    ds_write_b128 v186, v[36:39] offset:4096
    ds_write_b128 v186, v[100:103] offset:5120
    ds_write_b128 v186, v[104:107] offset:6144
    ds_write_b128 v186, v[108:111] offset:7168
    ds_write_b128 v186, v[112:115] offset:8192
    ds_write_b128 v186, v[116:119] offset:9216
K2_skipw1:
    s_cmp_eq_u32 s23, 2
    s_cbranch_scc1 K2_skipw2
    s_sub_u32 s30, s23, 3
    s_and_b32 s30, s30, 3
    s_mul_i32 s30, s30, 10240
    s_add_u32 s30, s30, 61440
    v_add_u32 v186, s30, v185
    ds_write_b128 v186, v[40:43] offset:0
    ds_write_b128 v186, v[44:47] offset:1024
    ds_write_b128 v186, v[48:51] offset:2048
    ds_write_b128 v186, v[52:55] offset:3072
    ds_write_b128 v186, v[56:59] offset:4096
    ds_write_b128 v186, v[120:123] offset:5120
    ds_write_b128 v186, v[124:127] offset:6144
    ds_write_b128 v186, v[128:131] offset:7168
    ds_write_b128 v186, v[132:135] offset:8192
    ds_write_b128 v186, v[136:139] offset:9216
K2_skipw2:
    s_cmp_eq_u32 s23, 3
    s_cbranch_scc1 K2_skipw3
    s_sub_u32 s30, s23, 4
    s_and_b32 s30, s30, 3
    s_mul_i32 s30, s30, 10240
    s_add_u32 s30, s30, 92160
    v_add_u32 v186, s30, v185
    ds_write_b128 v186, v[60:63] offset:0
    ds_write_b128 v186, v[64:67] offset:1024
    ds_write_b128 v186, v[68:71] offset:2048
    ds_write_b128 v186, v[72:75] offset:3072
    ds_write_b128 v186, v[76:79] offset:4096
    ds_write_b128 v186, v[140:143] offset:5120
    ds_write_b128 v186, v[144:147] offset:6144
    ds_write_b128 v186, v[148:151] offset:7168
    ds_write_b128 v186, v[152:155] offset:8192
    ds_write_b128 v186, v[156:159] offset:9216
K2_skipw3:
    s_cmp_lg_u32 s23, 0
    s_cbranch_scc1 K2_skipm0
    v_mov_b32 v192, v0
    v_mov_b32 v193, v1
    v_mov_b32 v194, v2
    v_mov_b32 v195, v3
    v_mov_b32 v196, v4
    v_mov_b32 v197, v5
    v_mov_b32 v198, v6
    v_mov_b32 v199, v7
    v_mov_b32 v200, v8
    v_mov_b32 v201, v9
    v_mov_b32 v202, v10
    v_mov_b32 v203, v11
    v_mov_b32 v204, v12
    v_mov_b32 v205, v13
    v_mov_b32 v206, v14
    v_mov_b32 v207, v15
    v_mov_b32 v208, v16
    v_mov_b32 v209, v17
    v_mov_b32 v210, v18
    v_mov_b32 v211, v19
    v_mov_b32 v212, v80
    v_mov_b32 v213, v81
    v_mov_b32 v214, v82
    v_mov_b32 v215, v83
    v_mov_b32 v216, v84
    v_mov_b32 v217, v85
    v_mov_b32 v218, v86
    v_mov_b32 v219, v87
    v_mov_b32 v220, v88
    v_mov_b32 v221, v89
    v_mov_b32 v222, v90
    v_mov_b32 v223, v91
    v_mov_b32 v224, v92
    v_mov_b32 v225, v93
    v_mov_b32 v226, v94
    v_mov_b32 v227, v95
    v_mov_b32 v228, v96
    v_mov_b32 v229, v97
    v_mov_b32 v230, v98
    v_mov_b32 v231, v99
K2_skipm0:
    s_cmp_lg_u32 s23, 1
    s_cbranch_scc1 K2_skipm1
    v_mov_b32 v192, v20
    v_mov_b32 v193, v21
    v_mov_b32 v194, v22
    v_mov_b32 v195, v23
    v_mov_b32 v196, v24
    v_mov_b32 v197, v25
    v_mov_b32 v198, v26
    v_mov_b32 v199, v27
    v_mov_b32 v200, v28
    v_mov_b32 v201, v29
    v_mov_b32 v202, v30
    v_mov_b32 v203, v31
    v_mov_b32 v204, v32
    v_mov_b32 v205, v33
    v_mov_b32 v206, v34
    v_mov_b32 v207, v35
    v_mov_b32 v208, v36
    v_mov_b32 v209, v37
    v_mov_b32 v210, v38
    v_mov_b32 v211, v39
    v_mov_b32 v212, v100
    v_mov_b32 v213, v101
    v_mov_b32 v214, v102
    v_mov_b32 v215, v103
    v_mov_b32 v216, v104
    v_mov_b32 v217, v105
    v_mov_b32 v218, v106
    v_mov_b32 v219, v107
    v_mov_b32 v220, v108
    v_mov_b32 v221, v109
    v_mov_b32 v222, v110
    v_mov_b32 v223, v111
    v_mov_b32 v224, v112
    v_mov_b32 v225, v113
    v_mov_b32 v226, v114
    v_mov_b32 v227, v115
    v_mov_b32 v228, v116
    v_mov_b32 v229, v117
    v_mov_b32 v230, v118
    v_mov_b32 v231, v119
K2_skipm1:
    s_cmp_lg_u32 s23, 2
    s_cbranch_scc1 K2_skipm2
    v_mov_b32 v192, v40
    v_mov_b32 v193, v41
    v_mov_b32 v194, v42
    v_mov_b32 v195, v43
    v_mov_b32 v196, v44
    v_mov_b32 v197, v45
    v_mov_b32 v198, v46
    v_mov_b32 v199, v47
    v_mov_b32 v200, v48
    v_mov_b32 v201, v49
    v_mov_b32 v202, v50
    v_mov_b32 v203, v51
    v_mov_b32 v204, v52
    v_mov_b32 v205, v53
    v_mov_b32 v206, v54
    v_mov_b32 v207, v55
    v_mov_b32 v208, v56
    v_mov_b32 v209, v57
    v_mov_b32 v210, v58
    v_mov_b32 v211, v59
    v_mov_b32 v212, v120
    v_mov_b32 v213, v121
    v_mov_b32 v214, v122
    v_mov_b32 v215, v123
    v_mov_b32 v216, v124
    v_mov_b32 v217, v125
    v_mov_b32 v218, v126
    v_mov_b32 v219, v127
    v_mov_b32 v220, v128
    v_mov_b32 v221, v129
    v_mov_b32 v222, v130
    v_mov_b32 v223, v131
    v_mov_b32 v224, v132
    v_mov_b32 v225, v133
    v_mov_b32 v226, v134
    v_mov_b32 v227, v135
    v_mov_b32 v228, v136
    v_mov_b32 v229, v137
    v_mov_b32 v230, v138
    v_mov_b32 v231, v139
K2_skipm2:
    s_cmp_lg_u32 s23, 3
    s_cbranch_scc1 K2_skipm3
    v_mov_b32 v192, v60
    v_mov_b32 v193, v61
    v_mov_b32 v194, v62
    v_mov_b32 v195, v63
    v_mov_b32 v196, v64
    v_mov_b32 v197, v65
    v_mov_b32 v198, v66
    v_mov_b32 v199, v67
    v_mov_b32 v200, v68
    v_mov_b32 v201, v69
    v_mov_b32 v202, v70
    v_mov_b32 v203, v71
    v_mov_b32 v204, v72
    v_mov_b32 v205, v73
    v_mov_b32 v206, v74
    v_mov_b32 v207, v75
    v_mov_b32 v208, v76
    v_mov_b32 v209, v77
    v_mov_b32 v210, v78
    v_mov_b32 v211, v79
    v_mov_b32 v212, v140
    v_mov_b32 v213, v141
    v_mov_b32 v214, v142
    v_mov_b32 v215, v143
    v_mov_b32 v216, v144
    v_mov_b32 v217, v145
    v_mov_b32 v218, v146
    v_mov_b32 v219, v147
    v_mov_b32 v220, v148
    v_mov_b32 v221, v149
    v_mov_b32 v222, v150
    v_mov_b32 v223, v151
    v_mov_b32 v224, v152
    v_mov_b32 v225, v153
    v_mov_b32 v226, v154
    v_mov_b32 v227, v155
    v_mov_b32 v228, v156
    v_mov_b32 v229, v157
    v_mov_b32 v230, v158
    v_mov_b32 v231, v159
K2_skipm3:
    s_mul_i32 s30, s23, 30720
    v_add_u32 v186, s30, v185
    s_waitcnt lgkmcnt(0)
    s_barrier
    ds_read_b128 v[0:3], v186 offset:0
    ds_read_b128 v[4:7], v186 offset:1024
    ds_read_b128 v[8:11], v186 offset:2048
    ds_read_b128 v[12:15], v186 offset:3072
    ds_read_b128 v[16:19], v186 offset:4096
    ds_read_b128 v[20:23], v186 offset:5120
    ds_read_b128 v[24:27], v186 offset:6144
    ds_read_b128 v[28:31], v186 offset:7168
    ds_read_b128 v[32:35], v186 offset:8192
    ds_read_b128 v[36:39], v186 offset:9216
    ds_read_b128 v[40:43], v186 offset:10240
    ds_read_b128 v[44:47], v186 offset:11264
    ds_read_b128 v[48:51], v186 offset:12288
    ds_read_b128 v[52:55], v186 offset:13312
    ds_read_b128 v[56:59], v186 offset:14336
    ds_read_b128 v[60:63], v186 offset:15360
    ds_read_b128 v[64:67], v186 offset:16384
    ds_read_b128 v[68:71], v186 offset:17408
    ds_read_b128 v[72:75], v186 offset:18432
    ds_read_b128 v[76:79], v186 offset:19456
    ds_read_b128 v[80:83], v186 offset:20480
    ds_read_b128 v[84:87], v186 offset:21504
    ds_read_b128 v[88:91], v186 offset:22528
    ds_read_b128 v[92:95], v186 offset:23552
    ds_read_b128 v[96:99], v186 offset:24576
    ds_read_b128 v[100:103], v186 offset:25600
    ds_read_b128 v[104:107], v186 offset:26624
    ds_read_b128 v[108:111], v186 offset:27648
    ds_read_b128 v[112:115], v186 offset:28672
    ds_read_b128 v[116:119], v186 offset:29696
    s_mov_b32 s35, 0xbfb8aa3b
    v_mul_u32_u24 v187, 176, v244
    v_lshl_add_u32 v187, v245, 3, v187
    v_add_u32 v187, s33, v187
    s_waitcnt lgkmcnt(15)
    s_waitcnt lgkmcnt(15)
    v_add_f32 v192, v192, v0
    v_add_f32 v193, v193, v1
    v_add_f32 v194, v194, v2
    v_add_f32 v195, v195, v3
    v_add_f32 v196, v196, v4
    v_add_f32 v197, v197, v5
    v_add_f32 v198, v198, v6
    v_add_f32 v199, v199, v7
    v_add_f32 v200, v200, v8
    v_add_f32 v201, v201, v9
    v_add_f32 v202, v202, v10
    v_add_f32 v203, v203, v11
    v_add_f32 v204, v204, v12
    v_add_f32 v205, v205, v13
    v_add_f32 v206, v206, v14
    v_add_f32 v207, v207, v15
    v_add_f32 v208, v208, v16
    v_add_f32 v209, v209, v17
    v_add_f32 v210, v210, v18
    v_add_f32 v211, v211, v19
    v_add_f32 v212, v212, v20
    v_add_f32 v213, v213, v21
    v_add_f32 v214, v214, v22
    v_add_f32 v215, v215, v23
    v_add_f32 v216, v216, v24
    v_add_f32 v217, v217, v25
    v_add_f32 v218, v218, v26
    v_add_f32 v219, v219, v27
    v_add_f32 v220, v220, v28
    v_add_f32 v221, v221, v29
    v_add_f32 v222, v222, v30
    v_add_f32 v223, v223, v31
    v_add_f32 v224, v224, v32
    v_add_f32 v225, v225, v33
    v_add_f32 v226, v226, v34
    v_add_f32 v227, v227, v35
    v_add_f32 v228, v228, v36
    v_add_f32 v229, v229, v37
    v_add_f32 v230, v230, v38
    v_add_f32 v231, v231, v39
    s_waitcnt lgkmcnt(10)
    v_add_f32 v192, v192, v40
    v_add_f32 v193, v193, v41
    v_add_f32 v194, v194, v42
    v_add_f32 v195, v195, v43
    v_add_f32 v196, v196, v44
    v_add_f32 v197, v197, v45
    v_add_f32 v198, v198, v46
    v_add_f32 v199, v199, v47
    v_add_f32 v200, v200, v48
    v_add_f32 v201, v201, v49
    v_add_f32 v202, v202, v50
    v_add_f32 v203, v203, v51
    v_add_f32 v204, v204, v52
    v_add_f32 v205, v205, v53
    v_add_f32 v206, v206, v54
    v_add_f32 v207, v207, v55
    v_add_f32 v208, v208, v56
    v_add_f32 v209, v209, v57
    v_add_f32 v210, v210, v58
    v_add_f32 v211, v211, v59
    v_add_f32 v212, v212, v60
    v_add_f32 v213, v213, v61
    v_add_f32 v214, v214, v62
    v_add_f32 v215, v215, v63
    v_add_f32 v216, v216, v64
    v_add_f32 v217, v217, v65
    v_add_f32 v218, v218, v66
    v_add_f32 v219, v219, v67
    v_add_f32 v220, v220, v68
    v_add_f32 v221, v221, v69
    v_add_f32 v222, v222, v70
    v_add_f32 v223, v223, v71
    v_add_f32 v224, v224, v72
    v_add_f32 v225, v225, v73
    v_add_f32 v226, v226, v74
    v_add_f32 v227, v227, v75
    v_add_f32 v228, v228, v76
    v_add_f32 v229, v229, v77
    v_add_f32 v230, v230, v78
    v_add_f32 v231, v231, v79
    s_waitcnt lgkmcnt(0)
    v_add_f32 v192, v192, v80
    v_add_f32 v193, v193, v81
    v_add_f32 v194, v194, v82
    v_add_f32 v195, v195, v83
    v_add_f32 v196, v196, v84
    v_add_f32 v197, v197, v85
    v_add_f32 v198, v198, v86
    v_add_f32 v199, v199, v87
    v_add_f32 v200, v200, v88
    v_add_f32 v201, v201, v89
    v_add_f32 v202, v202, v90
    v_add_f32 v203, v203, v91
    v_add_f32 v204, v204, v92
    v_add_f32 v205, v205, v93
    v_add_f32 v206, v206, v94
    v_add_f32 v207, v207, v95
    v_add_f32 v208, v208, v96
    v_add_f32 v209, v209, v97
    v_add_f32 v210, v210, v98
    v_add_f32 v211, v211, v99
    v_add_f32 v212, v212, v100
    v_add_f32 v213, v213, v101
    v_add_f32 v214, v214, v102
    v_add_f32 v215, v215, v103
    v_add_f32 v216, v216, v104
    v_add_f32 v217, v217, v105
    v_add_f32 v218, v218, v106
    v_add_f32 v219, v219, v107
    v_add_f32 v220, v220, v108
    v_add_f32 v221, v221, v109
    v_add_f32 v222, v222, v110
    v_add_f32 v223, v223, v111
    v_add_f32 v224, v224, v112
    v_add_f32 v225, v225, v113
    v_add_f32 v226, v226, v114
    v_add_f32 v227, v227, v115
    v_add_f32 v228, v228, v116
    v_add_f32 v229, v229, v117
    v_add_f32 v230, v230, v118
    v_add_f32 v231, v231, v119
    v_cvt_pk_bf16_f32 v0, v192, v193
    v_cvt_pk_bf16_f32 v1, v194, v195
    v_cvt_pk_bf16_f32 v2, v212, v213
    v_cvt_pk_bf16_f32 v3, v214, v215
    v_lshlrev_b32 v192, 16, v0
    v_and_b32 v193, 0xffff0000, v0
    v_lshlrev_b32 v212, 16, v2
    v_and_b32 v213, 0xffff0000, v2
    v_lshlrev_b32 v194, 16, v1
    v_and_b32 v195, 0xffff0000, v1
    v_lshlrev_b32 v214, 16, v3
    v_and_b32 v215, 0xffff0000, v3
    v_mul_f32 v4, s35, v192
    v_mul_f32 v5, s35, v193
    v_mul_f32 v6, s35, v194
    v_mul_f32 v7, s35, v195
    v_exp_f32 v4, v4
    v_exp_f32 v5, v5
    v_exp_f32 v6, v6
    v_exp_f32 v7, v7
    v_add_f32 v4, 1.0, v4
    v_add_f32 v5, 1.0, v5
    v_add_f32 v6, 1.0, v6
    v_add_f32 v7, 1.0, v7
    v_rcp_f32 v4, v4
    v_rcp_f32 v5, v5
    v_rcp_f32 v6, v6
    v_rcp_f32 v7, v7
    v_mul_f32 v4, v4, v192
    v_mul_f32 v5, v5, v193
    v_mul_f32 v6, v6, v194
    v_mul_f32 v7, v7, v195
    v_cvt_pk_bf16_f32 v0, v4, v5
    v_cvt_pk_bf16_f32 v1, v6, v7
    v_lshlrev_b32 v4, 16, v0
    v_and_b32 v5, 0xffff0000, v0
    v_lshlrev_b32 v6, 16, v1
    v_and_b32 v7, 0xffff0000, v1
    v_mul_f32 v4, v4, v212
    v_mul_f32 v5, v5, v213
    v_mul_f32 v6, v6, v214
    v_mul_f32 v7, v7, v215
    v_cvt_pk_bf16_f32 v0, v4, v5
    v_cvt_pk_bf16_f32 v1, v6, v7
    ds_write_b64 v187, v[0:1] offset:0
    v_cvt_pk_bf16_f32 v16, v196, v197
    v_cvt_pk_bf16_f32 v17, v198, v199
    v_cvt_pk_bf16_f32 v18, v216, v217
    v_cvt_pk_bf16_f32 v19, v218, v219
    v_lshlrev_b32 v196, 16, v16
    v_and_b32 v197, 0xffff0000, v16
    v_lshlrev_b32 v216, 16, v18
    v_and_b32 v217, 0xffff0000, v18
    v_lshlrev_b32 v198, 16, v17
    v_and_b32 v199, 0xffff0000, v17
    v_lshlrev_b32 v218, 16, v19
    v_and_b32 v219, 0xffff0000, v19
    v_mul_f32 v20, s35, v196
    v_mul_f32 v21, s35, v197
    v_mul_f32 v22, s35, v198
    v_mul_f32 v23, s35, v199
    v_exp_f32 v20, v20
    v_exp_f32 v21, v21
    v_exp_f32 v22, v22
    v_exp_f32 v23, v23
    v_add_f32 v20, 1.0, v20
    v_add_f32 v21, 1.0, v21
    v_add_f32 v22, 1.0, v22
    v_add_f32 v23, 1.0, v23
    v_rcp_f32 v20, v20
    v_rcp_f32 v21, v21
    v_rcp_f32 v22, v22
    v_rcp_f32 v23, v23
    v_mul_f32 v20, v20, v196
    v_mul_f32 v21, v21, v197
    v_mul_f32 v22, v22, v198
    v_mul_f32 v23, v23, v199
    v_cvt_pk_bf16_f32 v16, v20, v21
    v_cvt_pk_bf16_f32 v17, v22, v23
    v_lshlrev_b32 v20, 16, v16
    v_and_b32 v21, 0xffff0000, v16
    v_lshlrev_b32 v22, 16, v17
    v_and_b32 v23, 0xffff0000, v17
    v_mul_f32 v20, v20, v216
    v_mul_f32 v21, v21, v217
    v_mul_f32 v22, v22, v218
    v_mul_f32 v23, v23, v219
    v_cvt_pk_bf16_f32 v16, v20, v21
    v_cvt_pk_bf16_f32 v17, v22, v23
    ds_write_b64 v187, v[16:17] offset:32
    v_cvt_pk_bf16_f32 v32, v200, v201
    v_cvt_pk_bf16_f32 v33, v202, v203
    v_cvt_pk_bf16_f32 v34, v220, v221
    v_cvt_pk_bf16_f32 v35, v222, v223
    v_lshlrev_b32 v200, 16, v32
    v_and_b32 v201, 0xffff0000, v32
    v_lshlrev_b32 v220, 16, v34
    v_and_b32 v221, 0xffff0000, v34
    v_lshlrev_b32 v202, 16, v33
    v_and_b32 v203, 0xffff0000, v33
    v_lshlrev_b32 v222, 16, v35
    v_and_b32 v223, 0xffff0000, v35
    v_mul_f32 v36, s35, v200
    v_mul_f32 v37, s35, v201
    v_mul_f32 v38, s35, v202
    v_mul_f32 v39, s35, v203
    v_exp_f32 v36, v36
    v_exp_f32 v37, v37
    v_exp_f32 v38, v38
    v_exp_f32 v39, v39
    v_add_f32 v36, 1.0, v36
    v_add_f32 v37, 1.0, v37
    v_add_f32 v38, 1.0, v38
    v_add_f32 v39, 1.0, v39
    v_rcp_f32 v36, v36
    v_rcp_f32 v37, v37
    v_rcp_f32 v38, v38
    v_rcp_f32 v39, v39
    v_mul_f32 v36, v36, v200
    v_mul_f32 v37, v37, v201
    v_mul_f32 v38, v38, v202
    v_mul_f32 v39, v39, v203
    v_cvt_pk_bf16_f32 v32, v36, v37
    v_cvt_pk_bf16_f32 v33, v38, v39
    v_lshlrev_b32 v36, 16, v32
    v_and_b32 v37, 0xffff0000, v32
    v_lshlrev_b32 v38, 16, v33
    v_and_b32 v39, 0xffff0000, v33
    v_mul_f32 v36, v36, v220
    v_mul_f32 v37, v37, v221
    v_mul_f32 v38, v38, v222
    v_mul_f32 v39, v39, v223
    v_cvt_pk_bf16_f32 v32, v36, v37
    v_cvt_pk_bf16_f32 v33, v38, v39
    ds_write_b64 v187, v[32:33] offset:64
    v_cvt_pk_bf16_f32 v48, v204, v205
    v_cvt_pk_bf16_f32 v49, v206, v207
    v_cvt_pk_bf16_f32 v50, v224, v225
    v_cvt_pk_bf16_f32 v51, v226, v227
    v_lshlrev_b32 v204, 16, v48
    v_and_b32 v205, 0xffff0000, v48
    v_lshlrev_b32 v224, 16, v50
    v_and_b32 v225, 0xffff0000, v50
    v_lshlrev_b32 v206, 16, v49
    v_and_b32 v207, 0xffff0000, v49
    v_lshlrev_b32 v226, 16, v51
    v_and_b32 v227, 0xffff0000, v51
    v_mul_f32 v52, s35, v204
    v_mul_f32 v53, s35, v205
    v_mul_f32 v54, s35, v206
    v_mul_f32 v55, s35, v207
    v_exp_f32 v52, v52
    v_exp_f32 v53, v53
    v_exp_f32 v54, v54
    v_exp_f32 v55, v55
    v_add_f32 v52, 1.0, v52
    v_add_f32 v53, 1.0, v53
    v_add_f32 v54, 1.0, v54
    v_add_f32 v55, 1.0, v55
    v_rcp_f32 v52, v52
    v_rcp_f32 v53, v53
    v_rcp_f32 v54, v54
    v_rcp_f32 v55, v55
    v_mul_f32 v52, v52, v204
    v_mul_f32 v53, v53, v205
    v_mul_f32 v54, v54, v206
    v_mul_f32 v55, v55, v207
    v_cvt_pk_bf16_f32 v48, v52, v53
    v_cvt_pk_bf16_f32 v49, v54, v55
    v_lshlrev_b32 v52, 16, v48
    v_and_b32 v53, 0xffff0000, v48
    v_lshlrev_b32 v54, 16, v49
    v_and_b32 v55, 0xffff0000, v49
    v_mul_f32 v52, v52, v224
    v_mul_f32 v53, v53, v225
    v_mul_f32 v54, v54, v226
    v_mul_f32 v55, v55, v227
    v_cvt_pk_bf16_f32 v48, v52, v53
    v_cvt_pk_bf16_f32 v49, v54, v55
    ds_write_b64 v187, v[48:49] offset:96
    v_cvt_pk_bf16_f32 v64, v208, v209
    v_cvt_pk_bf16_f32 v65, v210, v211
    v_cvt_pk_bf16_f32 v66, v228, v229
    v_cvt_pk_bf16_f32 v67, v230, v231
    v_lshlrev_b32 v208, 16, v64
    v_and_b32 v209, 0xffff0000, v64
    v_lshlrev_b32 v228, 16, v66
    v_and_b32 v229, 0xffff0000, v66
    v_lshlrev_b32 v210, 16, v65
    v_and_b32 v211, 0xffff0000, v65
    v_lshlrev_b32 v230, 16, v67
    v_and_b32 v231, 0xffff0000, v67
    v_mul_f32 v68, s35, v208
    v_mul_f32 v69, s35, v209
    v_mul_f32 v70, s35, v210
    v_mul_f32 v71, s35, v211
    v_exp_f32 v68, v68
    v_exp_f32 v69, v69
    v_exp_f32 v70, v70
    v_exp_f32 v71, v71
    v_add_f32 v68, 1.0, v68
    v_add_f32 v69, 1.0, v69
    v_add_f32 v70, 1.0, v70
    v_add_f32 v71, 1.0, v71
    v_rcp_f32 v68, v68
    v_rcp_f32 v69, v69
    v_rcp_f32 v70, v70
    v_rcp_f32 v71, v71
    v_mul_f32 v68, v68, v208
    v_mul_f32 v69, v69, v209
    v_mul_f32 v70, v70, v210
    v_mul_f32 v71, v71, v211
    v_cvt_pk_bf16_f32 v64, v68, v69
    v_cvt_pk_bf16_f32 v65, v70, v71
    v_lshlrev_b32 v68, 16, v64
    v_and_b32 v69, 0xffff0000, v64
    v_lshlrev_b32 v70, 16, v65
    v_and_b32 v71, 0xffff0000, v65
    v_mul_f32 v68, v68, v228
    v_mul_f32 v69, v69, v229
    v_mul_f32 v70, v70, v230
    v_mul_f32 v71, v71, v231
    v_cvt_pk_bf16_f32 v64, v68, v69
    v_cvt_pk_bf16_f32 v65, v70, v71
    ds_write_b64 v187, v[64:65] offset:128
    s_waitcnt lgkmcnt(0)
    ds_read_b64 v[80:81], v175
    ds_read_b64 v[82:83], v176
    ds_read_b64 v[84:85], v177
    ds_read_b64 v[86:87], v178
    ds_read_b64 v[88:89], v179
    s_waitcnt vmcnt(0)
    s_waitcnt lgkmcnt(4)
    v_lshlrev_b32 v96, 16, v80
    v_and_b32 v97, 0xffff0000, v80
    v_lshlrev_b32 v100, 16, v160
    v_and_b32 v101, 0xffff0000, v160
    v_lshlrev_b32 v98, 16, v81
    v_and_b32 v99, 0xffff0000, v81
    v_lshlrev_b32 v102, 16, v161
    v_and_b32 v103, 0xffff0000, v161
    v_add_f32 v96, v96, v100
    v_add_f32 v97, v97, v101
    v_add_f32 v98, v98, v102
    v_add_f32 v99, v99, v103
    v_cvt_pk_bf16_f32 v104, v96, v97
    v_cvt_pk_bf16_f32 v105, v98, v99
    buffer_store_dwordx2 v[104:105], v170, s[16:19], 0 offen
    s_waitcnt lgkmcnt(3)
    v_lshlrev_b32 v108, 16, v82
    v_and_b32 v109, 0xffff0000, v82
    v_lshlrev_b32 v112, 16, v162
    v_and_b32 v113, 0xffff0000, v162
    v_lshlrev_b32 v110, 16, v83
    v_and_b32 v111, 0xffff0000, v83
    v_lshlrev_b32 v114, 16, v163
    v_and_b32 v115, 0xffff0000, v163
    v_add_f32 v108, v108, v112
    v_add_f32 v109, v109, v113
    v_add_f32 v110, v110, v114
    v_add_f32 v111, v111, v115
    v_cvt_pk_bf16_f32 v116, v108, v109
    v_cvt_pk_bf16_f32 v117, v110, v111
    buffer_store_dwordx2 v[116:117], v171, s[16:19], 0 offen
    s_waitcnt lgkmcnt(2)
    v_lshlrev_b32 v120, 16, v84
    v_and_b32 v121, 0xffff0000, v84
    v_lshlrev_b32 v124, 16, v164
    v_and_b32 v125, 0xffff0000, v164
    v_lshlrev_b32 v122, 16, v85
    v_and_b32 v123, 0xffff0000, v85
    v_lshlrev_b32 v126, 16, v165
    v_and_b32 v127, 0xffff0000, v165
    v_add_f32 v120, v120, v124
    v_add_f32 v121, v121, v125
    v_add_f32 v122, v122, v126
    v_add_f32 v123, v123, v127
    v_cvt_pk_bf16_f32 v128, v120, v121
    v_cvt_pk_bf16_f32 v129, v122, v123
    buffer_store_dwordx2 v[128:129], v172, s[16:19], 0 offen
    s_waitcnt lgkmcnt(1)
    v_lshlrev_b32 v132, 16, v86
    v_and_b32 v133, 0xffff0000, v86
    v_lshlrev_b32 v136, 16, v166
    v_and_b32 v137, 0xffff0000, v166
    v_lshlrev_b32 v134, 16, v87
    v_and_b32 v135, 0xffff0000, v87
    v_lshlrev_b32 v138, 16, v167
    v_and_b32 v139, 0xffff0000, v167
    v_add_f32 v132, v132, v136
    v_add_f32 v133, v133, v137
    v_add_f32 v134, v134, v138
    v_add_f32 v135, v135, v139
    v_cvt_pk_bf16_f32 v140, v132, v133
    v_cvt_pk_bf16_f32 v141, v134, v135
    buffer_store_dwordx2 v[140:141], v173, s[16:19], 0 offen
    s_waitcnt lgkmcnt(0)
    v_lshlrev_b32 v144, 16, v88
    v_and_b32 v145, 0xffff0000, v88
    v_lshlrev_b32 v148, 16, v168
    v_and_b32 v149, 0xffff0000, v168
    v_lshlrev_b32 v146, 16, v89
    v_and_b32 v147, 0xffff0000, v89
    v_lshlrev_b32 v150, 16, v169
    v_and_b32 v151, 0xffff0000, v169
    v_add_f32 v144, v144, v148
    v_add_f32 v145, v145, v149
    v_add_f32 v146, v146, v150
    v_add_f32 v147, v147, v151
    v_cvt_pk_bf16_f32 v152, v144, v145
    v_cvt_pk_bf16_f32 v153, v146, v147
    buffer_store_dwordx2 v[152:153], v174, s[16:19], 0 offen
    s_endpgm
K2_ko:
    s_nop 7
    s_nop 3
    s_setprio 3
    s_sub_u32 s23, s23, 4
    v_subrev_u32 v0, 256, v0
    s_lshr_b32 s30, s58, 1
    s_lshl_b32 s30, s30, 8
    s_add_u32 s30, s30, 17047552
    v_mov_b32 v253, s30
KM_pk:
    buffer_load_dword v254, v253, s[4:7], 0 offen sc1
    s_waitcnt vmcnt(0)
    v_readfirstlane_b32 s30, v254
    s_cmp_ge_u32 s30, 16
    s_cbranch_scc1 KM_pkok
    s_sleep 8
    s_sub_u32 s95, s95, 1
    s_cbranch_scc1 K2_exit
    s_branch KM_pk
KM_pkok:
    v_and_b32 v1, 63, v0
    v_and_b32 v2, 15, v0
    v_bfe_u32 v3, v0, 4, 2
    v_mov_b32 v25, 1073741824
    s_mov_b32 s34, 0x3fb8aa3b
    s_mov_b32 s35, 0xbfb8aa3b
    s_lshl_b32 s33, s58, 1
    s_lshr_b32 s30, s23, 1
    s_add_u32 s31, s30, s33
    s_mul_i32 s31, s31, 800
    v_lshl_add_u32 v224, v1, 4, s31
    v_cmp_gt_u32 vcc, 50, v1
    s_nop 1
    v_cndmask_b32 v224, v25, v224, vcc
    s_lshl_b32 s31, s23, 10
    s_add_u32 m0, s31, 155648
    s_nop 0
    buffer_load_dwordx4 v224, s[60:63], 0 offen lds
    v_subrev_u32 v4, 192, v0
    v_mul_u32_u24 v5, 205, v4
    v_lshrrev_b32 v5, 12, v5
    v_mul_u32_u24 v6, 20, v5
    v_sub_u32 v6, v4, v6
    v_mul_u32_u24 v7, 52, v6
    v_lshrrev_b32 v7, 8, v7
    v_mul_u32_u24 v8, 5, v7
    v_sub_u32 v8, v6, v8
    v_lshl_add_u32 v8, v7, 4, v8
    v_add_u32 v5, 3, v5
    v_lshlrev_b32 v5, 10, v5
    v_lshl_add_u32 v5, v8, 4, v5
    v_lshlrev_b32 v6, 4, v0
    v_cmp_gt_u32 vcc, 192, v0
    s_nop 1
    v_cndmask_b32 v5, v5, v6, vcc
    v_cmp_gt_u32 vcc, 252, v0
    s_nop 1
    v_cndmask_b32 v5, v25, v5, vcc
    v_add_u32 v6, 6144, v5
    s_mul_i32 s30, s33, 6144
    s_add_u32 s30, s30, 11272192
    buffer_load_dwordx4 v[32:35], v5, s[4:7], s30 offen sc1
    buffer_load_dwordx4 v[96:99], v6, s[4:7], s30 offen sc1
    s_add_u32 s30, s30, 196608
    buffer_load_dwordx4 v[36:39], v5, s[4:7], s30 offen sc1
    buffer_load_dwordx4 v[100:103], v6, s[4:7], s30 offen sc1
    s_add_u32 s30, s30, 196608
    buffer_load_dwordx4 v[40:43], v5, s[4:7], s30 offen sc1
    buffer_load_dwordx4 v[104:107], v6, s[4:7], s30 offen sc1
    s_add_u32 s30, s30, 196608
    buffer_load_dwordx4 v[44:47], v5, s[4:7], s30 offen sc1
    buffer_load_dwordx4 v[108:111], v6, s[4:7], s30 offen sc1
    s_add_u32 s30, s30, 196608
    buffer_load_dwordx4 v[48:51], v5, s[4:7], s30 offen sc1
    buffer_load_dwordx4 v[112:115], v6, s[4:7], s30 offen sc1
    s_add_u32 s30, s30, 196608
    buffer_load_dwordx4 v[52:55], v5, s[4:7], s30 offen sc1
    buffer_load_dwordx4 v[116:119], v6, s[4:7], s30 offen sc1
    s_add_u32 s30, s30, 196608
    buffer_load_dwordx4 v[56:59], v5, s[4:7], s30 offen sc1
    buffer_load_dwordx4 v[120:123], v6, s[4:7], s30 offen sc1
    s_add_u32 s30, s30, 196608
    buffer_load_dwordx4 v[60:63], v5, s[4:7], s30 offen sc1
    buffer_load_dwordx4 v[124:127], v6, s[4:7], s30 offen sc1
    s_add_u32 s30, s30, 196608
    buffer_load_dwordx4 v[64:67], v5, s[4:7], s30 offen sc1
    buffer_load_dwordx4 v[128:131], v6, s[4:7], s30 offen sc1
    s_add_u32 s30, s30, 196608
    buffer_load_dwordx4 v[68:71], v5, s[4:7], s30 offen sc1
    buffer_load_dwordx4 v[132:135], v6, s[4:7], s30 offen sc1
    s_add_u32 s30, s30, 196608
    buffer_load_dwordx4 v[72:75], v5, s[4:7], s30 offen sc1
    buffer_load_dwordx4 v[136:139], v6, s[4:7], s30 offen sc1
    s_add_u32 s30, s30, 196608
    buffer_load_dwordx4 v[76:79], v5, s[4:7], s30 offen sc1
    buffer_load_dwordx4 v[140:143], v6, s[4:7], s30 offen sc1
    s_add_u32 s30, s30, 196608
    buffer_load_dwordx4 v[80:83], v5, s[4:7], s30 offen sc1
    buffer_load_dwordx4 v[144:147], v6, s[4:7], s30 offen sc1
    s_add_u32 s30, s30, 196608
    buffer_load_dwordx4 v[84:87], v5, s[4:7], s30 offen sc1
    buffer_load_dwordx4 v[148:151], v6, s[4:7], s30 offen sc1
    s_add_u32 s30, s30, 196608
    buffer_load_dwordx4 v[88:91], v5, s[4:7], s30 offen sc1
    buffer_load_dwordx4 v[152:155], v6, s[4:7], s30 offen sc1
    s_add_u32 s30, s30, 196608
    buffer_load_dwordx4 v[92:95], v5, s[4:7], s30 offen sc1
    buffer_load_dwordx4 v[156:159], v6, s[4:7], s30 offen sc1
    s_add_u32 s30, s30, 196608
    s_lshl_b32 s30, s33, 7
    s_add_u32 s31, s59, 0
    s_lshl_b32 s31, s31, 3
    s_add_u32 s30, s30, s31
    s_lshl_b32 s31, s23, 1
    s_add_u32 s30, s30, s31
    s_lshl_b32 s30, s30, 10
    s_add_u32 s31, s30, 131072
    v_lshlrev_b32 v9, 4, v1
    buffer_load_dwordx4 v[160:163], v9, s[4:7], s30 offen offset:0 sc1
    buffer_load_dwordx4 v[164:167], v9, s[4:7], s31 offen offset:0 sc1
    buffer_load_dwordx4 v[168:171], v9, s[4:7], s30 offen offset:1024 sc1
    buffer_load_dwordx4 v[172:175], v9, s[4:7], s31 offen offset:1024 sc1
    s_and_b32 s30, s23, 1
    s_lshl_b32 s30, s30, 4
    v_lshrrev_b32 v225, 2, v1
    v_add_u32 v225, s30, v225
    v_and_b32 v226, 3, v1
    s_lshr_b32 s30, s23, 1
    s_and_b32 s30, s30, 1
    s_lshl_b32 s30, s30, 2
    v_subrev_u32 v227, s30, v225
    v_mul_u32_u24 v228, 40, v227
    v_and_b32 v229, 1, v226
    v_mul_u32_u24 v229, 20, v229
    s_lshl_b32 s31, s23, 10
    s_add_u32 s31, s31, 155648
    v_add3_u32 v228, v228, v229, s31
    v_cmp_gt_u32 s[36:37], 20, v227
    v_mov_b32 v229, s31
    s_nop 0
    v_cndmask_b32 v228, v229, v228, s[36:37]
    v_cmp_gt_u32 vcc, 2, v226
    v_add_u32 v230, 8, v228
    s_nop 0
    v_cndmask_b32 v230, v230, v228, vcc
    v_add_u32 v231, 18, v228
    v_add_u32 v232, 10, v228
    v_cndmask_b32 v231, v231, v232, vcc
    s_and_b64 s[38:39], vcc, s[36:37]
    s_waitcnt vmcnt(36)
    ds_read_u16 v234, v230
    ds_read_u16 v235, v228 offset:2
    ds_read_u16 v236, v228 offset:4
    ds_read_u16 v237, v228 offset:6
    ds_read_u16 v238, v231
    ds_read_u16 v239, v228 offset:12
    ds_read_u16 v240, v228 offset:14
    ds_read_u16 v241, v228 offset:16
    s_waitcnt lgkmcnt(0)
    v_cndmask_b32 v234, 0, v234, s[36:37]
    v_cndmask_b32 v235, 0, v235, s[38:39]
    v_cndmask_b32 v236, 0, v236, s[38:39]
    v_cndmask_b32 v237, 0, v237, s[38:39]
    v_cndmask_b32 v238, 0, v238, s[36:37]
    v_cndmask_b32 v239, 0, v239, s[38:39]
    v_cndmask_b32 v240, 0, v240, s[38:39]
    v_cndmask_b32 v241, 0, v241, s[38:39]
    v_lshl_or_b32 v224, v235, 16, v234
    v_lshl_or_b32 v225, v237, 16, v236
    v_lshl_or_b32 v226, v239, 16, v238
    v_lshl_or_b32 v227, v241, 16, v240
    s_lshl_b32 s31, s23, 10
    s_add_u32 s31, s31, 151552
    v_lshl_add_u32 v228, v1, 4, s31
    ds_write_b128 v228, v[224:227]
    s_waitcnt vmcnt(4)
    v_pk_add_f32 v[32:33], v[32:33], v[64:65]
    v_pk_add_f32 v[34:35], v[34:35], v[66:67]
    v_pk_add_f32 v[36:37], v[36:37], v[68:69]
    v_pk_add_f32 v[38:39], v[38:39], v[70:71]
    v_pk_add_f32 v[40:41], v[40:41], v[72:73]
    v_pk_add_f32 v[42:43], v[42:43], v[74:75]
    v_pk_add_f32 v[44:45], v[44:45], v[76:77]
    v_pk_add_f32 v[46:47], v[46:47], v[78:79]
    v_pk_add_f32 v[48:49], v[48:49], v[80:81]
    v_pk_add_f32 v[50:51], v[50:51], v[82:83]
    v_pk_add_f32 v[52:53], v[52:53], v[84:85]
    v_pk_add_f32 v[54:55], v[54:55], v[86:87]
    v_pk_add_f32 v[56:57], v[56:57], v[88:89]
    v_pk_add_f32 v[58:59], v[58:59], v[90:91]
    v_pk_add_f32 v[60:61], v[60:61], v[92:93]
    v_pk_add_f32 v[62:63], v[62:63], v[94:95]
    v_pk_add_f32 v[96:97], v[96:97], v[128:129]
    v_pk_add_f32 v[98:99], v[98:99], v[130:131]
    v_pk_add_f32 v[100:101], v[100:101], v[132:133]
    v_pk_add_f32 v[102:103], v[102:103], v[134:135]
    v_pk_add_f32 v[104:105], v[104:105], v[136:137]
    v_pk_add_f32 v[106:107], v[106:107], v[138:139]
    v_pk_add_f32 v[108:109], v[108:109], v[140:141]
    v_pk_add_f32 v[110:111], v[110:111], v[142:143]
    v_pk_add_f32 v[112:113], v[112:113], v[144:145]
    v_pk_add_f32 v[114:115], v[114:115], v[146:147]
    v_pk_add_f32 v[116:117], v[116:117], v[148:149]
    v_pk_add_f32 v[118:119], v[118:119], v[150:151]
    v_pk_add_f32 v[120:121], v[120:121], v[152:153]
    v_pk_add_f32 v[122:123], v[122:123], v[154:155]
    v_pk_add_f32 v[124:125], v[124:125], v[156:157]
    v_pk_add_f32 v[126:127], v[126:127], v[158:159]
    v_pk_add_f32 v[32:33], v[32:33], v[48:49]
    v_pk_add_f32 v[34:35], v[34:35], v[50:51]
    v_pk_add_f32 v[36:37], v[36:37], v[52:53]
    v_pk_add_f32 v[38:39], v[38:39], v[54:55]
    v_pk_add_f32 v[40:41], v[40:41], v[56:57]
    v_pk_add_f32 v[42:43], v[42:43], v[58:59]
    v_pk_add_f32 v[44:45], v[44:45], v[60:61]
    v_pk_add_f32 v[46:47], v[46:47], v[62:63]
    v_pk_add_f32 v[96:97], v[96:97], v[112:113]
    v_pk_add_f32 v[98:99], v[98:99], v[114:115]
    v_pk_add_f32 v[100:101], v[100:101], v[116:117]
    v_pk_add_f32 v[102:103], v[102:103], v[118:119]
    v_pk_add_f32 v[104:105], v[104:105], v[120:121]
    v_pk_add_f32 v[106:107], v[106:107], v[122:123]
    v_pk_add_f32 v[108:109], v[108:109], v[124:125]
    v_pk_add_f32 v[110:111], v[110:111], v[126:127]
    v_pk_add_f32 v[32:33], v[32:33], v[40:41]
    v_pk_add_f32 v[34:35], v[34:35], v[42:43]
    v_pk_add_f32 v[36:37], v[36:37], v[44:45]
    v_pk_add_f32 v[38:39], v[38:39], v[46:47]
    v_pk_add_f32 v[96:97], v[96:97], v[104:105]
    v_pk_add_f32 v[98:99], v[98:99], v[106:107]
    v_pk_add_f32 v[100:101], v[100:101], v[108:109]
    v_pk_add_f32 v[102:103], v[102:103], v[110:111]
    v_pk_add_f32 v[32:33], v[32:33], v[36:37]
    v_pk_add_f32 v[34:35], v[34:35], v[38:39]
    v_pk_add_f32 v[96:97], v[96:97], v[100:101]
    v_pk_add_f32 v[98:99], v[98:99], v[102:103]
    v_lshlrev_b32 v4, 3, v0
    v_add_u32 v4, 147456, v4
    v_cvt_pk_bf16_f32 v32, v32, v33
    v_cvt_pk_bf16_f32 v33, v34, v35
    ds_write_b64 v4, v[32:33] offset:0
    v_cvt_pk_bf16_f32 v96, v96, v97
    v_cvt_pk_bf16_f32 v97, v98, v99
    ds_write_b64 v4, v[96:97] offset:2048
    v_lshrrev_b32 v14, 2, v2
    v_lshl_add_u32 v14, v3, 2, v14
    v_lshlrev_b32 v14, 6, v14
    v_and_b32 v15, 3, v2
    v_lshl_add_u32 v14, v15, 3, v14
    v_add_u32 v14, 151552, v14
    v_lshlrev_b32 v4, 3, v1
    v_add_u32 v4, 147456, v4
    v_min_u32 v5, 4, v2
    v_mul_u32_u24 v6, 5, v3
    v_add_u32 v5, v5, v6
    v_lshlrev_b32 v5, 3, v5
    v_add_u32 v5, 147456, v5
    v_add_u32 v6, 4, v6
    v_lshlrev_b32 v6, 3, v6
    v_add_u32 v6, 147456, v6
    v_mov_b32 v16, 159744
    v_mov_b32 v17, 1
    s_waitcnt lgkmcnt(0)
    s_mov_b64 exec, 1
    ds_add_u32 v16, v17
    s_mov_b64 exec, -1
KO_spin:
    ds_read_b32 v17, v16
    s_waitcnt lgkmcnt(0)
    v_readfirstlane_b32 s30, v17
    s_sub_u32 s95, s95, 1
    s_cbranch_scc1 K2_exit
    s_cmp_lt_u32 s30, 4
    s_cbranch_scc1 KO_spin
    ds_read_b64_tr_b16 v[32:33], v14 offset:0
    ds_read_b64_tr_b16 v[34:35], v14 offset:1024
    ds_read_b64_tr_b16 v[36:37], v14 offset:32
    ds_read_b64_tr_b16 v[38:39], v14 offset:1056
    ds_read_b64_tr_b16 v[40:41], v14 offset:2048
    ds_read_b64_tr_b16 v[42:43], v14 offset:3072
    ds_read_b64_tr_b16 v[44:45], v14 offset:2080
    ds_read_b64_tr_b16 v[46:47], v14 offset:3104
    ds_read_b64 v[48:49], v4 offset:0
    ds_read_b64 v[54:55], v5 offset:1536
    ds_read_b64 v[60:61], v6 offset:1536
    ds_read_b64 v[50:51], v4 offset:512
    ds_read_b64 v[56:57], v5 offset:1696
    ds_read_b64 v[62:63], v6 offset:1696
    ds_read_b64 v[52:53], v4 offset:1024
    ds_read_b64 v[58:59], v5 offset:1856
    ds_read_b64 v[64:65], v6 offset:1856
    ds_read_b64 v[66:67], v4 offset:2048
    ds_read_b64 v[72:73], v5 offset:3584
    ds_read_b64 v[78:79], v6 offset:3584
    ds_read_b64 v[68:69], v4 offset:2560
    ds_read_b64 v[74:75], v5 offset:3744
    ds_read_b64 v[80:81], v6 offset:3744
    ds_read_b64 v[70:71], v4 offset:3072
    ds_read_b64 v[76:77], v5 offset:3904
    ds_read_b64 v[82:83], v6 offset:3904
    s_waitcnt lgkmcnt(0)
    s_waitcnt vmcnt(0)
    v_mfma_f32_16x16x32_bf16 v[84:87], v[32:35], v[160:163], 0
    v_mfma_f32_16x16x32_bf16 v[88:91], v[36:39], v[160:163], 0
    v_mfma_f32_16x16x32_bf16 v[92:95], v[40:43], v[164:167], 0
    v_mfma_f32_16x16x32_bf16 v[96:99], v[44:47], v[164:167], 0
    v_mfma_f32_16x16x32_bf16 v[100:103], v[32:35], v[168:171], 0
    v_mfma_f32_16x16x32_bf16 v[104:107], v[36:39], v[168:171], 0
    v_mfma_f32_16x16x32_bf16 v[108:111], v[40:43], v[172:175], 0
    v_mfma_f32_16x16x32_bf16 v[112:115], v[44:47], v[172:175], 0
    s_nop 0
    v_cvt_pk_bf16_f32 v185, v84, v85
    v_cvt_pk_bf16_f32 v186, v86, v87
    v_cvt_pk_bf16_f32 v187, v88, v88
    v_cvt_pk_bf16_f32 v201, v92, v93
    v_cvt_pk_bf16_f32 v202, v94, v95
    v_cvt_pk_bf16_f32 v203, v96, v96
    v_cvt_pk_bf16_f32 v217, v100, v101
    v_cvt_pk_bf16_f32 v218, v102, v103
    v_cvt_pk_bf16_f32 v219, v104, v104
    v_cvt_pk_bf16_f32 v233, v108, v109
    v_cvt_pk_bf16_f32 v234, v110, v111
    v_cvt_pk_bf16_f32 v235, v112, v112
    v_lshlrev_b32 v180, 16, v185
    v_and_b32 v181, 0xffff0000, v185
    v_lshlrev_b32 v182, 16, v186
    v_and_b32 v183, 0xffff0000, v186
    v_lshlrev_b32 v184, 16, v187
    v_lshlrev_b32 v196, 16, v201
    v_and_b32 v197, 0xffff0000, v201
    v_lshlrev_b32 v198, 16, v202
    v_and_b32 v199, 0xffff0000, v202
    v_lshlrev_b32 v200, 16, v203
    v_lshlrev_b32 v212, 16, v217
    v_and_b32 v213, 0xffff0000, v217
    v_lshlrev_b32 v214, 16, v218
    v_and_b32 v215, 0xffff0000, v218
    v_lshlrev_b32 v216, 16, v219
    v_lshlrev_b32 v228, 16, v233
    v_and_b32 v229, 0xffff0000, v233
    v_lshlrev_b32 v230, 16, v234
    v_and_b32 v231, 0xffff0000, v234
    v_lshlrev_b32 v232, 16, v235
    v_max3_f32 v116, v180, v181, v182
    v_min3_f32 v117, v180, v181, v182
    v_max3_f32 v116, v116, v183, v184
    v_min3_f32 v117, v117, v183, v184
    v_max3_f32 v122, v196, v197, v198
    v_min3_f32 v123, v196, v197, v198
    v_max3_f32 v122, v122, v199, v200
    v_min3_f32 v123, v123, v199, v200
    v_max3_f32 v128, v212, v213, v214
    v_min3_f32 v129, v212, v213, v214
    v_max3_f32 v128, v128, v215, v216
    v_min3_f32 v129, v129, v215, v216
    v_max3_f32 v134, v228, v229, v230
    v_min3_f32 v135, v228, v229, v230
    v_max3_f32 v134, v134, v231, v232
    v_min3_f32 v135, v135, v231, v232
    v_sub_f32 v117, 0, v117
    v_sub_f32 v123, 0, v123
    v_sub_f32 v129, 0, v129
    v_sub_f32 v135, 0, v135
    v_mov_b32 v118, v116
    v_mov_b32 v124, v122
    v_mov_b32 v130, v128
    v_mov_b32 v136, v134
    v_mov_b32 v119, v117
    v_mov_b32 v125, v123
    v_mov_b32 v131, v129
    v_mov_b32 v137, v135
    v_permlane32_swap_b32 v116, v118
    v_permlane32_swap_b32 v122, v124
    v_permlane32_swap_b32 v128, v130
    v_permlane32_swap_b32 v134, v136
    v_permlane32_swap_b32 v117, v119
    v_permlane32_swap_b32 v123, v125
    v_permlane32_swap_b32 v129, v131
    v_permlane32_swap_b32 v135, v137
    v_max_f32 v116, v116, v118
    v_max_f32 v122, v122, v124
    v_max_f32 v128, v128, v130
    v_max_f32 v134, v134, v136
    v_max_f32 v117, v117, v119
    v_max_f32 v123, v123, v125
    v_max_f32 v129, v129, v131
    v_max_f32 v135, v135, v137
    v_mov_b32 v118, v116
    v_mov_b32 v124, v122
    v_mov_b32 v130, v128
    v_mov_b32 v136, v134
    v_mov_b32 v119, v117
    v_mov_b32 v125, v123
    v_mov_b32 v131, v129
    v_mov_b32 v137, v135
    v_permlane16_swap_b32 v116, v118
    v_permlane16_swap_b32 v122, v124
    v_permlane16_swap_b32 v128, v130
    v_permlane16_swap_b32 v134, v136
    v_permlane16_swap_b32 v117, v119
    v_permlane16_swap_b32 v123, v125
    v_permlane16_swap_b32 v129, v131
    v_permlane16_swap_b32 v135, v137
    v_max_f32 v116, v116, v118
    v_max_f32 v122, v122, v124
    v_max_f32 v128, v128, v130
    v_max_f32 v134, v134, v136
    v_max_f32 v117, v117, v119
    v_max_f32 v123, v123, v125
    v_max_f32 v129, v129, v131
    v_max_f32 v135, v135, v137
    v_mul_f32 v116, s35, v116
    v_mul_f32 v117, s35, v117
    v_mul_f32 v122, s35, v122
    v_mul_f32 v123, s35, v123
    v_mul_f32 v128, s35, v128
    v_mul_f32 v129, s35, v129
    v_mul_f32 v134, s35, v134
    v_mul_f32 v135, s35, v135
    v_fma_f32 v185, v180, s34, v116
    v_fma_f32 v190, v180, s35, v117
    v_fma_f32 v186, v181, s34, v116
    v_fma_f32 v191, v181, s35, v117
    v_fma_f32 v187, v182, s34, v116
    v_fma_f32 v192, v182, s35, v117
    v_fma_f32 v188, v183, s34, v116
    v_fma_f32 v193, v183, s35, v117
    v_fma_f32 v189, v184, s34, v116
    v_fma_f32 v194, v184, s35, v117
    v_fma_f32 v201, v196, s34, v122
    v_fma_f32 v206, v196, s35, v123
    v_fma_f32 v202, v197, s34, v122
    v_fma_f32 v207, v197, s35, v123
    v_fma_f32 v203, v198, s34, v122
    v_fma_f32 v208, v198, s35, v123
    v_fma_f32 v204, v199, s34, v122
    v_fma_f32 v209, v199, s35, v123
    v_fma_f32 v205, v200, s34, v122
    v_fma_f32 v210, v200, s35, v123
    v_fma_f32 v217, v212, s34, v128
    v_fma_f32 v222, v212, s35, v129
    v_fma_f32 v218, v213, s34, v128
    v_fma_f32 v223, v213, s35, v129
    v_fma_f32 v219, v214, s34, v128
    v_fma_f32 v224, v214, s35, v129
    v_fma_f32 v220, v215, s34, v128
    v_fma_f32 v225, v215, s35, v129
    v_fma_f32 v221, v216, s34, v128
    v_fma_f32 v226, v216, s35, v129
    v_fma_f32 v233, v228, s34, v134
    v_fma_f32 v238, v228, s35, v135
    v_fma_f32 v234, v229, s34, v134
    v_fma_f32 v239, v229, s35, v135
    v_fma_f32 v235, v230, s34, v134
    v_fma_f32 v240, v230, s35, v135
    v_fma_f32 v236, v231, s34, v134
    v_fma_f32 v241, v231, s35, v135
    v_fma_f32 v237, v232, s34, v134
    v_fma_f32 v242, v232, s35, v135
    v_exp_f32 v185, v185
    v_exp_f32 v186, v186
    v_exp_f32 v187, v187
    v_exp_f32 v188, v188
    v_exp_f32 v189, v189
    v_exp_f32 v190, v190
    v_exp_f32 v191, v191
    v_exp_f32 v192, v192
    v_exp_f32 v193, v193
    v_exp_f32 v194, v194
    v_exp_f32 v201, v201
    v_exp_f32 v202, v202
    v_exp_f32 v203, v203
    v_exp_f32 v204, v204
    v_exp_f32 v205, v205
    v_exp_f32 v206, v206
    v_exp_f32 v207, v207
    v_exp_f32 v208, v208
    v_exp_f32 v209, v209
    v_exp_f32 v210, v210
    v_exp_f32 v217, v217
    v_exp_f32 v218, v218
    v_exp_f32 v219, v219
    v_exp_f32 v220, v220
    v_exp_f32 v221, v221
    v_exp_f32 v222, v222
    v_exp_f32 v223, v223
    v_exp_f32 v224, v224
    v_exp_f32 v225, v225
    v_exp_f32 v226, v226
    v_exp_f32 v233, v233
    v_exp_f32 v234, v234
    v_exp_f32 v235, v235
    v_exp_f32 v236, v236
    v_exp_f32 v237, v237
    v_exp_f32 v238, v238
    v_exp_f32 v239, v239
    v_exp_f32 v240, v240
    v_exp_f32 v241, v241
    v_exp_f32 v242, v242
    v_add_f32 v116, v185, v186
    v_add_f32 v117, v190, v191
    v_add_f32 v118, v187, v188
    v_add_f32 v119, v192, v193
    v_add_f32 v116, v116, v189
    v_add_f32 v117, v117, v194
    v_add_f32 v116, v116, v118
    v_add_f32 v117, v117, v119
    v_add_f32 v122, v201, v202
    v_add_f32 v123, v206, v207
    v_add_f32 v124, v203, v204
    v_add_f32 v125, v208, v209
    v_add_f32 v122, v122, v205
    v_add_f32 v123, v123, v210
    v_add_f32 v122, v122, v124
    v_add_f32 v123, v123, v125
    v_add_f32 v128, v217, v218
    v_add_f32 v129, v222, v223
    v_add_f32 v130, v219, v220
    v_add_f32 v131, v224, v225
    v_add_f32 v128, v128, v221
    v_add_f32 v129, v129, v226
    v_add_f32 v128, v128, v130
    v_add_f32 v129, v129, v131
    v_add_f32 v134, v233, v234
    v_add_f32 v135, v238, v239
    v_add_f32 v136, v235, v236
    v_add_f32 v137, v240, v241
    v_add_f32 v134, v134, v237
    v_add_f32 v135, v135, v242
    v_add_f32 v134, v134, v136
    v_add_f32 v135, v135, v137
    v_mov_b32 v118, v116
    v_mov_b32 v124, v122
    v_mov_b32 v130, v128
    v_mov_b32 v136, v134
    v_mov_b32 v119, v117
    v_mov_b32 v125, v123
    v_mov_b32 v131, v129
    v_mov_b32 v137, v135
    v_permlane32_swap_b32 v116, v118
    v_permlane32_swap_b32 v122, v124
    v_permlane32_swap_b32 v128, v130
    v_permlane32_swap_b32 v134, v136
    v_permlane32_swap_b32 v117, v119
    v_permlane32_swap_b32 v123, v125
    v_permlane32_swap_b32 v129, v131
    v_permlane32_swap_b32 v135, v137
    v_add_f32 v116, v116, v118
    v_add_f32 v122, v122, v124
    v_add_f32 v128, v128, v130
    v_add_f32 v134, v134, v136
    v_add_f32 v117, v117, v119
    v_add_f32 v123, v123, v125
    v_add_f32 v129, v129, v131
    v_add_f32 v135, v135, v137
    v_mov_b32 v118, v116
    v_mov_b32 v124, v122
    v_mov_b32 v130, v128
    v_mov_b32 v136, v134
    v_mov_b32 v119, v117
    v_mov_b32 v125, v123
    v_mov_b32 v131, v129
    v_mov_b32 v137, v135
    v_permlane16_swap_b32 v116, v118
    v_permlane16_swap_b32 v122, v124
    v_permlane16_swap_b32 v128, v130
    v_permlane16_swap_b32 v134, v136
    v_permlane16_swap_b32 v117, v119
    v_permlane16_swap_b32 v123, v125
    v_permlane16_swap_b32 v129, v131
    v_permlane16_swap_b32 v135, v137
    v_add_f32 v116, v116, v118
    v_add_f32 v122, v122, v124
    v_add_f32 v128, v128, v130
    v_add_f32 v134, v134, v136
    v_add_f32 v117, v117, v119
    v_add_f32 v123, v123, v125
    v_add_f32 v129, v129, v131
    v_add_f32 v135, v135, v137
    v_rcp_f32 v116, v116
    v_rcp_f32 v117, v117
    v_rcp_f32 v122, v122
    v_rcp_f32 v123, v123
    v_rcp_f32 v128, v128
    v_rcp_f32 v129, v129
    v_rcp_f32 v134, v134
    v_rcp_f32 v135, v135
    v_mul_f32 v185, v185, v116
    v_mul_f32 v190, v190, v117
    v_mul_f32 v186, v186, v116
    v_mul_f32 v191, v191, v117
    v_mul_f32 v187, v187, v116
    v_mul_f32 v192, v192, v117
    v_mul_f32 v188, v188, v116
    v_mul_f32 v193, v193, v117
    v_mul_f32 v189, v189, v116
    v_mul_f32 v194, v194, v117
    v_mul_f32 v201, v201, v122
    v_mul_f32 v206, v206, v123
    v_mul_f32 v202, v202, v122
    v_mul_f32 v207, v207, v123
    v_mul_f32 v203, v203, v122
    v_mul_f32 v208, v208, v123
    v_mul_f32 v204, v204, v122
    v_mul_f32 v209, v209, v123
    v_mul_f32 v205, v205, v122
    v_mul_f32 v210, v210, v123
    v_mul_f32 v217, v217, v128
    v_mul_f32 v222, v222, v129
    v_mul_f32 v218, v218, v128
    v_mul_f32 v223, v223, v129
    v_mul_f32 v219, v219, v128
    v_mul_f32 v224, v224, v129
    v_mul_f32 v220, v220, v128
    v_mul_f32 v225, v225, v129
    v_mul_f32 v221, v221, v128
    v_mul_f32 v226, v226, v129
    v_mul_f32 v233, v233, v134
    v_mul_f32 v238, v238, v135
    v_mul_f32 v234, v234, v134
    v_mul_f32 v239, v239, v135
    v_mul_f32 v235, v235, v134
    v_mul_f32 v240, v240, v135
    v_mul_f32 v236, v236, v134
    v_mul_f32 v241, v241, v135
    v_mul_f32 v237, v237, v134
    v_mul_f32 v242, v242, v135
    v_cvt_pk_bf16_f32 v116, v185, v186
    v_cvt_pk_bf16_f32 v117, v187, v188
    v_cvt_pk_bf16_f32 v118, v189, v190
    v_cvt_pk_bf16_f32 v119, v191, v192
    v_cvt_pk_bf16_f32 v120, v193, v194
    v_mov_b32 v121, 0
    v_cvt_pk_bf16_f32 v122, v201, v202
    v_cvt_pk_bf16_f32 v123, v203, v204
    v_cvt_pk_bf16_f32 v124, v205, v206
    v_cvt_pk_bf16_f32 v125, v207, v208
    v_cvt_pk_bf16_f32 v126, v209, v210
    v_mov_b32 v127, 0
    v_cvt_pk_bf16_f32 v128, v217, v218
    v_cvt_pk_bf16_f32 v129, v219, v220
    v_cvt_pk_bf16_f32 v130, v221, v222
    v_cvt_pk_bf16_f32 v131, v223, v224
    v_cvt_pk_bf16_f32 v132, v225, v226
    v_mov_b32 v133, 0
    v_cvt_pk_bf16_f32 v134, v233, v234
    v_cvt_pk_bf16_f32 v135, v235, v236
    v_cvt_pk_bf16_f32 v136, v237, v238
    v_cvt_pk_bf16_f32 v137, v239, v240
    v_cvt_pk_bf16_f32 v138, v241, v242
    v_mov_b32 v139, 0
    v_mfma_f32_16x16x32_bf16 v[180:183], v[48:51], v[116:119], 0
    v_mfma_f32_16x16x32_bf16 v[184:187], v[54:57], v[116:119], 0
    v_mfma_f32_16x16x32_bf16 v[188:191], v[60:63], v[116:119], 0
    v_mfma_f32_16x16x16_bf16 v[180:183], v[52:53], v[120:121], v[180:183]
    v_mfma_f32_16x16x16_bf16 v[184:187], v[58:59], v[120:121], v[184:187]
    v_mfma_f32_16x16x16_bf16 v[188:191], v[64:65], v[120:121], v[188:191]
    v_mfma_f32_16x16x32_bf16 v[192:195], v[66:69], v[122:125], 0
    v_mfma_f32_16x16x32_bf16 v[196:199], v[72:75], v[122:125], 0
    v_mfma_f32_16x16x32_bf16 v[200:203], v[78:81], v[122:125], 0
    v_mfma_f32_16x16x16_bf16 v[192:195], v[70:71], v[126:127], v[192:195]
    v_mfma_f32_16x16x16_bf16 v[196:199], v[76:77], v[126:127], v[196:199]
    v_mfma_f32_16x16x16_bf16 v[200:203], v[82:83], v[126:127], v[200:203]
    v_mfma_f32_16x16x32_bf16 v[204:207], v[48:51], v[128:131], 0
    v_mfma_f32_16x16x32_bf16 v[208:211], v[54:57], v[128:131], 0
    v_mfma_f32_16x16x32_bf16 v[212:215], v[60:63], v[128:131], 0
    v_mfma_f32_16x16x16_bf16 v[204:207], v[52:53], v[132:133], v[204:207]
    v_mfma_f32_16x16x16_bf16 v[208:211], v[58:59], v[132:133], v[208:211]
    v_mfma_f32_16x16x16_bf16 v[212:215], v[64:65], v[132:133], v[212:215]
    v_mfma_f32_16x16x32_bf16 v[216:219], v[66:69], v[134:137], 0
    v_mfma_f32_16x16x32_bf16 v[220:223], v[72:75], v[134:137], 0
    v_mfma_f32_16x16x32_bf16 v[224:227], v[78:81], v[134:137], 0
    v_mfma_f32_16x16x16_bf16 v[216:219], v[70:71], v[138:139], v[216:219]
    v_mfma_f32_16x16x16_bf16 v[220:223], v[76:77], v[138:139], v[220:223]
    v_mfma_f32_16x16x16_bf16 v[224:227], v[82:83], v[138:139], v[224:227]
    s_mov_b32 s30, 0x358637bd
    s_add_u32 s31, s59, 0
    s_lshl_b32 s31, s31, 7
    s_lshl_b32 s36, s23, 5
    s_add_u32 s31, s31, s36
    v_add_u32 v12, s31, v2
    v_lshl_add_u32 v13, v3, 11, v12
    v_lshlrev_b32 v13, 4, v13
    v_lshlrev_b32 v12, 4, v12
    v_add_u32 v12, 131072, v12
    v_cmp_eq_u32 vcc, 0, v3
    s_nop 1
    v_cndmask_b32 v12, v25, v12, vcc
    s_mul_i32 s31, s58, 163840
    s_add_u32 s31, s31, 14417920
    v_cvt_pk_bf16_f32 v84, v188, v188
    v_lshlrev_b32 v84, 16, v84
    v_add_f32 v84, s30, v84
    v_cvt_pk_bf16_f32 v84, v84, v84
    v_lshlrev_b32 v84, 16, v84
    v_rcp_f32 v84, v84
    v_cvt_pk_bf16_f32 v86, v180, v181
    v_cvt_pk_bf16_f32 v87, v182, v183
    v_cvt_pk_bf16_f32 v88, v184, v185
    v_cvt_pk_bf16_f32 v89, v186, v187
    v_lshlrev_b32 v180, 16, v86
    v_and_b32 v181, 0xffff0000, v86
    v_lshlrev_b32 v182, 16, v87
    v_and_b32 v183, 0xffff0000, v87
    v_lshlrev_b32 v184, 16, v88
    v_and_b32 v185, 0xffff0000, v88
    v_lshlrev_b32 v186, 16, v89
    v_and_b32 v187, 0xffff0000, v89
    v_mul_f32 v180, v180, v84
    v_mul_f32 v181, v181, v84
    v_mul_f32 v182, v182, v84
    v_mul_f32 v183, v183, v84
    v_mul_f32 v184, v184, v84
    v_mul_f32 v185, v185, v84
    v_mul_f32 v186, v186, v84
    v_mul_f32 v187, v187, v84
    v_cvt_pk_bf16_f32 v228, v180, v181
    v_cvt_pk_bf16_f32 v236, v184, v185
    v_cvt_pk_bf16_f32 v229, v182, v183
    v_cvt_pk_bf16_f32 v237, v186, v187
    v_cvt_pk_bf16_f32 v92, v200, v200
    v_lshlrev_b32 v92, 16, v92
    v_add_f32 v92, s30, v92
    v_cvt_pk_bf16_f32 v92, v92, v92
    v_lshlrev_b32 v92, 16, v92
    v_rcp_f32 v92, v92
    v_cvt_pk_bf16_f32 v94, v192, v193
    v_cvt_pk_bf16_f32 v95, v194, v195
    v_cvt_pk_bf16_f32 v96, v196, v197
    v_cvt_pk_bf16_f32 v97, v198, v199
    v_lshlrev_b32 v192, 16, v94
    v_and_b32 v193, 0xffff0000, v94
    v_lshlrev_b32 v194, 16, v95
    v_and_b32 v195, 0xffff0000, v95
    v_lshlrev_b32 v196, 16, v96
    v_and_b32 v197, 0xffff0000, v96
    v_lshlrev_b32 v198, 16, v97
    v_and_b32 v199, 0xffff0000, v97
    v_mul_f32 v192, v192, v92
    v_mul_f32 v193, v193, v92
    v_mul_f32 v194, v194, v92
    v_mul_f32 v195, v195, v92
    v_mul_f32 v196, v196, v92
    v_mul_f32 v197, v197, v92
    v_mul_f32 v198, v198, v92
    v_mul_f32 v199, v199, v92
    v_cvt_pk_bf16_f32 v230, v192, v193
    v_cvt_pk_bf16_f32 v238, v196, v197
    v_cvt_pk_bf16_f32 v231, v194, v195
    v_cvt_pk_bf16_f32 v239, v198, v199
    v_cvt_pk_bf16_f32 v100, v212, v212
    v_lshlrev_b32 v100, 16, v100
    v_add_f32 v100, s30, v100
    v_cvt_pk_bf16_f32 v100, v100, v100
    v_lshlrev_b32 v100, 16, v100
    v_rcp_f32 v100, v100
    v_cvt_pk_bf16_f32 v102, v204, v205
    v_cvt_pk_bf16_f32 v103, v206, v207
    v_cvt_pk_bf16_f32 v104, v208, v209
    v_cvt_pk_bf16_f32 v105, v210, v211
    v_lshlrev_b32 v204, 16, v102
    v_and_b32 v205, 0xffff0000, v102
    v_lshlrev_b32 v206, 16, v103
    v_and_b32 v207, 0xffff0000, v103
    v_lshlrev_b32 v208, 16, v104
    v_and_b32 v209, 0xffff0000, v104
    v_lshlrev_b32 v210, 16, v105
    v_and_b32 v211, 0xffff0000, v105
    v_mul_f32 v204, v204, v100
    v_mul_f32 v205, v205, v100
    v_mul_f32 v206, v206, v100
    v_mul_f32 v207, v207, v100
    v_mul_f32 v208, v208, v100
    v_mul_f32 v209, v209, v100
    v_mul_f32 v210, v210, v100
    v_mul_f32 v211, v211, v100
    v_cvt_pk_bf16_f32 v232, v204, v205
    v_cvt_pk_bf16_f32 v240, v208, v209
    v_cvt_pk_bf16_f32 v233, v206, v207
    v_cvt_pk_bf16_f32 v241, v210, v211
    v_cvt_pk_bf16_f32 v108, v224, v224
    v_lshlrev_b32 v108, 16, v108
    v_add_f32 v108, s30, v108
    v_cvt_pk_bf16_f32 v108, v108, v108
    v_lshlrev_b32 v108, 16, v108
    v_rcp_f32 v108, v108
    v_cvt_pk_bf16_f32 v110, v216, v217
    v_cvt_pk_bf16_f32 v111, v218, v219
    v_cvt_pk_bf16_f32 v112, v220, v221
    v_cvt_pk_bf16_f32 v113, v222, v223
    v_lshlrev_b32 v216, 16, v110
    v_and_b32 v217, 0xffff0000, v110
    v_lshlrev_b32 v218, 16, v111
    v_and_b32 v219, 0xffff0000, v111
    v_lshlrev_b32 v220, 16, v112
    v_and_b32 v221, 0xffff0000, v112
    v_lshlrev_b32 v222, 16, v113
    v_and_b32 v223, 0xffff0000, v113
    v_mul_f32 v216, v216, v108
    v_mul_f32 v217, v217, v108
    v_mul_f32 v218, v218, v108
    v_mul_f32 v219, v219, v108
    v_mul_f32 v220, v220, v108
    v_mul_f32 v221, v221, v108
    v_mul_f32 v222, v222, v108
    v_mul_f32 v223, v223, v108
    v_cvt_pk_bf16_f32 v234, v216, v217
    v_cvt_pk_bf16_f32 v242, v220, v221
    v_cvt_pk_bf16_f32 v235, v218, v219
    v_cvt_pk_bf16_f32 v243, v222, v223
    buffer_store_dwordx4 v[228:231], v13, s[4:7], s31 offen offset:0 sc1
    buffer_store_dwordx4 v[236:239], v12, s[4:7], s31 offen offset:0 sc1
    buffer_store_dwordx4 v[232:235], v13, s[4:7], s31 offen offset:256 sc1
    buffer_store_dwordx4 v[240:243], v12, s[4:7], s31 offen offset:256 sc1
    s_waitcnt vmcnt(0)
    s_mov_b64 exec, 1
    v_mov_b32 v6, 1
    s_add_u32 s30, s59, 0
    s_lshl_b32 s30, s30, 8
    s_add_u32 s30, s30, 17039360
    v_mov_b32 v7, s30
    buffer_atomic_add v6, v7, s[4:7], 0 offen sc1
    s_mov_b64 exec, -1
    s_add_u32 s23, s23, 4
K2_exit:
    s_endpgm
.section .rodata,"a"
.p2align 6
.amdhsa_kernel recurrent_scan__linear_kernel_hedgehog__dense_activation_mish__prompt_kernel
  .amdhsa_next_free_vgpr 256
  .amdhsa_next_free_sgpr 102
  .amdhsa_accum_offset 256
  .amdhsa_group_segment_fixed_size 0
  .amdhsa_kernarg_size 88
  .amdhsa_user_sgpr_count 2
  .amdhsa_user_sgpr_kernarg_segment_ptr 1
  .amdhsa_system_sgpr_workgroup_id_x 1
  .amdhsa_float_denorm_mode_32 3
.end_amdhsa_kernel
.text
```
